```python
import torch

def _softmax(x, axis=-1):
    return torch.softmax(x, dim=axis)
def _gelu(x):
    return torch.nn.functional.gelu(x, approximate="tanh")
def _silu(x):
    return torch.nn.functional.silu(x)
def _sigmoid(x):
    return torch.sigmoid(x)
def _layernorm(x, axis=-1, eps=1e-5):
    m = x.mean(dim=axis, keepdim=True)
    v = x.var(dim=axis, keepdim=True, unbiased=False)
    return (x - m) / torch.sqrt(v + eps)
def _scatter_add(tgt, idx, src, axis=0):
    return tgt.clone().index_add_(axis, idx, src)
def _segment_sum(src, seg, n):
    out = torch.zeros((n,) + src.shape[1:], dtype=src.dtype)
    return out.index_add_(0, seg, src)
def _pad(x, pw):
    flat = tuple(v for pair in reversed(pw) for v in pair)
    return torch.nn.functional.pad(x, flat)

kernel_name = 'parallel_sum__sliding_local_dilated__geglu_ffn__prompt'

def setup_inputs():

    _w = (lambda a: (lambda t: t.to(torch.bfloat16) if t.is_floating_point() else t)(torch.as_tensor(a)))
    def _A_setup():
        B, S, D = 1, 2048, 448
        return {
            "x": _w((lambda *s: torch.randn(*s, dtype=torch.bfloat16) * 0.05)(B, S, D)),
            "wqkv": _w((lambda *s: torch.randn(*s, dtype=torch.bfloat16) * 0.05)(D, 3 * D)),
            "wo": _w((lambda *s: torch.randn(*s, dtype=torch.bfloat16) * 0.05)(D, D)),
        }
    _A_in = _A_setup()

    def _B_setup():
        B, S, D, F = 1, 2048, 448, 1792
        return {
            "x": _w((lambda *s: torch.randn(*s, dtype=torch.bfloat16) * 0.05)(B, S, D)),
            "w_gate": _w((lambda *s: torch.randn(*s, dtype=torch.bfloat16) * 0.05)(D, F)),
            "w_up": _w((lambda *s: torch.randn(*s, dtype=torch.bfloat16) * 0.05)(D, F)),
            "w_down": _w((lambda *s: torch.randn(*s, dtype=torch.bfloat16) * 0.05)(F, D)),
        }
    _B_in = _B_setup()

    return {
        "A_x": _A_in["x"],
        "A_wqkv": _A_in["wqkv"],
        "A_wo": _A_in["wo"],
        "B_x": _B_in["x"],
        "B_w_gate": _B_in["w_gate"],
        "B_w_up": _B_in["w_up"],
        "B_w_down": _B_in["w_down"],
    }

def reference(A_x, A_wqkv, A_wo, B_x, B_w_gate, B_w_up, B_w_down):
    def _A_ref(x, wqkv, wo):
        B, S, D = x.shape
        H = 16; Dh = D // H
        W, dil = 8, 2
        qkv = (lambda x, *d: x.permute(*d))((x @ wqkv).reshape(B, S, 3, H, Dh), 2, 0, 3, 1, 4)
        q, k, v = qkv[0], qkv[1], qkv[2]
        scale = Dh ** -0.5
        pos = torch.arange(S)
        off = torch.arange(W) * dil
        idx = pos[:, None] - off[None, :]
        mask = idx >= 0
        idx_c = torch.where(mask, idx, 0).reshape(-1)
        kg = k[:, :, idx_c, :].reshape(B, H, S, W, Dh)
        vg = v[:, :, idx_c, :].reshape(B, H, S, W, Dh)
        logits = torch.einsum("bhsd,bhswd->bhsw", q, kg) * scale
        logits = torch.where(mask[None, None, :, :], logits, -1e9)
        attn = _softmax(logits, axis=-1)
        o = torch.einsum("bhsw,bhswd->bhsd", attn, vg)
        return (lambda x, *d: x.permute(*d))(o, 0, 2, 1, 3).reshape(B, S, D) @ wo

    def _B_ref(x, w_gate, w_up, w_down):
        return (_gelu(x @ w_gate) * (x @ w_up)) @ w_down

    x = A_x
    xn = _layernorm(x, axis=-1)
    return x + _A_ref(xn, A_wqkv, A_wo) + _B_ref(xn, B_w_gate, B_w_up, B_w_down)
```

```asm
; @launch grid=(256,1,1) block=(512,1,1) lds=163840
.amdgcn_target "amdgcn-amd-amdhsa--gfx950"
.text
.globl parallel_sum__sliding_local_dilated__geglu_ffn__prompt_kernel
.p2align 8
.type parallel_sum__sliding_local_dilated__geglu_ffn__prompt_kernel,@function
parallel_sum__sliding_local_dilated__geglu_ffn__prompt_kernel:
    s_cmp_ge_u32 s2, 256
    s_cbranch_scc1 k_done
    s_load_dwordx16 s[16:31], s[0:1], 0
    s_load_dwordx4 s[32:35], s[0:1], 64
    v_lshrrev_b32 v2, 6, v0
    v_and_b32 v1, 63, v0
    s_and_b32 s56, s2, 7
    v_readfirstlane_b32 s12, v2
    s_lshr_b32 s57, s2, 3
    s_lshr_b32 s58, s56, 1
    s_and_b32 s59, s56, 1
    s_lshl_b32 s13, s12, 10
    s_lshl_b32 s61, s2, 3
    s_add_u32 s61, s61, s12
    s_mul_i32 s61, s61, 896
    v_lshlrev_b32 v228, 4, v1
    v_mov_b32 v224, 0
    v_mov_b32 v225, 0
    v_mov_b32 v226, 0
    v_mov_b32 v227, 0
    s_getpc_b64 s[52:53]
k_pc:
    s_mov_b32 s54, k_end-k_pc
    s_mov_b32 s55, 0x20000
    s_mul_i32 s60, s57, 1536
    v_lshlrev_b32 v3, 7, v0
    v_cmp_gt_u32 vcc, 12, v0
    v_mov_b32 v4, 2147483648
    s_and_b32 s53, s53, 0xffff
    v_cndmask_b32 v3, v4, v3, vcc
    buffer_load_dword v251, v3, s[52:55], s60 offen
    s_cmp_ge_u32 s57, 21
    s_cbranch_scc1 kA
    s_mul_i32 s60, s57, 37
    s_lshr_b32 s60, s60, 8
    s_mul_i32 s63, s60, 7
    s_sub_u32 s71, s57, s63
    s_mul_i32 s14, s58, 3
    s_add_u32 s14, s14, s60
    s_mul_i32 s15, s59, 7
    s_add_u32 s15, s15, s71
    s_mul_i32 s70, s56, 3
    s_add_u32 s70, s70, s60
    s_mov_b32 s77, s60
    s_lshl_b32 s91, s57, 3
    s_add_u32 s91, s91, s12
    v_lshrrev_b32 v4, 4, v1
    s_lshl_b32 s60, s12, 2
    v_add_u32 v4, s60, v4
    v_and_b32 v5, 3, v4
    v_bfe_u32 v6, v4, 3, 1
    v_lshl_or_b32 v5, v6, 2, v5
    v_lshlrev_b32 v5, 1, v5
    v_and_b32 v6, 15, v1
    v_xor_b32 v5, v5, v6
    v_lshlrev_b32 v5, 4, v5
    v_mul_u32_u24 v2, 3584, v4
    v_add_u32 v2, v2, v5
    s_lshl_b32 s60, s15, 8
    v_add_u32 v2, s60, v2
    v_lshrrev_b32 v6, 3, v1
    v_and_b32 v7, 7, v1
    v_lshrrev_b32 v8, 4, v1
    s_and_b32 s60, s12, 1
    s_lshl_b32 s60, s60, 2
    v_xor_b32 v7, v7, v8
    v_xor_b32 v7, s60, v7
    s_mul_i32 s62, s14, 174
    s_lshl_b32 s60, s12, 3
    s_add_u32 s60, s60, s62
    s_sub_u32 s60, s60, 1
    s_mul_i32 s60, s60, 896
    v_mul_u32_u24 v4, 896, v6
    v_lshl_add_u32 v4, v7, 4, v4
    v_add_u32 v4, s60, v4
    v_add_u32 v5, 56448, v4
    s_mov_b64 s[80:81], -1
    s_mov_b64 s[82:83], -1
    s_cmp_eq_u32 s12, 0
    s_cselect_b32 s80, 0xffffff00, s80
    s_cmp_eq_u32 s12, 4
    s_cselect_b32 s82, 0xffffff00, s82
    s_cmp_lt_u32 s12, 4
    s_cselect_b32 s63, 896, 0
    s_add_u32 s65, s13, 98304
    s_mov_b32 s64, 57344
    s_cmp_ge_u32 s12, 6
    s_cselect_b32 s64, 0x40000000, s64
    s_cselect_b32 s65, 152576, s65
    s_cselect_b32 s66, 0, 22528
    s_mov_b32 s3, -1
    s_waitcnt lgkmcnt(0)
    s_mov_b32 s36, s16
    s_mov_b32 s37, s17
    s_mov_b32 s38, 1835008
    s_mov_b32 s39, 0x20000
    s_mov_b32 s40, s24
    s_mov_b32 s41, s25
    s_mov_b32 s42, 1605632
    s_mov_b32 s43, 0x20000
    s_mov_b32 s44, s26
    s_mov_b32 s45, s27
    s_mov_b32 s46, 1605632
    s_mov_b32 s47, 0x20000
    s_mov_b32 exec_hi, 0x00ffffff
    buffer_load_dwordx4 v[224:227], v228, s[36:39], s61 offen
    s_mov_b32 exec_hi, -1
    s_add_u32 m0, s13, 0
    s_mov_b32 s56, 0
    buffer_load_dwordx4 v2, s[40:43], s56 offen lds
    s_add_u32 m0, s13, 8192
    s_mov_b32 s56, 0
    buffer_load_dwordx4 v2, s[44:47], s56 offen lds
    s_add_u32 m0, s13, 81920
    s_mov_b32 s56, 0
    s_mov_b64 exec, s[80:81]
    buffer_load_dwordx4 v4, s[36:39], s56 offen lds
    s_mov_b64 exec, -1
    s_add_u32 m0, s13, 90112
    s_add_u32 s56, s63, 0
    s_mov_b64 exec, s[82:83]
    buffer_load_dwordx4 v5, s[36:39], s56 offen lds
    s_mov_b64 exec, -1
    s_mul_i32 s56, s66, 0
    s_add_u32 m0, s65, s56
    s_add_u32 s56, s64, 0
    buffer_load_dwordx4 v5, s[36:39], s56 offen lds
    s_mov_b32 s48, s34
    s_mov_b32 s49, s35
    s_mov_b32 s50, 268435456
    s_mov_b32 s51, 0x20000
    s_mov_b32 s96, s32
    s_mov_b32 s97, s33
    s_mov_b32 s98, 256
    s_mov_b32 s99, 0x20000
    s_or_b32 s56, s2, s12
    s_cmp_lg_u32 s56, 0
    s_cbranch_scc1 kk_nn_1
    s_memrealtime s[58:59]
    s_waitcnt lgkmcnt(0)
    s_or_b32 s58, s58, 1
    v_mov_b32 v12, s58
    v_mov_b32 v13, s59
    v_mov_b32 v14, 0
    s_mov_b64 exec, 1
    buffer_store_dwordx2 v[12:13], v14, s[96:99], 0 offen sc0 sc1
    s_mov_b64 exec, -1
kk_nn_1:
    v_and_b32 v16, 15, v1
    v_lshrrev_b32 v17, 4, v1
    v_lshrrev_b32 v18, 1, v16
    v_xor_b32 v19, v17, v18
    v_xor_b32 v20, 4, v19
    v_lshlrev_b32 v18, 7, v16
    v_lshl_add_u32 v6, v19, 4, v18
    v_lshl_add_u32 v7, v20, 4, v18
    s_lshr_b32 s56, s12, 2
    s_mul_i32 s56, s56, 12288
    s_add_u32 s56, s56, 81920
    v_add_u32 v6, s56, v6
    v_add_u32 v7, s56, v7
    v_lshrrev_b32 v18, 2, v16
    v_and_b32 v19, 3, v16
    v_and_b32 v20, 1, v17
    v_lshl_or_b32 v20, v20, 2, v18
    v_lshl_add_u32 v18, v17, 3, v18
    v_lshlrev_b32 v18, 8, v18
    v_lshl_add_u32 v18, v19, 3, v18
    s_and_b32 s56, s12, 3
    s_lshl_b32 s56, s56, 1
    v_xor_b32 v21, s56, v20
    v_xor_b32 v22, 1, v21
    v_lshl_add_u32 v8, v21, 5, v18
    v_lshl_add_u32 v9, v22, 5, v18
    v_add_u32 v10, 0xc000, v8
    v_add_u32 v11, 0xc000, v9
    v_lshrrev_b32 v16, 3, v1
    v_and_b32 v17, 1, v16
    v_lshrrev_b32 v16, 1, v16
    v_mul_u32_u24 v16, 22528, v16
    v_mul_u32_u24 v17, 12288, v17
    v_and_b32 v18, 7, v1
    v_lshlrev_b32 v18, 4, v18
    v_add3_u32 v16, v16, v17, v18
    v_add_u32 v16, 81920, v16
    v_mov_b32 v20, 0x3f803f80
    v_mov_b32 v21, 0x3f803f80
    v_mov_b32 v22, 0x3f803f80
    v_mov_b32 v23, 0x3f803f80
    s_mov_b32 exec_hi, 0xffff
    ds_write_b128 v16, v[20:23]
    s_mov_b32 exec_hi, -1
    s_bitcmp1_b32 s70, 0
    s_cselect_b32 s92, 6, 0
    s_cselect_b32 s93, 3, 1
    s_cselect_b32 s94, 8, 2
    s_cselect_b32 s95, 5, 4
    s_lshr_b32 s70, s70, 1
    s_lshl_b32 s56, s12, 6
    v_add_u32 v249, s56, v1
    v_cmp_lt_u32 vcc, 95, v249
    v_cmp_ne_u32 s[58:59], 0, v249
    s_movk_i32 s56, 96
    v_cmp_ne_u32 s[60:61], s56, v249
    v_subbrev_co_u32 v248, vcc, 1, v249, vcc
    s_and_b64 s[58:59], s[58:59], s[60:61]
    v_cmp_gt_u32 vcc, 176, v249
    v_add_u32 v248, s62, v248
    s_and_b64 s[58:59], s[58:59], vcc
    s_movk_i32 s56, 2048
    v_cmp_gt_u32 s[60:61], s56, v248
    v_lshlrev_b32 v248, 4, v248
    v_add_u32 v248, 10485760, v248
    s_and_b64 s[84:85], s[58:59], s[60:61]
    v_lshlrev_b32 v249, 4, v249
    v_add_u32 v249, 149504, v249
    v_lshlrev_b32 v16, 4, v1
    v_add_u32 v16, 152576, v16
    v_cndmask_b32 v249, v16, v249, vcc
    v_lshrrev_b32 v16, 3, v1
    v_and_b32 v17, 7, v1
    v_lshrrev_b32 v18, 4, v1
    v_lshlrev_b32 v19, 1, v18
    v_xor_b32 v17, v17, v19
    v_mul_u32_u24 v244, 896, v16
    v_lshl_add_u32 v244, v17, 4, v244
    s_lshl_b32 s56, s71, 7
    v_add_u32 v244, s56, v244
    v_mov_b32 v17, 2147483648
    v_cmp_gt_u32 vcc, 4, v16
    s_mul_i32 s78, s12, 200704
    s_mul_i32 s79, s12, 50176
    v_cndmask_b32 v245, v17, v244, vcc
    v_bfe_u32 v16, v1, 2, 2
    v_lshl_add_u32 v16, v18, 2, v16
    v_bfe_u32 v17, v16, 1, 2
    v_lshlrev_b32 v16, 7, v16
    v_and_b32 v18, 3, v1
    v_lshl_add_u32 v16, v18, 3, v16
    v_lshl_add_u32 v246, v17, 5, v16
    s_lshl_b32 s56, s12, 12
    v_add_u32 v246, s56, v246
    s_lshl_b32 s76, s77, 1
    s_add_u32 s76, s76, s71
    s_sub_u32 s56, s76, 7
    s_cmp_ge_u32 s76, 7
    s_cselect_b32 s76, s56, s76
    s_sub_u32 s77, s76, 1
    s_mul_i32 s56, s70, 11
    s_add_u32 s72, s56, s92
    s_mul_i32 s72, s72, 73728
    s_add_u32 s73, s56, s93
    s_mul_i32 s73, s73, 73728
    s_add_u32 s74, s56, s94
    s_mul_i32 s74, s74, 73728
    s_add_u32 s75, s56, s95
    s_mul_i32 s75, s75, 73728
    v_and_b32 v16, 15, v1
    v_min_u32 v247, 13, v16
    v_lshlrev_b32 v247, 3, v247
    s_lshl_b32 s56, s70, 7
    s_add_u32 s56, s56, 10551296
    v_add_u32 v247, s56, v247
    s_mul_i32 s56, s70, 174
    s_mul_i32 s57, s56, 342
    s_lshr_b32 s57, s57, 16
    s_add_u32 s58, s56, 173
    s_min_u32 s58, s58, 2047
    s_mul_i32 s58, s58, 342
    s_lshr_b32 s58, s58, 16
    s_cmp_lg_u32 s58, s57
    s_cselect_b32 s58, 15, 7
    v_min_u32 v16, s58, v16
    s_lshl_b32 s58, s57, 6
    s_add_u32 s58, s58, 10559488
    v_lshl_add_u32 v16, v16, 3, s58
    v_cmp_lt_u32 vcc, 15, v1
    s_lshr_b32 s58, s12, 1
    s_and_b32 s59, s12, 1
    v_cndmask_b32 v247, v247, v16, vcc
    s_lshl_b32 s59, s59, 3
    s_cmp_eq_u32 s58, 1
    s_cselect_b32 s60, s93, s92
    s_cmp_eq_u32 s58, 2
    s_cselect_b32 s60, s94, s60
    s_cmp_eq_u32 s58, 3
    s_cselect_b32 s60, s95, s60
    s_lshl_b32 s60, s60, 4
    s_add_u32 s60, s60, s59
    v_lshrrev_b32 v250, 3, v1
    v_add_u32 v250, s60, v250
    v_cmp_lt_u32 vcc, 95, v250
    v_cmp_ne_u32 s[60:61], 0, v250
    s_movk_i32 s59, 96
    v_cmp_ne_u32 s[86:87], s59, v250
    v_subbrev_co_u32 v250, vcc, 1, v250, vcc
    s_and_b64 s[60:61], s[60:61], s[86:87]
    v_add_u32 v250, s56, v250
    s_cmp_lt_u32 s58, 4
    s_cselect_b64 s[86:87], -1, 0
    s_and_b64 s[60:61], s[60:61], s[86:87]
    v_mul_u32_u24 v250, 896, v250
    v_and_b32 v16, 7, v1
    v_lshl_add_u32 v250, v16, 4, v250
    s_lshl_b32 s56, s71, 7
    v_add_u32 v250, s56, v250
    v_mov_b32 v16, 2147483648
    v_cndmask_b32 v250, v16, v250, s[60:61]
    s_mov_b32 s7, 65536
    s_cmp_ge_u32 s12, 4
    s_cselect_b32 s7, 88064, s7
    s_mov_b32 s8, 32768
    s_cmp_ge_u32 s12, 4
    s_cselect_b32 s8, 104448, s8
    s_mov_b32 s10, 49152
    s_cmp_ge_u32 s12, 4
    s_cselect_b32 s10, 65536, s10
    s_add_u32 m0, s13, 16384
    s_mov_b32 s56, 114688
    buffer_load_dwordx4 v2, s[40:43], s56 offen lds
    s_add_u32 m0, s13, 24576
    s_mov_b32 s56, 114688
    buffer_load_dwordx4 v2, s[44:47], s56 offen lds
    s_mov_b32 s52, s28
    s_mov_b32 s53, s29
    s_mov_b32 s54, 1605632
    s_mov_b32 s55, 0x20000
    s_waitcnt vmcnt(7)
    v_lshlrev_b32 v230, 16, v224
    v_and_b32 v231, 0xffff0000, v224
    v_lshlrev_b32 v232, 16, v225
    v_and_b32 v233, 0xffff0000, v225
    v_lshlrev_b32 v234, 16, v226
    v_and_b32 v235, 0xffff0000, v226
    v_lshlrev_b32 v236, 16, v227
    v_and_b32 v237, 0xffff0000, v227
    v_add_f32 v228, v230, v231
    v_add_f32 v229, v232, v233
    v_add_f32 v224, v234, v235
    v_add_f32 v225, v236, v237
    v_add_f32 v228, v228, v229
    v_add_f32 v224, v224, v225
    v_add_f32 v228, v228, v224
    s_nop 1
    v_add_f32_dpp v228, v228, v228 quad_perm:[1,0,3,2] row_mask:0xf bank_mask:0xf
    s_nop 1
    v_add_f32_dpp v228, v228, v228 quad_perm:[2,3,0,1] row_mask:0xf bank_mask:0xf
    s_nop 1
    v_add_f32_dpp v228, v228, v228 row_half_mirror row_mask:0xf bank_mask:0xf
    s_nop 1
    v_add_f32_dpp v228, v228, v228 row_mirror row_mask:0xf bank_mask:0xf
    v_mov_b32 v238, v228
    s_nop 1
    v_permlane16_swap_b32 v228, v238
    s_nop 1
    v_add_f32 v228, v228, v238
    v_mov_b32 v238, v228
    s_nop 1
    v_permlane32_swap_b32 v228, v238
    s_nop 1
    v_add_f32 v228, v228, v238
    v_mul_f32 v228, 0x3b124925, v228
    v_cmp_gt_u32 vcc, 56, v1
    v_sub_f32 v230, v230, v228
    v_sub_f32 v231, v231, v228
    v_sub_f32 v232, v232, v228
    v_sub_f32 v233, v233, v228
    v_sub_f32 v234, v234, v228
    v_sub_f32 v235, v235, v228
    v_sub_f32 v236, v236, v228
    v_sub_f32 v237, v237, v228
    v_mul_f32 v229, v230, v230
    v_mul_f32 v224, v231, v231
    v_fmac_f32 v229, v232, v232
    v_fmac_f32 v224, v233, v233
    v_fmac_f32 v229, v234, v234
    v_fmac_f32 v224, v235, v235
    v_fmac_f32 v229, v236, v236
    v_fmac_f32 v224, v237, v237
    v_add_f32 v229, v229, v224
    v_cndmask_b32 v229, 0, v229, vcc
    s_nop 1
    v_add_f32_dpp v229, v229, v229 quad_perm:[1,0,3,2] row_mask:0xf bank_mask:0xf
    s_nop 1
    v_add_f32_dpp v229, v229, v229 quad_perm:[2,3,0,1] row_mask:0xf bank_mask:0xf
    s_nop 1
    v_add_f32_dpp v229, v229, v229 row_half_mirror row_mask:0xf bank_mask:0xf
    s_nop 1
    v_add_f32_dpp v229, v229, v229 row_mirror row_mask:0xf bank_mask:0xf
    v_mov_b32 v238, v229
    s_nop 1
    v_permlane16_swap_b32 v229, v238
    s_nop 1
    v_add_f32 v229, v229, v238
    v_mov_b32 v238, v229
    s_nop 1
    v_permlane32_swap_b32 v229, v238
    s_nop 1
    v_add_f32 v229, v229, v238
    v_mul_f32 v229, 0x3b124925, v229
    v_cvt_pk_bf16_f32 v228, v228, v228
    v_lshlrev_b32 v228, 16, v228
    v_cvt_pk_bf16_f32 v229, v229, v229
    v_lshlrev_b32 v229, 16, v229
    v_add_f32 v229, 0x3727c5ac, v229
    v_cvt_pk_bf16_f32 v229, v229, v229
    v_lshlrev_b32 v229, 16, v229
    v_sqrt_f32 v229, v229
    s_nop 0
    v_cvt_pk_bf16_f32 v229, v229, v229
    v_lshlrev_b32 v229, 16, v229
    s_add_u32 m0, s13, 32768
    s_mov_b32 s56, 229376
    buffer_load_dwordx4 v2, s[40:43], s56 offen lds
    s_add_u32 m0, s13, 40960
    s_mov_b32 s56, 229376
    buffer_load_dwordx4 v2, s[44:47], s56 offen lds
    s_add_u32 m0, s13, 104448
    s_mov_b32 s56, 128
    s_mov_b64 exec, s[80:81]
    buffer_load_dwordx4 v4, s[36:39], s56 offen lds
    s_mov_b64 exec, -1
    s_add_u32 m0, s13, 112640
    s_add_u32 s56, s63, 128
    s_mov_b64 exec, s[82:83]
    buffer_load_dwordx4 v5, s[36:39], s56 offen lds
    s_mov_b64 exec, -1
    s_mul_i32 s56, s66, 1
    s_add_u32 m0, s65, s56
    s_add_u32 s56, s64, 128
    buffer_load_dwordx4 v5, s[36:39], s56 offen lds
    s_waitcnt vmcnt(7) lgkmcnt(0)
    s_barrier
    s_cmp_ge_u32 s12, 4
    s_cbranch_scc1 kF_h1
    ds_read_b128 v[112:115], v6 offset:0
    ds_read_b64_tr_b16 v[160:161], v8 offset:0
    ds_read_b64_tr_b16 v[162:163], v8 offset:1024
    ds_read_b64_tr_b16 v[164:165], v9 offset:0
    ds_read_b64_tr_b16 v[166:167], v9 offset:1024
    ds_read_b64_tr_b16 v[168:169], v8 offset:8192
    ds_read_b64_tr_b16 v[170:171], v8 offset:9216
    ds_read_b64_tr_b16 v[172:173], v9 offset:8192
    ds_read_b64_tr_b16 v[174:175], v9 offset:9216
    ds_read_b128 v[116:119], v6 offset:2048
    ds_read_b128 v[120:123], v6 offset:4096
    ds_read_b128 v[124:127], v6 offset:6144
    ds_read_b128 v[128:131], v6 offset:8192
    ds_read_b128 v[132:135], v6 offset:10240
    s_waitcnt vmcnt(5) lgkmcnt(0)
    s_barrier
    s_setprio 3
    v_mfma_f32_16x16x32_bf16 v[16:19], v[160:163], v[112:115], 0
    ds_read_b128 v[136:139], v7 offset:0
    v_mfma_f32_16x16x32_bf16 v[20:23], v[164:167], v[112:115], 0
    ds_read_b64_tr_b16 v[176:177], v8 offset:16384
    v_mfma_f32_16x16x32_bf16 v[24:27], v[168:171], v[112:115], 0
    ds_read_b64_tr_b16 v[178:179], v8 offset:17408
    v_mfma_f32_16x16x32_bf16 v[28:31], v[172:175], v[112:115], 0
    ds_read_b64_tr_b16 v[180:181], v9 offset:16384
    v_mfma_f32_16x16x32_bf16 v[32:35], v[160:163], v[116:119], 0
    ds_read_b64_tr_b16 v[182:183], v9 offset:17408
    s_add_u32 m0, s13, 49152
    s_mov_b32 s56, 344064
    buffer_load_dwordx4 v2, s[40:43], s56 offen lds
    v_mfma_f32_16x16x32_bf16 v[36:39], v[164:167], v[116:119], 0
    ds_read_b64_tr_b16 v[184:185], v8 offset:24576
    s_setprio 2
    v_mfma_f32_16x16x32_bf16 v[40:43], v[168:171], v[116:119], 0
    ds_read_b64_tr_b16 v[186:187], v8 offset:25600
    v_mfma_f32_16x16x32_bf16 v[44:47], v[172:175], v[116:119], 0
    ds_read_b64_tr_b16 v[188:189], v9 offset:24576
    v_mfma_f32_16x16x32_bf16 v[48:51], v[160:163], v[120:123], 0
    ds_read_b64_tr_b16 v[190:191], v9 offset:25600
    v_mfma_f32_16x16x32_bf16 v[52:55], v[164:167], v[120:123], 0
    ds_read_b128 v[140:143], v7 offset:2048
    s_add_u32 m0, s13, 57344
    s_mov_b32 s56, 344064
    buffer_load_dwordx4 v2, s[44:47], s56 offen lds
    v_mfma_f32_16x16x32_bf16 v[56:59], v[168:171], v[120:123], 0
    ds_read_b128 v[144:147], v7 offset:4096
    v_mfma_f32_16x16x32_bf16 v[60:63], v[172:175], v[120:123], 0
    ds_read_b128 v[148:151], v7 offset:6144
    s_setprio 1
    v_mfma_f32_16x16x32_bf16 v[64:67], v[160:163], v[124:127], 0
    ds_read_b128 v[152:155], v7 offset:8192
    v_mfma_f32_16x16x32_bf16 v[68:71], v[164:167], v[124:127], 0
    s_waitcnt lgkmcnt(8)
    ds_read_b128 v[156:159], v7 offset:10240
    v_mfma_f32_16x16x32_bf16 v[72:75], v[168:171], v[124:127], 0
    s_add_u32 m0, s13, 65536
    s_mov_b32 s56, 458752
    buffer_load_dwordx4 v2, s[40:43], s56 offen lds
    v_mfma_f32_16x16x32_bf16 v[76:79], v[172:175], v[124:127], 0
    v_mfma_f32_16x16x32_bf16 v[80:83], v[160:163], v[128:131], 0
    v_mfma_f32_16x16x32_bf16 v[84:87], v[164:167], v[128:131], 0
    s_setprio 0
    v_mfma_f32_16x16x32_bf16 v[88:91], v[168:171], v[128:131], 0
    v_mfma_f32_16x16x32_bf16 v[92:95], v[172:175], v[128:131], 0
    s_add_u32 m0, s13, 73728
    s_mov_b32 s56, 458752
    buffer_load_dwordx4 v2, s[44:47], s56 offen lds
    v_mfma_f32_16x16x32_bf16 v[96:99], v[160:163], v[132:135], 0
    v_mfma_f32_16x16x32_bf16 v[100:103], v[164:167], v[132:135], 0
    v_mfma_f32_16x16x32_bf16 v[104:107], v[168:171], v[132:135], 0
    v_mfma_f32_16x16x32_bf16 v[108:111], v[172:175], v[132:135], 0
    v_mov_b32 v14, 0
    buffer_load_dwordx2 v[12:13], v14, s[96:99], 0 offen sc0 sc1
    s_waitcnt vmcnt(5) lgkmcnt(0)
    s_barrier
    s_setprio 3
    v_mfma_f32_16x16x32_bf16 v[16:19], v[176:179], v[136:139], v[16:19]
    ds_read_b128 v[112:115], v6 offset:22528
    v_mfma_f32_16x16x32_bf16 v[20:23], v[180:183], v[136:139], v[20:23]
    ds_read_b64_tr_b16 v[160:161], v8 offset:32768
    v_mfma_f32_16x16x32_bf16 v[24:27], v[184:187], v[136:139], v[24:27]
    ds_read_b64_tr_b16 v[162:163], v8 offset:33792
    v_mfma_f32_16x16x32_bf16 v[28:31], v[188:191], v[136:139], v[28:31]
    ds_read_b64_tr_b16 v[164:165], v9 offset:32768
    v_mfma_f32_16x16x32_bf16 v[32:35], v[176:179], v[140:143], v[32:35]
    ds_read_b64_tr_b16 v[166:167], v9 offset:33792
    v_mfma_f32_16x16x32_bf16 v[36:39], v[180:183], v[140:143], v[36:39]
    ds_read_b64_tr_b16 v[168:169], v8 offset:40960
    s_add_u32 m0, s13, 126976
    s_mov_b32 s56, 256
    s_mov_b64 exec, s[80:81]
    buffer_load_dwordx4 v4, s[36:39], s56 offen lds
    s_mov_b64 exec, -1
    s_setprio 2
    v_mfma_f32_16x16x32_bf16 v[40:43], v[184:187], v[140:143], v[40:43]
    ds_read_b64_tr_b16 v[170:171], v8 offset:41984
    v_mfma_f32_16x16x32_bf16 v[44:47], v[188:191], v[140:143], v[44:47]
    ds_read_b64_tr_b16 v[172:173], v9 offset:40960
    v_mfma_f32_16x16x32_bf16 v[48:51], v[176:179], v[144:147], v[48:51]
    ds_read_b64_tr_b16 v[174:175], v9 offset:41984
    v_mfma_f32_16x16x32_bf16 v[52:55], v[180:183], v[144:147], v[52:55]
    ds_read_b128 v[116:119], v6 offset:24576
    v_mfma_f32_16x16x32_bf16 v[56:59], v[184:187], v[144:147], v[56:59]
    ds_read_b128 v[120:123], v6 offset:26624
    v_mfma_f32_16x16x32_bf16 v[60:63], v[188:191], v[144:147], v[60:63]
    ds_read_b128 v[124:127], v6 offset:28672
    s_add_u32 m0, s13, 135168
    s_add_u32 s56, s63, 256
    s_mov_b64 exec, s[82:83]
    buffer_load_dwordx4 v5, s[36:39], s56 offen lds
    s_mov_b64 exec, -1
    s_setprio 1
    v_mfma_f32_16x16x32_bf16 v[64:67], v[176:179], v[148:151], v[64:67]
    ds_read_b128 v[128:131], v6 offset:30720
    v_mfma_f32_16x16x32_bf16 v[68:71], v[180:183], v[148:151], v[68:71]
    s_waitcnt lgkmcnt(8)
    ds_read_b128 v[132:135], v6 offset:32768
    v_mfma_f32_16x16x32_bf16 v[72:75], v[184:187], v[148:151], v[72:75]
    v_mfma_f32_16x16x32_bf16 v[76:79], v[188:191], v[148:151], v[76:79]
    v_mfma_f32_16x16x32_bf16 v[80:83], v[176:179], v[152:155], v[80:83]
    v_mfma_f32_16x16x32_bf16 v[84:87], v[180:183], v[152:155], v[84:87]
    s_mul_i32 s56, s66, 2
    s_add_u32 m0, s65, s56
    s_add_u32 s56, s64, 256
    buffer_load_dwordx4 v5, s[36:39], s56 offen lds
    s_setprio 0
    v_mfma_f32_16x16x32_bf16 v[88:91], v[184:187], v[152:155], v[88:91]
    v_mfma_f32_16x16x32_bf16 v[92:95], v[188:191], v[152:155], v[92:95]
    v_mfma_f32_16x16x32_bf16 v[96:99], v[176:179], v[156:159], v[96:99]
    v_mfma_f32_16x16x32_bf16 v[100:103], v[180:183], v[156:159], v[100:103]
    v_mfma_f32_16x16x32_bf16 v[104:107], v[184:187], v[156:159], v[104:107]
    v_mfma_f32_16x16x32_bf16 v[108:111], v[188:191], v[156:159], v[108:111]
    s_add_u32 m0, s13, 0
    s_mov_b32 s56, 573440
    buffer_load_dwordx4 v2, s[40:43], s56 offen lds
    s_waitcnt vmcnt(7) lgkmcnt(0)
    s_barrier
    s_setprio 3
    v_mfma_f32_16x16x32_bf16 v[16:19], v[160:163], v[112:115], v[16:19]
    ds_read_b128 v[136:139], v7 offset:22528
    v_mfma_f32_16x16x32_bf16 v[20:23], v[164:167], v[112:115], v[20:23]
    ds_read_b64_tr_b16 v[176:177], v10 offset:0
    v_mfma_f32_16x16x32_bf16 v[24:27], v[168:171], v[112:115], v[24:27]
    ds_read_b64_tr_b16 v[178:179], v10 offset:1024
    v_mfma_f32_16x16x32_bf16 v[28:31], v[172:175], v[112:115], v[28:31]
    ds_read_b64_tr_b16 v[180:181], v11 offset:0
    v_mfma_f32_16x16x32_bf16 v[32:35], v[160:163], v[116:119], v[32:35]
    ds_read_b64_tr_b16 v[182:183], v11 offset:1024
    v_mfma_f32_16x16x32_bf16 v[36:39], v[164:167], v[116:119], v[36:39]
    ds_read_b64_tr_b16 v[184:185], v10 offset:8192
    s_add_u32 m0, s13, 8192
    s_mov_b32 s56, 573440
    buffer_load_dwordx4 v2, s[44:47], s56 offen lds
    s_setprio 2
    v_mfma_f32_16x16x32_bf16 v[40:43], v[168:171], v[116:119], v[40:43]
    ds_read_b64_tr_b16 v[186:187], v10 offset:9216
    v_mfma_f32_16x16x32_bf16 v[44:47], v[172:175], v[116:119], v[44:47]
    ds_read_b64_tr_b16 v[188:189], v11 offset:8192
    v_mfma_f32_16x16x32_bf16 v[48:51], v[160:163], v[120:123], v[48:51]
    ds_read_b64_tr_b16 v[190:191], v11 offset:9216
    v_mfma_f32_16x16x32_bf16 v[52:55], v[164:167], v[120:123], v[52:55]
    ds_read_b128 v[140:143], v7 offset:24576
    v_mfma_f32_16x16x32_bf16 v[56:59], v[168:171], v[120:123], v[56:59]
    ds_read_b128 v[144:147], v7 offset:26624
    v_mfma_f32_16x16x32_bf16 v[60:63], v[172:175], v[120:123], v[60:63]
    ds_read_b128 v[148:151], v7 offset:28672
    s_add_u32 m0, s13, 16384
    s_mov_b32 s56, 688128
    buffer_load_dwordx4 v2, s[40:43], s56 offen lds
    s_setprio 1
    v_mfma_f32_16x16x32_bf16 v[64:67], v[160:163], v[124:127], v[64:67]
    ds_read_b128 v[152:155], v7 offset:30720
    v_mfma_f32_16x16x32_bf16 v[68:71], v[164:167], v[124:127], v[68:71]
    s_waitcnt lgkmcnt(8)
    ds_read_b128 v[156:159], v7 offset:32768
    v_mfma_f32_16x16x32_bf16 v[72:75], v[168:171], v[124:127], v[72:75]
    v_mfma_f32_16x16x32_bf16 v[76:79], v[172:175], v[124:127], v[76:79]
    v_mfma_f32_16x16x32_bf16 v[80:83], v[160:163], v[128:131], v[80:83]
    v_mfma_f32_16x16x32_bf16 v[84:87], v[164:167], v[128:131], v[84:87]
    s_add_u32 m0, s13, 24576
    s_mov_b32 s56, 688128
    buffer_load_dwordx4 v2, s[44:47], s56 offen lds
    s_setprio 0
    v_mfma_f32_16x16x32_bf16 v[88:91], v[168:171], v[128:131], v[88:91]
    v_mfma_f32_16x16x32_bf16 v[92:95], v[172:175], v[128:131], v[92:95]
    v_mfma_f32_16x16x32_bf16 v[96:99], v[160:163], v[132:135], v[96:99]
    v_mfma_f32_16x16x32_bf16 v[100:103], v[164:167], v[132:135], v[100:103]
    v_mfma_f32_16x16x32_bf16 v[104:107], v[168:171], v[132:135], v[104:107]
    v_mfma_f32_16x16x32_bf16 v[108:111], v[172:175], v[132:135], v[108:111]
    s_add_u32 m0, s13, 81920
    s_mov_b32 s56, 384
    s_mov_b64 exec, s[80:81]
    buffer_load_dwordx4 v4, s[36:39], s56 offen lds
    s_mov_b64 exec, -1
    s_waitcnt vmcnt(5) lgkmcnt(0)
    s_barrier
    s_setprio 3
    v_mfma_f32_16x16x32_bf16 v[16:19], v[176:179], v[136:139], v[16:19]
    ds_read_b128 v[112:115], v6 offset:45056
    v_mfma_f32_16x16x32_bf16 v[20:23], v[180:183], v[136:139], v[20:23]
    ds_read_b64_tr_b16 v[160:161], v10 offset:16384
    v_mfma_f32_16x16x32_bf16 v[24:27], v[184:187], v[136:139], v[24:27]
    ds_read_b64_tr_b16 v[162:163], v10 offset:17408
    v_mfma_f32_16x16x32_bf16 v[28:31], v[188:191], v[136:139], v[28:31]
    ds_read_b64_tr_b16 v[164:165], v11 offset:16384
    v_mfma_f32_16x16x32_bf16 v[32:35], v[176:179], v[140:143], v[32:35]
    ds_read_b64_tr_b16 v[166:167], v11 offset:17408
    v_readfirstlane_b32 s68, v12
    v_readfirstlane_b32 s69, v13
    s_cmp_lg_u32 s68, 0
    s_cbranch_scc1 kk_nok_2
    s_mov_b32 s57, 0
kk_nsp_3:
    s_sleep 2
    buffer_load_dwordx2 v[12:13], v14, s[96:99], 0 offen sc0 sc1
    s_add_u32 s57, s57, 1
    s_waitcnt vmcnt(0)
    v_readfirstlane_b32 s68, v12
    v_readfirstlane_b32 s69, v13
    s_cmp_lg_u32 s68, 0
    s_cbranch_scc1 kk_nok_2
    s_cmp_lt_u32 s57, 32768
    s_cbranch_scc1 kk_nsp_3
kk_nok_2:
    s_lshl_b32 s56, s2, 3
    s_add_u32 s56, s56, s12
    s_lshl_b32 s56, s56, 4
    s_add_u32 s56, s56, 10485760
    v_mov_b32 v230, s68
    v_mov_b32 v231, s69
    s_mov_b64 exec, 1
    buffer_store_dwordx4 v[228:231], v14, s[48:51], s56 offen sc0 sc1
    s_mov_b64 exec, -1
    v_mfma_f32_16x16x32_bf16 v[36:39], v[180:183], v[140:143], v[36:39]
    ds_read_b64_tr_b16 v[168:169], v10 offset:24576
    s_setprio 2
    v_mfma_f32_16x16x32_bf16 v[40:43], v[184:187], v[140:143], v[40:43]
    ds_read_b64_tr_b16 v[170:171], v10 offset:25600
    v_mfma_f32_16x16x32_bf16 v[44:47], v[188:191], v[140:143], v[44:47]
    ds_read_b64_tr_b16 v[172:173], v11 offset:24576
    v_mfma_f32_16x16x32_bf16 v[48:51], v[176:179], v[144:147], v[48:51]
    ds_read_b64_tr_b16 v[174:175], v11 offset:25600
    v_mfma_f32_16x16x32_bf16 v[52:55], v[180:183], v[144:147], v[52:55]
    ds_read_b128 v[116:119], v6 offset:47104
    s_add_u32 m0, s13, 90112
    s_add_u32 s56, s63, 384
    s_mov_b64 exec, s[82:83]
    buffer_load_dwordx4 v5, s[36:39], s56 offen lds
    s_mov_b64 exec, -1
    v_mfma_f32_16x16x32_bf16 v[56:59], v[184:187], v[144:147], v[56:59]
    ds_read_b128 v[120:123], v6 offset:49152
    v_mfma_f32_16x16x32_bf16 v[60:63], v[188:191], v[144:147], v[60:63]
    ds_read_b128 v[124:127], v6 offset:51200
    s_setprio 1
    v_mfma_f32_16x16x32_bf16 v[64:67], v[176:179], v[148:151], v[64:67]
    ds_read_b128 v[128:131], v6 offset:53248
    v_mfma_f32_16x16x32_bf16 v[68:71], v[180:183], v[148:151], v[68:71]
    s_waitcnt lgkmcnt(8)
    ds_read_b128 v[132:135], v6 offset:55296
    v_mfma_f32_16x16x32_bf16 v[72:75], v[184:187], v[148:151], v[72:75]
    s_mul_i32 s56, s66, 0
    s_add_u32 m0, s65, s56
    s_add_u32 s56, s64, 384
    buffer_load_dwordx4 v5, s[36:39], s56 offen lds
    v_mfma_f32_16x16x32_bf16 v[76:79], v[188:191], v[148:151], v[76:79]
    v_mfma_f32_16x16x32_bf16 v[80:83], v[176:179], v[152:155], v[80:83]
    v_mfma_f32_16x16x32_bf16 v[84:87], v[180:183], v[152:155], v[84:87]
    s_setprio 0
    v_mfma_f32_16x16x32_bf16 v[88:91], v[184:187], v[152:155], v[88:91]
    v_mfma_f32_16x16x32_bf16 v[92:95], v[188:191], v[152:155], v[92:95]
    s_add_u32 m0, s13, 32768
    s_mov_b32 s56, 802816
    buffer_load_dwordx4 v2, s[40:43], s56 offen lds
    v_mfma_f32_16x16x32_bf16 v[96:99], v[176:179], v[156:159], v[96:99]
    v_mfma_f32_16x16x32_bf16 v[100:103], v[180:183], v[156:159], v[100:103]
    v_mfma_f32_16x16x32_bf16 v[104:107], v[184:187], v[156:159], v[104:107]
    v_mfma_f32_16x16x32_bf16 v[108:111], v[188:191], v[156:159], v[108:111]
    s_add_u32 m0, s13, 40960
    s_mov_b32 s56, 802816
    buffer_load_dwordx4 v2, s[44:47], s56 offen lds
    s_waitcnt vmcnt(8) lgkmcnt(0)
    s_barrier
    s_setprio 3
    v_mfma_f32_16x16x32_bf16 v[16:19], v[160:163], v[112:115], v[16:19]
    ds_read_b128 v[136:139], v7 offset:45056
    v_mfma_f32_16x16x32_bf16 v[20:23], v[164:167], v[112:115], v[20:23]
    ds_read_b64_tr_b16 v[176:177], v8 offset:0
    v_mfma_f32_16x16x32_bf16 v[24:27], v[168:171], v[112:115], v[24:27]
    ds_read_b64_tr_b16 v[178:179], v8 offset:1024
    v_mfma_f32_16x16x32_bf16 v[28:31], v[172:175], v[112:115], v[28:31]
    ds_read_b64_tr_b16 v[180:181], v9 offset:0
    v_mfma_f32_16x16x32_bf16 v[32:35], v[160:163], v[116:119], v[32:35]
    ds_read_b64_tr_b16 v[182:183], v9 offset:1024
    v_mfma_f32_16x16x32_bf16 v[36:39], v[164:167], v[116:119], v[36:39]
    ds_read_b64_tr_b16 v[184:185], v8 offset:8192
    s_add_u32 m0, s13, 49152
    s_mov_b32 s56, 917504
    buffer_load_dwordx4 v2, s[40:43], s56 offen lds
    s_setprio 2
    v_mfma_f32_16x16x32_bf16 v[40:43], v[168:171], v[116:119], v[40:43]
    ds_read_b64_tr_b16 v[186:187], v8 offset:9216
    v_mfma_f32_16x16x32_bf16 v[44:47], v[172:175], v[116:119], v[44:47]
    ds_read_b64_tr_b16 v[188:189], v9 offset:8192
    v_mfma_f32_16x16x32_bf16 v[48:51], v[160:163], v[120:123], v[48:51]
    ds_read_b64_tr_b16 v[190:191], v9 offset:9216
    v_mfma_f32_16x16x32_bf16 v[52:55], v[164:167], v[120:123], v[52:55]
    ds_read_b128 v[140:143], v7 offset:47104
    v_mfma_f32_16x16x32_bf16 v[56:59], v[168:171], v[120:123], v[56:59]
    ds_read_b128 v[144:147], v7 offset:49152
    v_mfma_f32_16x16x32_bf16 v[60:63], v[172:175], v[120:123], v[60:63]
    ds_read_b128 v[148:151], v7 offset:51200
    s_add_u32 m0, s13, 57344
    s_mov_b32 s56, 917504
    buffer_load_dwordx4 v2, s[44:47], s56 offen lds
    s_setprio 1
    v_mfma_f32_16x16x32_bf16 v[64:67], v[160:163], v[124:127], v[64:67]
    ds_read_b128 v[152:155], v7 offset:53248
    v_mfma_f32_16x16x32_bf16 v[68:71], v[164:167], v[124:127], v[68:71]
    s_waitcnt lgkmcnt(8)
    ds_read_b128 v[156:159], v7 offset:55296
    v_mfma_f32_16x16x32_bf16 v[72:75], v[168:171], v[124:127], v[72:75]
    v_mfma_f32_16x16x32_bf16 v[76:79], v[172:175], v[124:127], v[76:79]
    v_mfma_f32_16x16x32_bf16 v[80:83], v[160:163], v[128:131], v[80:83]
    v_mfma_f32_16x16x32_bf16 v[84:87], v[164:167], v[128:131], v[84:87]
    s_add_u32 m0, s13, 104448
    s_mov_b32 s56, 512
    s_mov_b64 exec, s[80:81]
    buffer_load_dwordx4 v4, s[36:39], s56 offen lds
    s_mov_b64 exec, -1
    s_setprio 0
    v_mfma_f32_16x16x32_bf16 v[88:91], v[168:171], v[128:131], v[88:91]
    v_mfma_f32_16x16x32_bf16 v[92:95], v[172:175], v[128:131], v[92:95]
    v_mfma_f32_16x16x32_bf16 v[96:99], v[160:163], v[132:135], v[96:99]
    v_mfma_f32_16x16x32_bf16 v[100:103], v[164:167], v[132:135], v[100:103]
    v_mfma_f32_16x16x32_bf16 v[104:107], v[168:171], v[132:135], v[104:107]
    v_mfma_f32_16x16x32_bf16 v[108:111], v[172:175], v[132:135], v[108:111]
    s_add_u32 m0, s13, 112640
    s_add_u32 s56, s63, 512
    s_mov_b64 exec, s[82:83]
    buffer_load_dwordx4 v5, s[36:39], s56 offen lds
    s_mov_b64 exec, -1
    s_waitcnt vmcnt(6) lgkmcnt(0)
    s_barrier
    s_setprio 3
    v_mfma_f32_16x16x32_bf16 v[16:19], v[176:179], v[136:139], v[16:19]
    ds_read_b128 v[112:115], v6 offset:0
    v_mfma_f32_16x16x32_bf16 v[20:23], v[180:183], v[136:139], v[20:23]
    ds_read_b64_tr_b16 v[160:161], v8 offset:16384
    v_mfma_f32_16x16x32_bf16 v[24:27], v[184:187], v[136:139], v[24:27]
    ds_read_b64_tr_b16 v[162:163], v8 offset:17408
    v_mfma_f32_16x16x32_bf16 v[28:31], v[188:191], v[136:139], v[28:31]
    ds_read_b64_tr_b16 v[164:165], v9 offset:16384
    v_mfma_f32_16x16x32_bf16 v[32:35], v[176:179], v[140:143], v[32:35]
    ds_read_b64_tr_b16 v[166:167], v9 offset:17408
    v_mfma_f32_16x16x32_bf16 v[36:39], v[180:183], v[140:143], v[36:39]
    ds_read_b64_tr_b16 v[168:169], v8 offset:24576
    s_mul_i32 s56, s66, 1
    s_add_u32 m0, s65, s56
    s_add_u32 s56, s64, 512
    buffer_load_dwordx4 v5, s[36:39], s56 offen lds
    s_setprio 2
    v_mfma_f32_16x16x32_bf16 v[40:43], v[184:187], v[140:143], v[40:43]
    ds_read_b64_tr_b16 v[170:171], v8 offset:25600
    v_mfma_f32_16x16x32_bf16 v[44:47], v[188:191], v[140:143], v[44:47]
    ds_read_b64_tr_b16 v[172:173], v9 offset:24576
    v_mfma_f32_16x16x32_bf16 v[48:51], v[176:179], v[144:147], v[48:51]
    ds_read_b64_tr_b16 v[174:175], v9 offset:25600
    v_mfma_f32_16x16x32_bf16 v[52:55], v[180:183], v[144:147], v[52:55]
    ds_read_b128 v[116:119], v6 offset:2048
    v_mfma_f32_16x16x32_bf16 v[56:59], v[184:187], v[144:147], v[56:59]
    ds_read_b128 v[120:123], v6 offset:4096
    v_mfma_f32_16x16x32_bf16 v[60:63], v[188:191], v[144:147], v[60:63]
    ds_read_b128 v[124:127], v6 offset:6144
    s_add_u32 m0, s13, 65536
    s_mov_b32 s56, 1032192
    buffer_load_dwordx4 v2, s[40:43], s56 offen lds
    s_setprio 1
    v_mfma_f32_16x16x32_bf16 v[64:67], v[176:179], v[148:151], v[64:67]
    ds_read_b128 v[128:131], v6 offset:8192
    v_mfma_f32_16x16x32_bf16 v[68:71], v[180:183], v[148:151], v[68:71]
    s_waitcnt lgkmcnt(8)
    ds_read_b128 v[132:135], v6 offset:10240
    v_mfma_f32_16x16x32_bf16 v[72:75], v[184:187], v[148:151], v[72:75]
    v_mfma_f32_16x16x32_bf16 v[76:79], v[188:191], v[148:151], v[76:79]
    v_mfma_f32_16x16x32_bf16 v[80:83], v[176:179], v[152:155], v[80:83]
    v_mfma_f32_16x16x32_bf16 v[84:87], v[180:183], v[152:155], v[84:87]
    s_add_u32 m0, s13, 73728
    s_mov_b32 s56, 1032192
    buffer_load_dwordx4 v2, s[44:47], s56 offen lds
    s_setprio 0
    v_mfma_f32_16x16x32_bf16 v[88:91], v[184:187], v[152:155], v[88:91]
    v_mfma_f32_16x16x32_bf16 v[92:95], v[188:191], v[152:155], v[92:95]
    v_mfma_f32_16x16x32_bf16 v[96:99], v[176:179], v[156:159], v[96:99]
    v_mfma_f32_16x16x32_bf16 v[100:103], v[180:183], v[156:159], v[100:103]
    v_mfma_f32_16x16x32_bf16 v[104:107], v[184:187], v[156:159], v[104:107]
    v_mfma_f32_16x16x32_bf16 v[108:111], v[188:191], v[156:159], v[108:111]
    s_add_u32 m0, s13, 0
    s_mov_b32 s56, 1146880
    buffer_load_dwordx4 v2, s[40:43], s56 offen lds
    s_waitcnt vmcnt(8) lgkmcnt(0)
    s_barrier
    s_setprio 3
    v_mfma_f32_16x16x32_bf16 v[16:19], v[160:163], v[112:115], v[16:19]
    ds_read_b128 v[136:139], v7 offset:0
    v_mfma_f32_16x16x32_bf16 v[20:23], v[164:167], v[112:115], v[20:23]
    ds_read_b64_tr_b16 v[176:177], v8 offset:32768
    v_mfma_f32_16x16x32_bf16 v[24:27], v[168:171], v[112:115], v[24:27]
    ds_read_b64_tr_b16 v[178:179], v8 offset:33792
    v_mfma_f32_16x16x32_bf16 v[28:31], v[172:175], v[112:115], v[28:31]
    ds_read_b64_tr_b16 v[180:181], v9 offset:32768
    v_mfma_f32_16x16x32_bf16 v[32:35], v[160:163], v[116:119], v[32:35]
    ds_read_b64_tr_b16 v[182:183], v9 offset:33792
    v_mfma_f32_16x16x32_bf16 v[36:39], v[164:167], v[116:119], v[36:39]
    ds_read_b64_tr_b16 v[184:185], v8 offset:40960
    s_add_u32 m0, s13, 8192
    s_mov_b32 s56, 1146880
    buffer_load_dwordx4 v2, s[44:47], s56 offen lds
    s_setprio 2
    v_mfma_f32_16x16x32_bf16 v[40:43], v[168:171], v[116:119], v[40:43]
    ds_read_b64_tr_b16 v[186:187], v8 offset:41984
    v_mfma_f32_16x16x32_bf16 v[44:47], v[172:175], v[116:119], v[44:47]
    ds_read_b64_tr_b16 v[188:189], v9 offset:40960
    v_mfma_f32_16x16x32_bf16 v[48:51], v[160:163], v[120:123], v[48:51]
    ds_read_b64_tr_b16 v[190:191], v9 offset:41984
    v_mfma_f32_16x16x32_bf16 v[52:55], v[164:167], v[120:123], v[52:55]
    ds_read_b128 v[140:143], v7 offset:2048
    v_mfma_f32_16x16x32_bf16 v[56:59], v[168:171], v[120:123], v[56:59]
    ds_read_b128 v[144:147], v7 offset:4096
    v_mfma_f32_16x16x32_bf16 v[60:63], v[172:175], v[120:123], v[60:63]
    ds_read_b128 v[148:151], v7 offset:6144
    s_add_u32 m0, s13, 126976
    s_mov_b32 s56, 640
    s_mov_b64 exec, s[80:81]
    buffer_load_dwordx4 v4, s[36:39], s56 offen lds
    s_mov_b64 exec, -1
    s_setprio 1
    v_mfma_f32_16x16x32_bf16 v[64:67], v[160:163], v[124:127], v[64:67]
    ds_read_b128 v[152:155], v7 offset:8192
    v_mfma_f32_16x16x32_bf16 v[68:71], v[164:167], v[124:127], v[68:71]
    s_waitcnt lgkmcnt(8)
    ds_read_b128 v[156:159], v7 offset:10240
    v_mfma_f32_16x16x32_bf16 v[72:75], v[168:171], v[124:127], v[72:75]
    v_mfma_f32_16x16x32_bf16 v[76:79], v[172:175], v[124:127], v[76:79]
    v_mfma_f32_16x16x32_bf16 v[80:83], v[160:163], v[128:131], v[80:83]
    v_mfma_f32_16x16x32_bf16 v[84:87], v[164:167], v[128:131], v[84:87]
    s_add_u32 m0, s13, 135168
    s_add_u32 s56, s63, 640
    s_mov_b64 exec, s[82:83]
    buffer_load_dwordx4 v5, s[36:39], s56 offen lds
    s_mov_b64 exec, -1
    s_setprio 0
    v_mfma_f32_16x16x32_bf16 v[88:91], v[168:171], v[128:131], v[88:91]
    v_mfma_f32_16x16x32_bf16 v[92:95], v[172:175], v[128:131], v[92:95]
    v_mfma_f32_16x16x32_bf16 v[96:99], v[160:163], v[132:135], v[96:99]
    v_mfma_f32_16x16x32_bf16 v[100:103], v[164:167], v[132:135], v[100:103]
    v_mfma_f32_16x16x32_bf16 v[104:107], v[168:171], v[132:135], v[104:107]
    v_mfma_f32_16x16x32_bf16 v[108:111], v[172:175], v[132:135], v[108:111]
    s_mul_i32 s56, s66, 2
    s_add_u32 m0, s65, s56
    s_add_u32 s56, s64, 640
    buffer_load_dwordx4 v5, s[36:39], s56 offen lds
    s_waitcnt vmcnt(7) lgkmcnt(0)
    s_barrier
    s_setprio 3
    v_mfma_f32_16x16x32_bf16 v[16:19], v[176:179], v[136:139], v[16:19]
    ds_read_b128 v[112:115], v6 offset:22528
    v_mfma_f32_16x16x32_bf16 v[20:23], v[180:183], v[136:139], v[20:23]
    ds_read_b64_tr_b16 v[160:161], v10 offset:0
    v_mfma_f32_16x16x32_bf16 v[24:27], v[184:187], v[136:139], v[24:27]
    ds_read_b64_tr_b16 v[162:163], v10 offset:1024
    v_mfma_f32_16x16x32_bf16 v[28:31], v[188:191], v[136:139], v[28:31]
    ds_read_b64_tr_b16 v[164:165], v11 offset:0
    v_mfma_f32_16x16x32_bf16 v[32:35], v[176:179], v[140:143], v[32:35]
    ds_read_b64_tr_b16 v[166:167], v11 offset:1024
    v_mfma_f32_16x16x32_bf16 v[36:39], v[180:183], v[140:143], v[36:39]
    ds_read_b64_tr_b16 v[168:169], v10 offset:8192
    s_add_u32 m0, s13, 16384
    s_mov_b32 s56, 1261568
    buffer_load_dwordx4 v2, s[40:43], s56 offen lds
    s_setprio 2
    v_mfma_f32_16x16x32_bf16 v[40:43], v[184:187], v[140:143], v[40:43]
    ds_read_b64_tr_b16 v[170:171], v10 offset:9216
    v_mfma_f32_16x16x32_bf16 v[44:47], v[188:191], v[140:143], v[44:47]
    ds_read_b64_tr_b16 v[172:173], v11 offset:8192
    v_mfma_f32_16x16x32_bf16 v[48:51], v[176:179], v[144:147], v[48:51]
    ds_read_b64_tr_b16 v[174:175], v11 offset:9216
    v_mfma_f32_16x16x32_bf16 v[52:55], v[180:183], v[144:147], v[52:55]
    ds_read_b128 v[116:119], v6 offset:24576
    v_mfma_f32_16x16x32_bf16 v[56:59], v[184:187], v[144:147], v[56:59]
    ds_read_b128 v[120:123], v6 offset:26624
    v_mfma_f32_16x16x32_bf16 v[60:63], v[188:191], v[144:147], v[60:63]
    ds_read_b128 v[124:127], v6 offset:28672
    s_add_u32 m0, s13, 24576
    s_mov_b32 s56, 1261568
    buffer_load_dwordx4 v2, s[44:47], s56 offen lds
    s_setprio 1
    v_mfma_f32_16x16x32_bf16 v[64:67], v[176:179], v[148:151], v[64:67]
    ds_read_b128 v[128:131], v6 offset:30720
    v_mfma_f32_16x16x32_bf16 v[68:71], v[180:183], v[148:151], v[68:71]
    s_waitcnt lgkmcnt(8)
    ds_read_b128 v[132:135], v6 offset:32768
    v_mfma_f32_16x16x32_bf16 v[72:75], v[184:187], v[148:151], v[72:75]
    v_mfma_f32_16x16x32_bf16 v[76:79], v[188:191], v[148:151], v[76:79]
    v_mfma_f32_16x16x32_bf16 v[80:83], v[176:179], v[152:155], v[80:83]
    v_mfma_f32_16x16x32_bf16 v[84:87], v[180:183], v[152:155], v[84:87]
    s_add_u32 m0, s13, 32768
    s_mov_b32 s56, 1376256
    buffer_load_dwordx4 v2, s[40:43], s56 offen lds
    s_setprio 0
    v_mfma_f32_16x16x32_bf16 v[88:91], v[184:187], v[152:155], v[88:91]
    v_mfma_f32_16x16x32_bf16 v[92:95], v[188:191], v[152:155], v[92:95]
    v_mfma_f32_16x16x32_bf16 v[96:99], v[176:179], v[156:159], v[96:99]
    v_mfma_f32_16x16x32_bf16 v[100:103], v[180:183], v[156:159], v[100:103]
    v_mfma_f32_16x16x32_bf16 v[104:107], v[184:187], v[156:159], v[104:107]
    v_mfma_f32_16x16x32_bf16 v[108:111], v[188:191], v[156:159], v[108:111]
    s_add_u32 m0, s13, 40960
    s_mov_b32 s56, 1376256
    buffer_load_dwordx4 v2, s[44:47], s56 offen lds
    s_waitcnt vmcnt(9) lgkmcnt(0)
    s_barrier
    s_setprio 3
    v_mfma_f32_16x16x32_bf16 v[16:19], v[160:163], v[112:115], v[16:19]
    ds_read_b128 v[136:139], v7 offset:22528
    v_mfma_f32_16x16x32_bf16 v[20:23], v[164:167], v[112:115], v[20:23]
    ds_read_b64_tr_b16 v[176:177], v10 offset:16384
    v_mfma_f32_16x16x32_bf16 v[24:27], v[168:171], v[112:115], v[24:27]
    ds_read_b64_tr_b16 v[178:179], v10 offset:17408
    v_mfma_f32_16x16x32_bf16 v[28:31], v[172:175], v[112:115], v[28:31]
    ds_read_b64_tr_b16 v[180:181], v11 offset:16384
    v_mfma_f32_16x16x32_bf16 v[32:35], v[160:163], v[116:119], v[32:35]
    ds_read_b64_tr_b16 v[182:183], v11 offset:17408
    v_mfma_f32_16x16x32_bf16 v[36:39], v[164:167], v[116:119], v[36:39]
    ds_read_b64_tr_b16 v[184:185], v10 offset:24576
    s_add_u32 m0, s13, 81920
    s_mov_b32 s56, 768
    s_mov_b64 exec, s[80:81]
    buffer_load_dwordx4 v4, s[36:39], s56 offen lds
    s_mov_b64 exec, -1
    s_setprio 2
    v_mfma_f32_16x16x32_bf16 v[40:43], v[168:171], v[116:119], v[40:43]
    ds_read_b64_tr_b16 v[186:187], v10 offset:25600
    v_mfma_f32_16x16x32_bf16 v[44:47], v[172:175], v[116:119], v[44:47]
    ds_read_b64_tr_b16 v[188:189], v11 offset:24576
    v_mfma_f32_16x16x32_bf16 v[48:51], v[160:163], v[120:123], v[48:51]
    ds_read_b64_tr_b16 v[190:191], v11 offset:25600
    v_mfma_f32_16x16x32_bf16 v[52:55], v[164:167], v[120:123], v[52:55]
    ds_read_b128 v[140:143], v7 offset:24576
    v_mfma_f32_16x16x32_bf16 v[56:59], v[168:171], v[120:123], v[56:59]
    ds_read_b128 v[144:147], v7 offset:26624
    v_mfma_f32_16x16x32_bf16 v[60:63], v[172:175], v[120:123], v[60:63]
    ds_read_b128 v[148:151], v7 offset:28672
    s_add_u32 m0, s13, 90112
    s_add_u32 s56, s63, 768
    s_mov_b64 exec, s[82:83]
    buffer_load_dwordx4 v5, s[36:39], s56 offen lds
    s_mov_b64 exec, -1
    s_setprio 1
    v_mfma_f32_16x16x32_bf16 v[64:67], v[160:163], v[124:127], v[64:67]
    ds_read_b128 v[152:155], v7 offset:30720
    v_mfma_f32_16x16x32_bf16 v[68:71], v[164:167], v[124:127], v[68:71]
    s_waitcnt lgkmcnt(8)
    ds_read_b128 v[156:159], v7 offset:32768
    v_mfma_f32_16x16x32_bf16 v[72:75], v[168:171], v[124:127], v[72:75]
    v_mfma_f32_16x16x32_bf16 v[76:79], v[172:175], v[124:127], v[76:79]
    v_mfma_f32_16x16x32_bf16 v[80:83], v[160:163], v[128:131], v[80:83]
    v_mfma_f32_16x16x32_bf16 v[84:87], v[164:167], v[128:131], v[84:87]
    s_mul_i32 s56, s66, 0
    s_add_u32 m0, s65, s56
    s_add_u32 s56, s64, 768
    buffer_load_dwordx4 v5, s[36:39], s56 offen lds
    s_setprio 0
    v_mfma_f32_16x16x32_bf16 v[88:91], v[168:171], v[128:131], v[88:91]
    v_mfma_f32_16x16x32_bf16 v[92:95], v[172:175], v[128:131], v[92:95]
    v_mfma_f32_16x16x32_bf16 v[96:99], v[160:163], v[132:135], v[96:99]
    v_mfma_f32_16x16x32_bf16 v[100:103], v[164:167], v[132:135], v[100:103]
    v_mfma_f32_16x16x32_bf16 v[104:107], v[168:171], v[132:135], v[104:107]
    v_mfma_f32_16x16x32_bf16 v[108:111], v[172:175], v[132:135], v[108:111]
    s_add_u32 m0, s13, 49152
    s_mov_b32 s56, 1490944
    buffer_load_dwordx4 v2, s[40:43], s56 offen lds
    s_waitcnt vmcnt(8) lgkmcnt(0)
    s_barrier
    s_setprio 3
    v_mfma_f32_16x16x32_bf16 v[16:19], v[176:179], v[136:139], v[16:19]
    ds_read_b128 v[112:115], v6 offset:45056
    v_mfma_f32_16x16x32_bf16 v[20:23], v[180:183], v[136:139], v[20:23]
    ds_read_b64_tr_b16 v[160:161], v8 offset:0
    v_mfma_f32_16x16x32_bf16 v[24:27], v[184:187], v[136:139], v[24:27]
    ds_read_b64_tr_b16 v[162:163], v8 offset:1024
    v_mfma_f32_16x16x32_bf16 v[28:31], v[188:191], v[136:139], v[28:31]
    ds_read_b64_tr_b16 v[164:165], v9 offset:0
    s_add_u32 s77, s77, 1
    s_cmp_eq_u32 s77, 7
    s_cselect_b32 s77, 0, s77
    s_mul_i32 s67, s77, 28672
    s_add_u32 s67, s67, s78
    s_lshl_b32 s9, s12, 12
    s_add_u32 s9, s9, s7
    s_add_u32 m0, s9, 0
    s_add_u32 s56, s67, 0
    buffer_load_dwordx4 v244, s[52:55], s56 offen lds
    v_mfma_f32_16x16x32_bf16 v[32:35], v[176:179], v[140:143], v[32:35]
    ds_read_b64_tr_b16 v[166:167], v9 offset:1024
    v_mfma_f32_16x16x32_bf16 v[36:39], v[180:183], v[140:143], v[36:39]
    ds_read_b64_tr_b16 v[168:169], v8 offset:8192
    s_setprio 2
    v_mfma_f32_16x16x32_bf16 v[40:43], v[184:187], v[140:143], v[40:43]
    ds_read_b64_tr_b16 v[170:171], v8 offset:9216
    v_mfma_f32_16x16x32_bf16 v[44:47], v[188:191], v[140:143], v[44:47]
    ds_read_b64_tr_b16 v[172:173], v9 offset:8192
    s_add_u32 m0, s9, 1024
    s_add_u32 s56, s67, 7168
    buffer_load_dwordx4 v244, s[52:55], s56 offen lds
    v_mfma_f32_16x16x32_bf16 v[48:51], v[176:179], v[144:147], v[48:51]
    ds_read_b64_tr_b16 v[174:175], v9 offset:9216
    v_mfma_f32_16x16x32_bf16 v[52:55], v[180:183], v[144:147], v[52:55]
    ds_read_b128 v[116:119], v6 offset:47104
    v_mfma_f32_16x16x32_bf16 v[56:59], v[184:187], v[144:147], v[56:59]
    ds_read_b128 v[120:123], v6 offset:49152
    v_mfma_f32_16x16x32_bf16 v[60:63], v[188:191], v[144:147], v[60:63]
    ds_read_b128 v[124:127], v6 offset:51200
    s_add_u32 m0, s9, 2048
    s_add_u32 s56, s67, 14336
    buffer_load_dwordx4 v244, s[52:55], s56 offen lds
    s_setprio 1
    v_mfma_f32_16x16x32_bf16 v[64:67], v[176:179], v[148:151], v[64:67]
    ds_read_b128 v[128:131], v6 offset:53248
    v_mfma_f32_16x16x32_bf16 v[68:71], v[180:183], v[148:151], v[68:71]
    s_waitcnt lgkmcnt(8)
    ds_read_b128 v[132:135], v6 offset:55296
    v_mfma_f32_16x16x32_bf16 v[72:75], v[184:187], v[148:151], v[72:75]
    v_mfma_f32_16x16x32_bf16 v[76:79], v[188:191], v[148:151], v[76:79]
    s_add_u32 m0, s9, 3072
    s_add_u32 s56, s67, 21504
    buffer_load_dwordx4 v244, s[52:55], s56 offen lds
    v_mfma_f32_16x16x32_bf16 v[80:83], v[176:179], v[152:155], v[80:83]
    v_mfma_f32_16x16x32_bf16 v[84:87], v[180:183], v[152:155], v[84:87]
    s_setprio 0
    v_mfma_f32_16x16x32_bf16 v[88:91], v[184:187], v[152:155], v[88:91]
    v_mfma_f32_16x16x32_bf16 v[92:95], v[188:191], v[152:155], v[92:95]
    s_add_u32 m0, s13, 57344
    s_mov_b32 s56, 1490944
    buffer_load_dwordx4 v2, s[44:47], s56 offen lds
    v_mfma_f32_16x16x32_bf16 v[96:99], v[176:179], v[156:159], v[96:99]
    v_mfma_f32_16x16x32_bf16 v[100:103], v[180:183], v[156:159], v[100:103]
    v_mfma_f32_16x16x32_bf16 v[104:107], v[184:187], v[156:159], v[104:107]
    v_mfma_f32_16x16x32_bf16 v[108:111], v[188:191], v[156:159], v[108:111]
    buffer_load_dwordx4 v[12:15], v248, s[48:51], 0 offen sc0 sc1
    s_waitcnt vmcnt(12) lgkmcnt(0)
    s_barrier
    s_setprio 3
    v_mfma_f32_16x16x32_bf16 v[16:19], v[160:163], v[112:115], v[16:19]
    ds_read_b128 v[136:139], v7 offset:45056
    v_mfma_f32_16x16x32_bf16 v[20:23], v[164:167], v[112:115], v[20:23]
    ds_read_b64_tr_b16 v[176:177], v8 offset:16384
    v_mfma_f32_16x16x32_bf16 v[24:27], v[168:171], v[112:115], v[24:27]
    ds_read_b64_tr_b16 v[178:179], v8 offset:17408
    v_mfma_f32_16x16x32_bf16 v[28:31], v[172:175], v[112:115], v[28:31]
    ds_read_b64_tr_b16 v[180:181], v9 offset:16384
    v_mfma_f32_16x16x32_bf16 v[32:35], v[160:163], v[116:119], v[32:35]
    ds_read_b64_tr_b16 v[182:183], v9 offset:17408
    v_mfma_f32_16x16x32_bf16 v[36:39], v[164:167], v[116:119], v[36:39]
    ds_read_b64_tr_b16 v[184:185], v8 offset:24576
    s_setprio 2
    v_mfma_f32_16x16x32_bf16 v[40:43], v[168:171], v[116:119], v[40:43]
    ds_read_b64_tr_b16 v[186:187], v8 offset:25600
    v_mfma_f32_16x16x32_bf16 v[44:47], v[172:175], v[116:119], v[44:47]
    ds_read_b64_tr_b16 v[188:189], v9 offset:24576
    v_mfma_f32_16x16x32_bf16 v[48:51], v[160:163], v[120:123], v[48:51]
    ds_read_b64_tr_b16 v[190:191], v9 offset:25600
    v_mfma_f32_16x16x32_bf16 v[52:55], v[164:167], v[120:123], v[52:55]
    ds_read_b128 v[140:143], v7 offset:47104
    v_mfma_f32_16x16x32_bf16 v[56:59], v[168:171], v[120:123], v[56:59]
    ds_read_b128 v[144:147], v7 offset:49152
    v_mfma_f32_16x16x32_bf16 v[60:63], v[172:175], v[120:123], v[60:63]
    ds_read_b128 v[148:151], v7 offset:51200
    s_setprio 1
    v_mfma_f32_16x16x32_bf16 v[64:67], v[160:163], v[124:127], v[64:67]
    ds_read_b128 v[152:155], v7 offset:53248
    v_mfma_f32_16x16x32_bf16 v[68:71], v[164:167], v[124:127], v[68:71]
    s_waitcnt lgkmcnt(8)
    ds_read_b128 v[156:159], v7 offset:55296
    v_mfma_f32_16x16x32_bf16 v[72:75], v[168:171], v[124:127], v[72:75]
    v_mfma_f32_16x16x32_bf16 v[76:79], v[172:175], v[124:127], v[76:79]
    v_mfma_f32_16x16x32_bf16 v[80:83], v[160:163], v[128:131], v[80:83]
    v_mfma_f32_16x16x32_bf16 v[84:87], v[164:167], v[128:131], v[84:87]
    s_setprio 0
    v_mfma_f32_16x16x32_bf16 v[88:91], v[168:171], v[128:131], v[88:91]
    v_mfma_f32_16x16x32_bf16 v[92:95], v[172:175], v[128:131], v[92:95]
    v_mfma_f32_16x16x32_bf16 v[96:99], v[160:163], v[132:135], v[96:99]
    v_mfma_f32_16x16x32_bf16 v[100:103], v[164:167], v[132:135], v[100:103]
    v_mfma_f32_16x16x32_bf16 v[104:107], v[168:171], v[132:135], v[104:107]
    v_mfma_f32_16x16x32_bf16 v[108:111], v[172:175], v[132:135], v[108:111]
    s_waitcnt vmcnt(7) lgkmcnt(0)
    s_barrier
    s_setprio 3
    v_mfma_f32_16x16x32_bf16 v[16:19], v[176:179], v[136:139], v[16:19]
    ds_read_b128 v[112:115], v6 offset:0
    v_mfma_f32_16x16x32_bf16 v[20:23], v[180:183], v[136:139], v[20:23]
    ds_read_b64_tr_b16 v[160:161], v8 offset:32768
    v_mfma_f32_16x16x32_bf16 v[24:27], v[184:187], v[136:139], v[24:27]
    ds_read_b64_tr_b16 v[162:163], v8 offset:33792
    v_mfma_f32_16x16x32_bf16 v[28:31], v[188:191], v[136:139], v[28:31]
    ds_read_b64_tr_b16 v[164:165], v9 offset:32768
    v_mfma_f32_16x16x32_bf16 v[32:35], v[176:179], v[140:143], v[32:35]
    ds_read_b64_tr_b16 v[166:167], v9 offset:33792
    s_add_u32 s77, s77, 1
    s_cmp_eq_u32 s77, 7
    s_cselect_b32 s77, 0, s77
    s_mul_i32 s67, s77, 28672
    s_add_u32 s67, s67, s78
    s_lshl_b32 s9, s12, 12
    s_add_u32 s9, s9, 0
    s_add_u32 m0, s9, 0
    s_add_u32 s56, s67, 0
    buffer_load_dwordx4 v244, s[52:55], s56 offen lds
    v_mfma_f32_16x16x32_bf16 v[36:39], v[180:183], v[140:143], v[36:39]
    ds_read_b64_tr_b16 v[168:169], v8 offset:40960
    s_setprio 2
    v_mfma_f32_16x16x32_bf16 v[40:43], v[184:187], v[140:143], v[40:43]
    ds_read_b64_tr_b16 v[170:171], v8 offset:41984
    v_mfma_f32_16x16x32_bf16 v[44:47], v[188:191], v[140:143], v[44:47]
    ds_read_b64_tr_b16 v[172:173], v9 offset:40960
    v_mfma_f32_16x16x32_bf16 v[48:51], v[176:179], v[144:147], v[48:51]
    ds_read_b64_tr_b16 v[174:175], v9 offset:41984
    v_mfma_f32_16x16x32_bf16 v[52:55], v[180:183], v[144:147], v[52:55]
    ds_read_b128 v[116:119], v6 offset:2048
    s_add_u32 m0, s9, 1024
    s_add_u32 s56, s67, 7168
    buffer_load_dwordx4 v244, s[52:55], s56 offen lds
    v_mfma_f32_16x16x32_bf16 v[56:59], v[184:187], v[144:147], v[56:59]
    ds_read_b128 v[120:123], v6 offset:4096
    v_mfma_f32_16x16x32_bf16 v[60:63], v[188:191], v[144:147], v[60:63]
    ds_read_b128 v[124:127], v6 offset:6144
    s_setprio 1
    v_mfma_f32_16x16x32_bf16 v[64:67], v[176:179], v[148:151], v[64:67]
    ds_read_b128 v[128:131], v6 offset:8192
    v_mfma_f32_16x16x32_bf16 v[68:71], v[180:183], v[148:151], v[68:71]
    s_waitcnt lgkmcnt(8)
    ds_read_b128 v[132:135], v6 offset:10240
    v_mfma_f32_16x16x32_bf16 v[72:75], v[184:187], v[148:151], v[72:75]
    s_add_u32 m0, s9, 2048
    s_add_u32 s56, s67, 14336
    buffer_load_dwordx4 v244, s[52:55], s56 offen lds
    v_mfma_f32_16x16x32_bf16 v[76:79], v[188:191], v[148:151], v[76:79]
    v_mfma_f32_16x16x32_bf16 v[80:83], v[176:179], v[152:155], v[80:83]
    v_mfma_f32_16x16x32_bf16 v[84:87], v[180:183], v[152:155], v[84:87]
    s_setprio 0
    v_mfma_f32_16x16x32_bf16 v[88:91], v[184:187], v[152:155], v[88:91]
    v_mfma_f32_16x16x32_bf16 v[92:95], v[188:191], v[152:155], v[92:95]
    s_add_u32 m0, s9, 3072
    s_add_u32 s56, s67, 21504
    buffer_load_dwordx4 v244, s[52:55], s56 offen lds
    v_mfma_f32_16x16x32_bf16 v[96:99], v[176:179], v[156:159], v[96:99]
    v_mfma_f32_16x16x32_bf16 v[100:103], v[180:183], v[156:159], v[100:103]
    v_mfma_f32_16x16x32_bf16 v[104:107], v[184:187], v[156:159], v[104:107]
    v_mfma_f32_16x16x32_bf16 v[108:111], v[188:191], v[156:159], v[108:111]
    s_waitcnt vmcnt(4)
    v_cmp_ne_u64 vcc, s[68:69], v[14:15]
    s_and_b64 vcc, vcc, s[84:85]
    s_cbranch_scc0 kk_gok_4
    s_mov_b32 s57, 0
kk_gsp_5:
    s_sleep 2
    buffer_load_dwordx4 v[12:15], v248, s[48:51], 0 offen sc0 sc1
    s_add_u32 s57, s57, 1
    s_waitcnt vmcnt(0)
    v_cmp_ne_u64 vcc, s[68:69], v[14:15]
    s_and_b64 vcc, vcc, s[84:85]
    s_cbranch_scc0 kk_gok_4
    s_cmp_lt_u32 s57, 32768
    s_cbranch_scc1 kk_gsp_5
kk_gok_4:
    v_rcp_f32 v14, v13
    v_mul_f32 v15, v13, v13
    v_sub_f32 v12, 0, v12
    v_mul_f32 v13, 0xc0135761, v14
    v_mul_f32 v248, v14, v14
    v_mul_f32 v14, v14, v248
    v_mul_f32 v14, 0xbdd2d3e8, v14
    ds_write_b128 v249, v[12:15]
    s_waitcnt lgkmcnt(0)
    s_barrier
    s_setprio 3
    v_mfma_f32_16x16x32_bf16 v[16:19], v[160:163], v[112:115], v[16:19]
    ds_read_b128 v[136:139], v7 offset:0
    v_mfma_f32_16x16x32_bf16 v[20:23], v[164:167], v[112:115], v[20:23]
    ds_read_b64_tr_b16 v[176:177], v10 offset:0
    v_mfma_f32_16x16x32_bf16 v[24:27], v[168:171], v[112:115], v[24:27]
    ds_read_b64_tr_b16 v[178:179], v10 offset:1024
    v_mfma_f32_16x16x32_bf16 v[28:31], v[172:175], v[112:115], v[28:31]
    ds_read_b64_tr_b16 v[180:181], v11 offset:0
    v_mfma_f32_16x16x32_bf16 v[32:35], v[160:163], v[116:119], v[32:35]
    ds_read_b64_tr_b16 v[182:183], v11 offset:1024
    v_mfma_f32_16x16x32_bf16 v[36:39], v[164:167], v[116:119], v[36:39]
    ds_read_b64_tr_b16 v[184:185], v10 offset:8192
    s_add_u32 s77, s77, 1
    s_cmp_eq_u32 s77, 7
    s_cselect_b32 s77, 0, s77
    s_mul_i32 s67, s77, 28672
    s_add_u32 s67, s67, s78
    s_lshl_b32 s9, s12, 12
    s_add_u32 s9, s9, s8
    s_add_u32 m0, s9, 0
    s_add_u32 s56, s67, 0
    buffer_load_dwordx4 v244, s[52:55], s56 offen lds
    s_setprio 2
    v_mfma_f32_16x16x32_bf16 v[40:43], v[168:171], v[116:119], v[40:43]
    ds_read_b64_tr_b16 v[186:187], v10 offset:9216
    v_mfma_f32_16x16x32_bf16 v[44:47], v[172:175], v[116:119], v[44:47]
    ds_read_b64_tr_b16 v[188:189], v11 offset:8192
    v_mfma_f32_16x16x32_bf16 v[48:51], v[160:163], v[120:123], v[48:51]
    ds_read_b64_tr_b16 v[190:191], v11 offset:9216
    v_mfma_f32_16x16x32_bf16 v[52:55], v[164:167], v[120:123], v[52:55]
    ds_read_b128 v[140:143], v7 offset:2048
    v_mfma_f32_16x16x32_bf16 v[56:59], v[168:171], v[120:123], v[56:59]
    ds_read_b128 v[144:147], v7 offset:4096
    v_mfma_f32_16x16x32_bf16 v[60:63], v[172:175], v[120:123], v[60:63]
    ds_read_b128 v[148:151], v7 offset:6144
    s_add_u32 m0, s9, 1024
    s_add_u32 s56, s67, 7168
    buffer_load_dwordx4 v244, s[52:55], s56 offen lds
    s_setprio 1
    v_mfma_f32_16x16x32_bf16 v[64:67], v[160:163], v[124:127], v[64:67]
    ds_read_b128 v[152:155], v7 offset:8192
    v_mfma_f32_16x16x32_bf16 v[68:71], v[164:167], v[124:127], v[68:71]
    s_waitcnt lgkmcnt(8)
    ds_read_b128 v[156:159], v7 offset:10240
    v_mfma_f32_16x16x32_bf16 v[72:75], v[168:171], v[124:127], v[72:75]
    v_mfma_f32_16x16x32_bf16 v[76:79], v[172:175], v[124:127], v[76:79]
    v_mfma_f32_16x16x32_bf16 v[80:83], v[160:163], v[128:131], v[80:83]
    v_mfma_f32_16x16x32_bf16 v[84:87], v[164:167], v[128:131], v[84:87]
    s_add_u32 m0, s9, 2048
    s_add_u32 s56, s67, 14336
    buffer_load_dwordx4 v244, s[52:55], s56 offen lds
    s_setprio 0
    v_mfma_f32_16x16x32_bf16 v[88:91], v[168:171], v[128:131], v[88:91]
    v_mfma_f32_16x16x32_bf16 v[92:95], v[172:175], v[128:131], v[92:95]
    v_mfma_f32_16x16x32_bf16 v[96:99], v[160:163], v[132:135], v[96:99]
    v_mfma_f32_16x16x32_bf16 v[100:103], v[164:167], v[132:135], v[100:103]
    v_mfma_f32_16x16x32_bf16 v[104:107], v[168:171], v[132:135], v[104:107]
    v_mfma_f32_16x16x32_bf16 v[108:111], v[172:175], v[132:135], v[108:111]
    s_add_u32 m0, s9, 3072
    s_add_u32 s56, s67, 21504
    buffer_load_dwordx4 v244, s[52:55], s56 offen lds
    s_waitcnt lgkmcnt(0)
    s_barrier
    s_setprio 3
    v_mfma_f32_16x16x32_bf16 v[16:19], v[176:179], v[136:139], v[16:19]
    v_mfma_f32_16x16x32_bf16 v[20:23], v[180:183], v[136:139], v[20:23]
    v_mfma_f32_16x16x32_bf16 v[24:27], v[184:187], v[136:139], v[24:27]
    v_mfma_f32_16x16x32_bf16 v[28:31], v[188:191], v[136:139], v[28:31]
    v_mfma_f32_16x16x32_bf16 v[32:35], v[176:179], v[140:143], v[32:35]
    v_mfma_f32_16x16x32_bf16 v[36:39], v[180:183], v[140:143], v[36:39]
    s_add_u32 s77, s77, 1
    s_cmp_eq_u32 s77, 7
    s_cselect_b32 s77, 0, s77
    s_mul_i32 s67, s77, 28672
    s_add_u32 s67, s67, s78
    s_lshl_b32 s9, s12, 12
    s_add_u32 s9, s9, s10
    s_add_u32 m0, s9, 0
    s_add_u32 s56, s67, 0
    buffer_load_dwordx4 v244, s[52:55], s56 offen lds
    s_setprio 2
    v_mfma_f32_16x16x32_bf16 v[40:43], v[184:187], v[140:143], v[40:43]
    v_mfma_f32_16x16x32_bf16 v[44:47], v[188:191], v[140:143], v[44:47]
    v_mfma_f32_16x16x32_bf16 v[48:51], v[176:179], v[144:147], v[48:51]
    v_mfma_f32_16x16x32_bf16 v[52:55], v[180:183], v[144:147], v[52:55]
    v_mfma_f32_16x16x32_bf16 v[56:59], v[184:187], v[144:147], v[56:59]
    v_mfma_f32_16x16x32_bf16 v[60:63], v[188:191], v[144:147], v[60:63]
    s_add_u32 m0, s9, 1024
    s_add_u32 s56, s67, 7168
    buffer_load_dwordx4 v244, s[52:55], s56 offen lds
    s_setprio 1
    v_mfma_f32_16x16x32_bf16 v[64:67], v[176:179], v[148:151], v[64:67]
    v_mfma_f32_16x16x32_bf16 v[68:71], v[180:183], v[148:151], v[68:71]
    v_mfma_f32_16x16x32_bf16 v[72:75], v[184:187], v[148:151], v[72:75]
    v_mfma_f32_16x16x32_bf16 v[76:79], v[188:191], v[148:151], v[76:79]
    v_mfma_f32_16x16x32_bf16 v[80:83], v[176:179], v[152:155], v[80:83]
    v_mfma_f32_16x16x32_bf16 v[84:87], v[180:183], v[152:155], v[84:87]
    s_add_u32 m0, s9, 2048
    s_add_u32 s56, s67, 14336
    buffer_load_dwordx4 v244, s[52:55], s56 offen lds
    s_setprio 0
    v_mfma_f32_16x16x32_bf16 v[88:91], v[184:187], v[152:155], v[88:91]
    v_mfma_f32_16x16x32_bf16 v[92:95], v[188:191], v[152:155], v[92:95]
    v_mfma_f32_16x16x32_bf16 v[96:99], v[176:179], v[156:159], v[96:99]
    v_mfma_f32_16x16x32_bf16 v[100:103], v[180:183], v[156:159], v[100:103]
    v_mfma_f32_16x16x32_bf16 v[104:107], v[184:187], v[156:159], v[104:107]
    v_mfma_f32_16x16x32_bf16 v[108:111], v[188:191], v[156:159], v[108:111]
    s_add_u32 m0, s9, 3072
    s_add_u32 s56, s67, 21504
    buffer_load_dwordx4 v244, s[52:55], s56 offen lds
    s_setprio 0
    s_barrier
    s_mov_b32 s40, s20
    s_mov_b32 s41, s21
    s_mov_b32 s42, 401408
    s_mov_b32 s43, 0x20000
    v_and_b32 v4, 15, v1
    v_lshlrev_b32 v4, 4, v4
    v_add_u32 v4, 149504, v4
    ds_read_b128 v[12:15], v4
    v_lshlrev_b32 v5, 4, v1
    s_mul_i32 s62, s14, 811008
    s_lshl_b32 s63, s15, 2
    s_and_b32 s56, s12, 3
    s_add_u32 s63, s63, s56
    s_lshl_b32 s63, s63, 10
    s_add_u32 s62, s62, s63
    s_add_u32 s62, s62, 0
    s_lshl_b32 s63, s14, 7
    s_lshl_b32 s56, s15, 3
    s_add_u32 s63, s63, s56
    s_add_u32 s63, s63, 10551296
    v_mov_b32_dpp v224, v16 row_newbcast:0 row_mask:0xf bank_mask:0xf
    v_mov_b32_dpp v225, v17 row_newbcast:0 row_mask:0xf bank_mask:0xf
    v_mov_b32_dpp v226, v18 row_newbcast:0 row_mask:0xf bank_mask:0xf
    v_mov_b32_dpp v227, v19 row_newbcast:0 row_mask:0xf bank_mask:0xf
    v_mov_b32_dpp v228, v20 row_newbcast:0 row_mask:0xf bank_mask:0xf
    v_mov_b32_dpp v229, v21 row_newbcast:0 row_mask:0xf bank_mask:0xf
    v_mov_b32_dpp v230, v22 row_newbcast:0 row_mask:0xf bank_mask:0xf
    v_mov_b32_dpp v231, v23 row_newbcast:0 row_mask:0xf bank_mask:0xf
    v_mov_b32_dpp v232, v24 row_newbcast:0 row_mask:0xf bank_mask:0xf
    v_mov_b32_dpp v233, v25 row_newbcast:0 row_mask:0xf bank_mask:0xf
    v_mov_b32_dpp v234, v26 row_newbcast:0 row_mask:0xf bank_mask:0xf
    v_mov_b32_dpp v235, v27 row_newbcast:0 row_mask:0xf bank_mask:0xf
    v_mov_b32_dpp v236, v28 row_newbcast:0 row_mask:0xf bank_mask:0xf
    v_mov_b32_dpp v237, v29 row_newbcast:0 row_mask:0xf bank_mask:0xf
    v_mov_b32_dpp v238, v30 row_newbcast:0 row_mask:0xf bank_mask:0xf
    v_mov_b32_dpp v239, v31 row_newbcast:0 row_mask:0xf bank_mask:0xf
    s_waitcnt lgkmcnt(0)
    v_mov_b32 v176, v13
    v_mov_b32 v178, v15
    v_pk_fma_f32 v[16:17], v[12:13], v[224:225], v[16:17] op_sel_hi:[0,1,1]
    v_pk_fma_f32 v[18:19], v[12:13], v[226:227], v[18:19] op_sel_hi:[0,1,1]
    v_pk_fma_f32 v[20:21], v[12:13], v[228:229], v[20:21] op_sel_hi:[0,1,1]
    v_pk_fma_f32 v[22:23], v[12:13], v[230:231], v[22:23] op_sel_hi:[0,1,1]
    v_pk_mul_f32 v[2:3], v[16:17], v[16:17]
    v_pk_mul_f32 v[6:7], v[18:19], v[18:19]
    v_pk_mul_f32 v[8:9], v[20:21], v[20:21]
    v_pk_mul_f32 v[10:11], v[22:23], v[22:23]
    v_pk_fma_f32 v[2:3], v[2:3], v[14:15], v[176:177] op_sel_hi:[1,0,0]
    v_pk_fma_f32 v[6:7], v[6:7], v[14:15], v[176:177] op_sel_hi:[1,0,0]
    v_pk_fma_f32 v[8:9], v[8:9], v[14:15], v[176:177] op_sel_hi:[1,0,0]
    v_pk_fma_f32 v[10:11], v[10:11], v[14:15], v[176:177] op_sel_hi:[1,0,0]
    v_pk_mul_f32 v[2:3], v[2:3], v[16:17]
    v_pk_mul_f32 v[6:7], v[6:7], v[18:19]
    v_pk_mul_f32 v[8:9], v[8:9], v[20:21]
    v_pk_mul_f32 v[10:11], v[10:11], v[22:23]
    v_exp_f32 v2, v2
    v_exp_f32 v3, v3
    v_pk_fma_f32 v[24:25], v[12:13], v[232:233], v[24:25] op_sel_hi:[0,1,1]
    v_exp_f32 v6, v6
    v_exp_f32 v7, v7
    v_pk_fma_f32 v[26:27], v[12:13], v[234:235], v[26:27] op_sel_hi:[0,1,1]
    v_exp_f32 v8, v8
    v_exp_f32 v9, v9
    v_pk_fma_f32 v[28:29], v[12:13], v[236:237], v[28:29] op_sel_hi:[0,1,1]
    v_exp_f32 v10, v10
    v_exp_f32 v11, v11
    v_pk_fma_f32 v[30:31], v[12:13], v[238:239], v[30:31] op_sel_hi:[0,1,1]
    v_pk_fma_f32 v[2:3], v[2:3], v[178:179], v[178:179] op_sel_hi:[1,0,0]
    v_pk_fma_f32 v[6:7], v[6:7], v[178:179], v[178:179] op_sel_hi:[1,0,0]
    v_pk_fma_f32 v[8:9], v[8:9], v[178:179], v[178:179] op_sel_hi:[1,0,0]
    v_pk_fma_f32 v[10:11], v[10:11], v[178:179], v[178:179] op_sel_hi:[1,0,0]
    v_rcp_f32 v2, v2
    v_rcp_f32 v3, v3
    v_pk_mul_f32 v[16:17], v[16:17], v[24:25]
    v_rcp_f32 v6, v6
    v_rcp_f32 v7, v7
    v_pk_mul_f32 v[18:19], v[18:19], v[26:27]
    v_rcp_f32 v8, v8
    v_rcp_f32 v9, v9
    v_pk_mul_f32 v[20:21], v[20:21], v[28:29]
    v_rcp_f32 v10, v10
    v_rcp_f32 v11, v11
    v_pk_mul_f32 v[22:23], v[22:23], v[30:31]
    v_pk_mul_f32 v[16:17], v[16:17], v[2:3]
    v_pk_mul_f32 v[18:19], v[18:19], v[6:7]
    v_pk_mul_f32 v[20:21], v[20:21], v[8:9]
    v_pk_mul_f32 v[22:23], v[22:23], v[10:11]
    ds_read_b128 v[12:15], v4 offset:256
    v_cvt_pk_bf16_f32 v24, v16, v17
    v_cvt_pk_bf16_f32 v25, v18, v19
    v_cvt_pk_bf16_f32 v26, v20, v21
    v_cvt_pk_bf16_f32 v27, v22, v23
    s_add_u32 s56, s62, 0
    buffer_store_dwordx4 v[24:27], v5, s[48:51], s56 offen sc1
    s_waitcnt lgkmcnt(0)
    v_mov_b32 v176, v13
    v_mov_b32 v178, v15
    v_pk_fma_f32 v[32:33], v[12:13], v[224:225], v[32:33] op_sel_hi:[0,1,1]
    v_pk_fma_f32 v[34:35], v[12:13], v[226:227], v[34:35] op_sel_hi:[0,1,1]
    v_pk_fma_f32 v[36:37], v[12:13], v[228:229], v[36:37] op_sel_hi:[0,1,1]
    v_pk_fma_f32 v[38:39], v[12:13], v[230:231], v[38:39] op_sel_hi:[0,1,1]
    v_pk_mul_f32 v[2:3], v[32:33], v[32:33]
    v_pk_mul_f32 v[6:7], v[34:35], v[34:35]
    v_pk_mul_f32 v[8:9], v[36:37], v[36:37]
    v_pk_mul_f32 v[10:11], v[38:39], v[38:39]
    v_pk_fma_f32 v[2:3], v[2:3], v[14:15], v[176:177] op_sel_hi:[1,0,0]
    v_pk_fma_f32 v[6:7], v[6:7], v[14:15], v[176:177] op_sel_hi:[1,0,0]
    v_pk_fma_f32 v[8:9], v[8:9], v[14:15], v[176:177] op_sel_hi:[1,0,0]
    v_pk_fma_f32 v[10:11], v[10:11], v[14:15], v[176:177] op_sel_hi:[1,0,0]
    v_pk_mul_f32 v[2:3], v[2:3], v[32:33]
    v_pk_mul_f32 v[6:7], v[6:7], v[34:35]
    v_pk_mul_f32 v[8:9], v[8:9], v[36:37]
    v_pk_mul_f32 v[10:11], v[10:11], v[38:39]
    v_exp_f32 v2, v2
    v_exp_f32 v3, v3
    v_pk_fma_f32 v[40:41], v[12:13], v[232:233], v[40:41] op_sel_hi:[0,1,1]
    v_exp_f32 v6, v6
    v_exp_f32 v7, v7
    v_pk_fma_f32 v[42:43], v[12:13], v[234:235], v[42:43] op_sel_hi:[0,1,1]
    v_exp_f32 v8, v8
    v_exp_f32 v9, v9
    v_pk_fma_f32 v[44:45], v[12:13], v[236:237], v[44:45] op_sel_hi:[0,1,1]
    v_exp_f32 v10, v10
    v_exp_f32 v11, v11
    v_pk_fma_f32 v[46:47], v[12:13], v[238:239], v[46:47] op_sel_hi:[0,1,1]
    v_pk_fma_f32 v[2:3], v[2:3], v[178:179], v[178:179] op_sel_hi:[1,0,0]
    v_pk_fma_f32 v[6:7], v[6:7], v[178:179], v[178:179] op_sel_hi:[1,0,0]
    v_pk_fma_f32 v[8:9], v[8:9], v[178:179], v[178:179] op_sel_hi:[1,0,0]
    v_pk_fma_f32 v[10:11], v[10:11], v[178:179], v[178:179] op_sel_hi:[1,0,0]
    v_rcp_f32 v2, v2
    v_rcp_f32 v3, v3
    v_pk_mul_f32 v[32:33], v[32:33], v[40:41]
    v_rcp_f32 v6, v6
    v_rcp_f32 v7, v7
    v_pk_mul_f32 v[34:35], v[34:35], v[42:43]
    v_rcp_f32 v8, v8
    v_rcp_f32 v9, v9
    v_pk_mul_f32 v[36:37], v[36:37], v[44:45]
    v_rcp_f32 v10, v10
    v_rcp_f32 v11, v11
    v_pk_mul_f32 v[38:39], v[38:39], v[46:47]
    v_pk_mul_f32 v[32:33], v[32:33], v[2:3]
    v_pk_mul_f32 v[34:35], v[34:35], v[6:7]
    v_pk_mul_f32 v[36:37], v[36:37], v[8:9]
    v_pk_mul_f32 v[38:39], v[38:39], v[10:11]
    ds_read_b128 v[12:15], v4 offset:512
    v_cvt_pk_bf16_f32 v40, v32, v33
    v_cvt_pk_bf16_f32 v41, v34, v35
    v_cvt_pk_bf16_f32 v42, v36, v37
    v_cvt_pk_bf16_f32 v43, v38, v39
    s_add_u32 s56, s62, 73728
    buffer_store_dwordx4 v[40:43], v5, s[48:51], s56 offen sc1
    s_waitcnt lgkmcnt(7)
    v_add_u32 v240, s7, v246
    v_xor_b32 v241, 32, v240
    v_xor_b32 v242, 64, v240
    v_xor_b32 v243, 96, v240
    ds_read_b64_tr_b16 v[192:193], v240 offset:0
    ds_read_b64_tr_b16 v[194:195], v240 offset:2048
    ds_read_b64_tr_b16 v[196:197], v241 offset:0
    ds_read_b64_tr_b16 v[198:199], v241 offset:2048
    ds_read_b64_tr_b16 v[200:201], v242 offset:0
    ds_read_b64_tr_b16 v[202:203], v242 offset:2048
    ds_read_b64_tr_b16 v[204:205], v243 offset:0
    ds_read_b64_tr_b16 v[206:207], v243 offset:2048
    s_waitcnt vmcnt(10) lgkmcnt(7)
    v_add_u32 v240, 0, v246
    v_xor_b32 v241, 32, v240
    v_xor_b32 v242, 64, v240
    v_xor_b32 v243, 96, v240
    ds_read_b64_tr_b16 v[208:209], v240 offset:0
    ds_read_b64_tr_b16 v[210:211], v240 offset:2048
    ds_read_b64_tr_b16 v[212:213], v241 offset:0
    ds_read_b64_tr_b16 v[214:215], v241 offset:2048
    ds_read_b64_tr_b16 v[216:217], v242 offset:0
    ds_read_b64_tr_b16 v[218:219], v242 offset:2048
    ds_read_b64_tr_b16 v[220:221], v243 offset:0
    ds_read_b64_tr_b16 v[222:223], v243 offset:2048
    s_waitcnt lgkmcnt(0)
    v_mov_b32 v176, v13
    v_mov_b32 v178, v15
    v_pk_fma_f32 v[48:49], v[12:13], v[224:225], v[48:49] op_sel_hi:[0,1,1]
    s_add_u32 s77, s77, 1
    s_cmp_eq_u32 s77, 7
    s_cselect_b32 s77, 0, s77
    s_mul_i32 s67, s77, 28672
    s_add_u32 s67, s67, s78
    s_lshl_b32 s9, s12, 12
    s_add_u32 s9, s9, s7
    s_add_u32 m0, s9, 0
    s_add_u32 s56, s67, 0
    buffer_load_dwordx4 v244, s[52:55], s56 offen lds
    v_pk_fma_f32 v[50:51], v[12:13], v[226:227], v[50:51] op_sel_hi:[0,1,1]
    v_pk_fma_f32 v[52:53], v[12:13], v[228:229], v[52:53] op_sel_hi:[0,1,1]
    v_pk_fma_f32 v[54:55], v[12:13], v[230:231], v[54:55] op_sel_hi:[0,1,1]
    v_pk_mul_f32 v[2:3], v[48:49], v[48:49]
    v_pk_mul_f32 v[6:7], v[50:51], v[50:51]
    v_pk_mul_f32 v[8:9], v[52:53], v[52:53]
    s_add_u32 m0, s9, 1024
    s_add_u32 s56, s67, 7168
    buffer_load_dwordx4 v244, s[52:55], s56 offen lds
    v_pk_mul_f32 v[10:11], v[54:55], v[54:55]
    v_pk_fma_f32 v[2:3], v[2:3], v[14:15], v[176:177] op_sel_hi:[1,0,0]
    v_pk_fma_f32 v[6:7], v[6:7], v[14:15], v[176:177] op_sel_hi:[1,0,0]
    v_pk_fma_f32 v[8:9], v[8:9], v[14:15], v[176:177] op_sel_hi:[1,0,0]
    v_pk_fma_f32 v[10:11], v[10:11], v[14:15], v[176:177] op_sel_hi:[1,0,0]
    v_pk_mul_f32 v[2:3], v[2:3], v[48:49]
    s_add_u32 m0, s9, 2048
    s_add_u32 s56, s67, 14336
    buffer_load_dwordx4 v244, s[52:55], s56 offen lds
    v_pk_mul_f32 v[6:7], v[6:7], v[50:51]
    v_pk_mul_f32 v[8:9], v[8:9], v[52:53]
    v_pk_mul_f32 v[10:11], v[10:11], v[54:55]
    v_exp_f32 v2, v2
    v_exp_f32 v3, v3
    v_pk_fma_f32 v[56:57], v[12:13], v[232:233], v[56:57] op_sel_hi:[0,1,1]
    s_add_u32 m0, s9, 3072
    s_add_u32 s56, s67, 21504
    buffer_load_dwordx4 v244, s[52:55], s56 offen lds
    v_exp_f32 v6, v6
    v_exp_f32 v7, v7
    v_pk_fma_f32 v[58:59], v[12:13], v[234:235], v[58:59] op_sel_hi:[0,1,1]
    v_exp_f32 v8, v8
    v_exp_f32 v9, v9
    v_pk_fma_f32 v[60:61], v[12:13], v[236:237], v[60:61] op_sel_hi:[0,1,1]
    s_add_u32 s77, s77, 1
    s_cmp_eq_u32 s77, 7
    s_cselect_b32 s77, 0, s77
    s_mul_i32 s67, s77, 28672
    s_add_u32 s67, s67, s78
    s_lshl_b32 s9, s12, 12
    s_add_u32 s9, s9, 0
    s_add_u32 m0, s9, 0
    s_add_u32 s56, s67, 0
    buffer_load_dwordx4 v244, s[52:55], s56 offen lds
    v_exp_f32 v10, v10
    v_exp_f32 v11, v11
    v_pk_fma_f32 v[62:63], v[12:13], v[238:239], v[62:63] op_sel_hi:[0,1,1]
    v_pk_fma_f32 v[2:3], v[2:3], v[178:179], v[178:179] op_sel_hi:[1,0,0]
    v_pk_fma_f32 v[6:7], v[6:7], v[178:179], v[178:179] op_sel_hi:[1,0,0]
    v_pk_fma_f32 v[8:9], v[8:9], v[178:179], v[178:179] op_sel_hi:[1,0,0]
    s_add_u32 m0, s9, 1024
    s_add_u32 s56, s67, 7168
    buffer_load_dwordx4 v244, s[52:55], s56 offen lds
    v_pk_fma_f32 v[10:11], v[10:11], v[178:179], v[178:179] op_sel_hi:[1,0,0]
    v_rcp_f32 v2, v2
    v_rcp_f32 v3, v3
    v_pk_mul_f32 v[48:49], v[48:49], v[56:57]
    v_rcp_f32 v6, v6
    v_rcp_f32 v7, v7
    s_add_u32 m0, s9, 2048
    s_add_u32 s56, s67, 14336
    buffer_load_dwordx4 v244, s[52:55], s56 offen lds
    v_pk_mul_f32 v[50:51], v[50:51], v[58:59]
    v_rcp_f32 v8, v8
    v_rcp_f32 v9, v9
    v_pk_mul_f32 v[52:53], v[52:53], v[60:61]
    v_rcp_f32 v10, v10
    v_rcp_f32 v11, v11
    s_add_u32 m0, s9, 3072
    s_add_u32 s56, s67, 21504
    buffer_load_dwordx4 v244, s[52:55], s56 offen lds
    v_pk_mul_f32 v[54:55], v[54:55], v[62:63]
    v_pk_mul_f32 v[48:49], v[48:49], v[2:3]
    v_pk_mul_f32 v[50:51], v[50:51], v[6:7]
    v_pk_mul_f32 v[52:53], v[52:53], v[8:9]
    v_pk_mul_f32 v[54:55], v[54:55], v[10:11]
    ds_read_b128 v[12:15], v4 offset:768
    v_cvt_pk_bf16_f32 v56, v48, v49
    v_cvt_pk_bf16_f32 v57, v50, v51
    v_cvt_pk_bf16_f32 v58, v52, v53
    v_cvt_pk_bf16_f32 v59, v54, v55
    s_add_u32 s56, s62, 147456
    buffer_store_dwordx4 v[56:59], v5, s[48:51], s56 offen sc1
    s_waitcnt lgkmcnt(0)
    v_mov_b32 v176, v13
    v_mov_b32 v178, v15
    v_pk_fma_f32 v[64:65], v[12:13], v[224:225], v[64:65] op_sel_hi:[0,1,1]
    v_pk_fma_f32 v[66:67], v[12:13], v[226:227], v[66:67] op_sel_hi:[0,1,1]
    v_pk_fma_f32 v[68:69], v[12:13], v[228:229], v[68:69] op_sel_hi:[0,1,1]
    v_pk_fma_f32 v[70:71], v[12:13], v[230:231], v[70:71] op_sel_hi:[0,1,1]
    v_pk_mul_f32 v[2:3], v[64:65], v[64:65]
    v_pk_mul_f32 v[6:7], v[66:67], v[66:67]
    v_pk_mul_f32 v[8:9], v[68:69], v[68:69]
    v_pk_mul_f32 v[10:11], v[70:71], v[70:71]
    v_pk_fma_f32 v[2:3], v[2:3], v[14:15], v[176:177] op_sel_hi:[1,0,0]
    v_pk_fma_f32 v[6:7], v[6:7], v[14:15], v[176:177] op_sel_hi:[1,0,0]
    v_pk_fma_f32 v[8:9], v[8:9], v[14:15], v[176:177] op_sel_hi:[1,0,0]
    v_pk_fma_f32 v[10:11], v[10:11], v[14:15], v[176:177] op_sel_hi:[1,0,0]
    v_pk_mul_f32 v[2:3], v[2:3], v[64:65]
    v_pk_mul_f32 v[6:7], v[6:7], v[66:67]
    v_pk_mul_f32 v[8:9], v[8:9], v[68:69]
    v_pk_mul_f32 v[10:11], v[10:11], v[70:71]
    v_exp_f32 v2, v2
    v_exp_f32 v3, v3
    v_pk_fma_f32 v[72:73], v[12:13], v[232:233], v[72:73] op_sel_hi:[0,1,1]
    v_exp_f32 v6, v6
    v_exp_f32 v7, v7
    v_pk_fma_f32 v[74:75], v[12:13], v[234:235], v[74:75] op_sel_hi:[0,1,1]
    v_exp_f32 v8, v8
    v_exp_f32 v9, v9
    v_pk_fma_f32 v[76:77], v[12:13], v[236:237], v[76:77] op_sel_hi:[0,1,1]
    v_exp_f32 v10, v10
    v_exp_f32 v11, v11
    v_pk_fma_f32 v[78:79], v[12:13], v[238:239], v[78:79] op_sel_hi:[0,1,1]
    v_pk_fma_f32 v[2:3], v[2:3], v[178:179], v[178:179] op_sel_hi:[1,0,0]
    v_pk_fma_f32 v[6:7], v[6:7], v[178:179], v[178:179] op_sel_hi:[1,0,0]
    v_pk_fma_f32 v[8:9], v[8:9], v[178:179], v[178:179] op_sel_hi:[1,0,0]
    v_pk_fma_f32 v[10:11], v[10:11], v[178:179], v[178:179] op_sel_hi:[1,0,0]
    v_rcp_f32 v2, v2
    v_rcp_f32 v3, v3
    v_pk_mul_f32 v[64:65], v[64:65], v[72:73]
    v_rcp_f32 v6, v6
    v_rcp_f32 v7, v7
    v_pk_mul_f32 v[66:67], v[66:67], v[74:75]
    v_rcp_f32 v8, v8
    v_rcp_f32 v9, v9
    v_pk_mul_f32 v[68:69], v[68:69], v[76:77]
    v_rcp_f32 v10, v10
    v_rcp_f32 v11, v11
    v_pk_mul_f32 v[70:71], v[70:71], v[78:79]
    v_pk_mul_f32 v[64:65], v[64:65], v[2:3]
    v_pk_mul_f32 v[66:67], v[66:67], v[6:7]
    v_pk_mul_f32 v[68:69], v[68:69], v[8:9]
    v_pk_mul_f32 v[70:71], v[70:71], v[10:11]
    ds_read_b128 v[12:15], v4 offset:1024
    v_cvt_pk_bf16_f32 v72, v64, v65
    v_cvt_pk_bf16_f32 v73, v66, v67
    v_cvt_pk_bf16_f32 v74, v68, v69
    v_cvt_pk_bf16_f32 v75, v70, v71
    s_add_u32 s56, s62, 221184
    buffer_store_dwordx4 v[72:75], v5, s[48:51], s56 offen sc1
    s_waitcnt lgkmcnt(0)
    v_mov_b32 v176, v13
    v_mov_b32 v178, v15
    v_pk_fma_f32 v[80:81], v[12:13], v[224:225], v[80:81] op_sel_hi:[0,1,1]
    v_pk_fma_f32 v[82:83], v[12:13], v[226:227], v[82:83] op_sel_hi:[0,1,1]
    v_pk_fma_f32 v[84:85], v[12:13], v[228:229], v[84:85] op_sel_hi:[0,1,1]
    v_pk_fma_f32 v[86:87], v[12:13], v[230:231], v[86:87] op_sel_hi:[0,1,1]
    v_pk_mul_f32 v[2:3], v[80:81], v[80:81]
    v_pk_mul_f32 v[6:7], v[82:83], v[82:83]
    v_pk_mul_f32 v[8:9], v[84:85], v[84:85]
    v_pk_mul_f32 v[10:11], v[86:87], v[86:87]
    v_pk_fma_f32 v[2:3], v[2:3], v[14:15], v[176:177] op_sel_hi:[1,0,0]
    v_pk_fma_f32 v[6:7], v[6:7], v[14:15], v[176:177] op_sel_hi:[1,0,0]
    v_pk_fma_f32 v[8:9], v[8:9], v[14:15], v[176:177] op_sel_hi:[1,0,0]
    v_pk_fma_f32 v[10:11], v[10:11], v[14:15], v[176:177] op_sel_hi:[1,0,0]
    v_pk_mul_f32 v[2:3], v[2:3], v[80:81]
    v_pk_mul_f32 v[6:7], v[6:7], v[82:83]
    v_pk_mul_f32 v[8:9], v[8:9], v[84:85]
    v_pk_mul_f32 v[10:11], v[10:11], v[86:87]
    v_exp_f32 v2, v2
    v_exp_f32 v3, v3
    v_pk_fma_f32 v[88:89], v[12:13], v[232:233], v[88:89] op_sel_hi:[0,1,1]
    v_exp_f32 v6, v6
    v_exp_f32 v7, v7
    v_pk_fma_f32 v[90:91], v[12:13], v[234:235], v[90:91] op_sel_hi:[0,1,1]
    v_exp_f32 v8, v8
    v_exp_f32 v9, v9
    v_pk_fma_f32 v[92:93], v[12:13], v[236:237], v[92:93] op_sel_hi:[0,1,1]
    v_exp_f32 v10, v10
    v_exp_f32 v11, v11
    v_pk_fma_f32 v[94:95], v[12:13], v[238:239], v[94:95] op_sel_hi:[0,1,1]
    v_pk_fma_f32 v[2:3], v[2:3], v[178:179], v[178:179] op_sel_hi:[1,0,0]
    v_pk_fma_f32 v[6:7], v[6:7], v[178:179], v[178:179] op_sel_hi:[1,0,0]
    v_pk_fma_f32 v[8:9], v[8:9], v[178:179], v[178:179] op_sel_hi:[1,0,0]
    v_pk_fma_f32 v[10:11], v[10:11], v[178:179], v[178:179] op_sel_hi:[1,0,0]
    v_rcp_f32 v2, v2
    v_rcp_f32 v3, v3
    v_pk_mul_f32 v[80:81], v[80:81], v[88:89]
    v_rcp_f32 v6, v6
    v_rcp_f32 v7, v7
    v_pk_mul_f32 v[82:83], v[82:83], v[90:91]
    v_rcp_f32 v8, v8
    v_rcp_f32 v9, v9
    v_pk_mul_f32 v[84:85], v[84:85], v[92:93]
    v_rcp_f32 v10, v10
    v_rcp_f32 v11, v11
    v_pk_mul_f32 v[86:87], v[86:87], v[94:95]
    v_pk_mul_f32 v[80:81], v[80:81], v[2:3]
    v_pk_mul_f32 v[82:83], v[82:83], v[6:7]
    v_pk_mul_f32 v[84:85], v[84:85], v[8:9]
    v_pk_mul_f32 v[86:87], v[86:87], v[10:11]
    ds_read_b128 v[12:15], v4 offset:1280
    v_cvt_pk_bf16_f32 v88, v80, v81
    v_cvt_pk_bf16_f32 v89, v82, v83
    v_cvt_pk_bf16_f32 v90, v84, v85
    v_cvt_pk_bf16_f32 v91, v86, v87
    s_add_u32 s56, s62, 294912
    buffer_store_dwordx4 v[88:91], v5, s[48:51], s56 offen sc1
    s_waitcnt lgkmcnt(0)
    v_mov_b32 v176, v13
    v_mov_b32 v178, v15
    v_pk_fma_f32 v[96:97], v[12:13], v[224:225], v[96:97] op_sel_hi:[0,1,1]
    v_pk_fma_f32 v[98:99], v[12:13], v[226:227], v[98:99] op_sel_hi:[0,1,1]
    v_pk_fma_f32 v[100:101], v[12:13], v[228:229], v[100:101] op_sel_hi:[0,1,1]
    v_pk_fma_f32 v[102:103], v[12:13], v[230:231], v[102:103] op_sel_hi:[0,1,1]
    v_pk_mul_f32 v[2:3], v[96:97], v[96:97]
    v_pk_mul_f32 v[6:7], v[98:99], v[98:99]
    v_pk_mul_f32 v[8:9], v[100:101], v[100:101]
    v_pk_mul_f32 v[10:11], v[102:103], v[102:103]
    v_pk_fma_f32 v[2:3], v[2:3], v[14:15], v[176:177] op_sel_hi:[1,0,0]
    v_pk_fma_f32 v[6:7], v[6:7], v[14:15], v[176:177] op_sel_hi:[1,0,0]
    v_pk_fma_f32 v[8:9], v[8:9], v[14:15], v[176:177] op_sel_hi:[1,0,0]
    v_pk_fma_f32 v[10:11], v[10:11], v[14:15], v[176:177] op_sel_hi:[1,0,0]
    v_pk_mul_f32 v[2:3], v[2:3], v[96:97]
    v_pk_mul_f32 v[6:7], v[6:7], v[98:99]
    v_pk_mul_f32 v[8:9], v[8:9], v[100:101]
    v_pk_mul_f32 v[10:11], v[10:11], v[102:103]
    v_exp_f32 v2, v2
    v_exp_f32 v3, v3
    v_pk_fma_f32 v[104:105], v[12:13], v[232:233], v[104:105] op_sel_hi:[0,1,1]
    v_exp_f32 v6, v6
    v_exp_f32 v7, v7
    v_pk_fma_f32 v[106:107], v[12:13], v[234:235], v[106:107] op_sel_hi:[0,1,1]
    v_exp_f32 v8, v8
    v_exp_f32 v9, v9
    v_pk_fma_f32 v[108:109], v[12:13], v[236:237], v[108:109] op_sel_hi:[0,1,1]
    v_exp_f32 v10, v10
    v_exp_f32 v11, v11
    v_pk_fma_f32 v[110:111], v[12:13], v[238:239], v[110:111] op_sel_hi:[0,1,1]
    v_pk_fma_f32 v[2:3], v[2:3], v[178:179], v[178:179] op_sel_hi:[1,0,0]
    v_pk_fma_f32 v[6:7], v[6:7], v[178:179], v[178:179] op_sel_hi:[1,0,0]
    v_pk_fma_f32 v[8:9], v[8:9], v[178:179], v[178:179] op_sel_hi:[1,0,0]
    v_pk_fma_f32 v[10:11], v[10:11], v[178:179], v[178:179] op_sel_hi:[1,0,0]
    v_rcp_f32 v2, v2
    v_rcp_f32 v3, v3
    v_pk_mul_f32 v[96:97], v[96:97], v[104:105]
    v_rcp_f32 v6, v6
    v_rcp_f32 v7, v7
    v_pk_mul_f32 v[98:99], v[98:99], v[106:107]
    v_rcp_f32 v8, v8
    v_rcp_f32 v9, v9
    v_pk_mul_f32 v[100:101], v[100:101], v[108:109]
    v_rcp_f32 v10, v10
    v_rcp_f32 v11, v11
    v_pk_mul_f32 v[102:103], v[102:103], v[110:111]
    v_pk_mul_f32 v[96:97], v[96:97], v[2:3]
    v_pk_mul_f32 v[98:99], v[98:99], v[6:7]
    v_pk_mul_f32 v[100:101], v[100:101], v[8:9]
    v_pk_mul_f32 v[102:103], v[102:103], v[10:11]
    v_cvt_pk_bf16_f32 v104, v96, v97
    v_cvt_pk_bf16_f32 v105, v98, v99
    v_cvt_pk_bf16_f32 v106, v100, v101
    v_cvt_pk_bf16_f32 v107, v102, v103
    s_add_u32 s56, s62, 368640
    buffer_store_dwordx4 v[104:107], v5, s[48:51], s56 offen sc1
    s_branch kF_join
kF_h1:
    ds_read_b128 v[112:115], v6 offset:0
    ds_read_b64_tr_b16 v[160:161], v8 offset:0
    ds_read_b64_tr_b16 v[162:163], v8 offset:1024
    ds_read_b64_tr_b16 v[164:165], v9 offset:0
    ds_read_b64_tr_b16 v[166:167], v9 offset:1024
    ds_read_b64_tr_b16 v[168:169], v8 offset:8192
    ds_read_b64_tr_b16 v[170:171], v8 offset:9216
    ds_read_b64_tr_b16 v[172:173], v9 offset:8192
    ds_read_b64_tr_b16 v[174:175], v9 offset:9216
    ds_read_b128 v[116:119], v6 offset:2048
    ds_read_b128 v[120:123], v6 offset:4096
    ds_read_b128 v[124:127], v6 offset:6144
    ds_read_b128 v[128:131], v6 offset:8192
    s_waitcnt vmcnt(5) lgkmcnt(0)
    s_barrier
    s_setprio 3
    v_mfma_f32_16x16x32_bf16 v[16:19], v[160:163], v[112:115], 0
    ds_read_b128 v[136:139], v7 offset:0
    v_mfma_f32_16x16x32_bf16 v[20:23], v[164:167], v[112:115], 0
    ds_read_b64_tr_b16 v[176:177], v8 offset:16384
    v_mfma_f32_16x16x32_bf16 v[24:27], v[168:171], v[112:115], 0
    ds_read_b64_tr_b16 v[178:179], v8 offset:17408
    v_mfma_f32_16x16x32_bf16 v[28:31], v[172:175], v[112:115], 0
    ds_read_b64_tr_b16 v[180:181], v9 offset:16384
    s_add_u32 m0, s13, 49152
    s_mov_b32 s56, 344064
    buffer_load_dwordx4 v2, s[40:43], s56 offen lds
    v_mfma_f32_16x16x32_bf16 v[32:35], v[160:163], v[116:119], 0
    ds_read_b64_tr_b16 v[182:183], v9 offset:17408
    s_setprio 2
    v_mfma_f32_16x16x32_bf16 v[36:39], v[164:167], v[116:119], 0
    ds_read_b64_tr_b16 v[184:185], v8 offset:24576
    v_mfma_f32_16x16x32_bf16 v[40:43], v[168:171], v[116:119], 0
    ds_read_b64_tr_b16 v[186:187], v8 offset:25600
    v_mfma_f32_16x16x32_bf16 v[44:47], v[172:175], v[116:119], 0
    ds_read_b64_tr_b16 v[188:189], v9 offset:24576
    s_add_u32 m0, s13, 57344
    s_mov_b32 s56, 344064
    buffer_load_dwordx4 v2, s[44:47], s56 offen lds
    v_mfma_f32_16x16x32_bf16 v[48:51], v[160:163], v[120:123], 0
    ds_read_b64_tr_b16 v[190:191], v9 offset:25600
    v_mfma_f32_16x16x32_bf16 v[52:55], v[164:167], v[120:123], 0
    ds_read_b128 v[140:143], v7 offset:2048
    s_setprio 1
    v_mfma_f32_16x16x32_bf16 v[56:59], v[168:171], v[120:123], 0
    ds_read_b128 v[144:147], v7 offset:4096
    v_mfma_f32_16x16x32_bf16 v[60:63], v[172:175], v[120:123], 0
    ds_read_b128 v[148:151], v7 offset:6144
    s_add_u32 m0, s13, 65536
    s_mov_b32 s56, 458752
    buffer_load_dwordx4 v2, s[40:43], s56 offen lds
    v_mfma_f32_16x16x32_bf16 v[64:67], v[160:163], v[124:127], 0
    ds_read_b128 v[152:155], v7 offset:8192
    v_mfma_f32_16x16x32_bf16 v[68:71], v[164:167], v[124:127], 0
    v_mfma_f32_16x16x32_bf16 v[72:75], v[168:171], v[124:127], 0
    s_setprio 0
    v_mfma_f32_16x16x32_bf16 v[76:79], v[172:175], v[124:127], 0
    s_add_u32 m0, s13, 73728
    s_mov_b32 s56, 458752
    buffer_load_dwordx4 v2, s[44:47], s56 offen lds
    v_mfma_f32_16x16x32_bf16 v[80:83], v[160:163], v[128:131], 0
    v_mfma_f32_16x16x32_bf16 v[84:87], v[164:167], v[128:131], 0
    v_mfma_f32_16x16x32_bf16 v[88:91], v[168:171], v[128:131], 0
    v_mfma_f32_16x16x32_bf16 v[92:95], v[172:175], v[128:131], 0
    v_mov_b32 v14, 0
    buffer_load_dwordx2 v[12:13], v14, s[96:99], 0 offen sc0 sc1
    s_waitcnt vmcnt(5) lgkmcnt(0)
    s_barrier
    s_setprio 3
    v_mfma_f32_16x16x32_bf16 v[16:19], v[176:179], v[136:139], v[16:19]
    ds_read_b128 v[112:115], v6 offset:22528
    v_mfma_f32_16x16x32_bf16 v[20:23], v[180:183], v[136:139], v[20:23]
    ds_read_b64_tr_b16 v[160:161], v8 offset:32768
    v_mfma_f32_16x16x32_bf16 v[24:27], v[184:187], v[136:139], v[24:27]
    ds_read_b64_tr_b16 v[162:163], v8 offset:33792
    v_mfma_f32_16x16x32_bf16 v[28:31], v[188:191], v[136:139], v[28:31]
    ds_read_b64_tr_b16 v[164:165], v9 offset:32768
    v_mfma_f32_16x16x32_bf16 v[32:35], v[176:179], v[140:143], v[32:35]
    ds_read_b64_tr_b16 v[166:167], v9 offset:33792
    s_add_u32 m0, s13, 126976
    s_mov_b32 s56, 256
    s_mov_b64 exec, s[80:81]
    buffer_load_dwordx4 v4, s[36:39], s56 offen lds
    s_mov_b64 exec, -1
    s_setprio 2
    v_mfma_f32_16x16x32_bf16 v[36:39], v[180:183], v[140:143], v[36:39]
    ds_read_b64_tr_b16 v[168:169], v8 offset:40960
    v_mfma_f32_16x16x32_bf16 v[40:43], v[184:187], v[140:143], v[40:43]
    ds_read_b64_tr_b16 v[170:171], v8 offset:41984
    v_mfma_f32_16x16x32_bf16 v[44:47], v[188:191], v[140:143], v[44:47]
    ds_read_b64_tr_b16 v[172:173], v9 offset:40960
    v_mfma_f32_16x16x32_bf16 v[48:51], v[176:179], v[144:147], v[48:51]
    ds_read_b64_tr_b16 v[174:175], v9 offset:41984
    v_mfma_f32_16x16x32_bf16 v[52:55], v[180:183], v[144:147], v[52:55]
    ds_read_b128 v[116:119], v6 offset:24576
    s_add_u32 m0, s13, 135168
    s_add_u32 s56, s63, 256
    s_mov_b64 exec, s[82:83]
    buffer_load_dwordx4 v5, s[36:39], s56 offen lds
    s_mov_b64 exec, -1
    s_setprio 1
    v_mfma_f32_16x16x32_bf16 v[56:59], v[184:187], v[144:147], v[56:59]
    ds_read_b128 v[120:123], v6 offset:26624
    v_mfma_f32_16x16x32_bf16 v[60:63], v[188:191], v[144:147], v[60:63]
    ds_read_b128 v[124:127], v6 offset:28672
    v_mfma_f32_16x16x32_bf16 v[64:67], v[176:179], v[148:151], v[64:67]
    ds_read_b128 v[128:131], v6 offset:30720
    v_mfma_f32_16x16x32_bf16 v[68:71], v[180:183], v[148:151], v[68:71]
    v_mfma_f32_16x16x32_bf16 v[72:75], v[184:187], v[148:151], v[72:75]
    s_mul_i32 s56, s66, 2
    s_add_u32 m0, s65, s56
    s_add_u32 s56, s64, 256
    buffer_load_dwordx4 v5, s[36:39], s56 offen lds
    s_setprio 0
    v_mfma_f32_16x16x32_bf16 v[76:79], v[188:191], v[148:151], v[76:79]
    v_mfma_f32_16x16x32_bf16 v[80:83], v[176:179], v[152:155], v[80:83]
    v_mfma_f32_16x16x32_bf16 v[84:87], v[180:183], v[152:155], v[84:87]
    v_mfma_f32_16x16x32_bf16 v[88:91], v[184:187], v[152:155], v[88:91]
    v_mfma_f32_16x16x32_bf16 v[92:95], v[188:191], v[152:155], v[92:95]
    s_add_u32 m0, s13, 0
    s_mov_b32 s56, 573440
    buffer_load_dwordx4 v2, s[40:43], s56 offen lds
    s_waitcnt vmcnt(7) lgkmcnt(0)
    s_barrier
    s_setprio 3
    v_mfma_f32_16x16x32_bf16 v[16:19], v[160:163], v[112:115], v[16:19]
    ds_read_b128 v[136:139], v7 offset:22528
    v_mfma_f32_16x16x32_bf16 v[20:23], v[164:167], v[112:115], v[20:23]
    ds_read_b64_tr_b16 v[176:177], v10 offset:0
    v_mfma_f32_16x16x32_bf16 v[24:27], v[168:171], v[112:115], v[24:27]
    ds_read_b64_tr_b16 v[178:179], v10 offset:1024
    v_mfma_f32_16x16x32_bf16 v[28:31], v[172:175], v[112:115], v[28:31]
    ds_read_b64_tr_b16 v[180:181], v11 offset:0
    v_mfma_f32_16x16x32_bf16 v[32:35], v[160:163], v[116:119], v[32:35]
    ds_read_b64_tr_b16 v[182:183], v11 offset:1024
    s_add_u32 m0, s13, 8192
    s_mov_b32 s56, 573440
    buffer_load_dwordx4 v2, s[44:47], s56 offen lds
    s_setprio 2
    v_mfma_f32_16x16x32_bf16 v[36:39], v[164:167], v[116:119], v[36:39]
    ds_read_b64_tr_b16 v[184:185], v10 offset:8192
    v_mfma_f32_16x16x32_bf16 v[40:43], v[168:171], v[116:119], v[40:43]
    ds_read_b64_tr_b16 v[186:187], v10 offset:9216
    v_mfma_f32_16x16x32_bf16 v[44:47], v[172:175], v[116:119], v[44:47]
    ds_read_b64_tr_b16 v[188:189], v11 offset:8192
    v_mfma_f32_16x16x32_bf16 v[48:51], v[160:163], v[120:123], v[48:51]
    ds_read_b64_tr_b16 v[190:191], v11 offset:9216
    v_mfma_f32_16x16x32_bf16 v[52:55], v[164:167], v[120:123], v[52:55]
    ds_read_b128 v[140:143], v7 offset:24576
    s_add_u32 m0, s13, 16384
    s_mov_b32 s56, 688128
    buffer_load_dwordx4 v2, s[40:43], s56 offen lds
    s_setprio 1
    v_mfma_f32_16x16x32_bf16 v[56:59], v[168:171], v[120:123], v[56:59]
    ds_read_b128 v[144:147], v7 offset:26624
    v_mfma_f32_16x16x32_bf16 v[60:63], v[172:175], v[120:123], v[60:63]
    ds_read_b128 v[148:151], v7 offset:28672
    v_mfma_f32_16x16x32_bf16 v[64:67], v[160:163], v[124:127], v[64:67]
    ds_read_b128 v[152:155], v7 offset:30720
    v_mfma_f32_16x16x32_bf16 v[68:71], v[164:167], v[124:127], v[68:71]
    v_mfma_f32_16x16x32_bf16 v[72:75], v[168:171], v[124:127], v[72:75]
    s_add_u32 m0, s13, 24576
    s_mov_b32 s56, 688128
    buffer_load_dwordx4 v2, s[44:47], s56 offen lds
    s_setprio 0
    v_mfma_f32_16x16x32_bf16 v[76:79], v[172:175], v[124:127], v[76:79]
    v_mfma_f32_16x16x32_bf16 v[80:83], v[160:163], v[128:131], v[80:83]
    v_mfma_f32_16x16x32_bf16 v[84:87], v[164:167], v[128:131], v[84:87]
    v_mfma_f32_16x16x32_bf16 v[88:91], v[168:171], v[128:131], v[88:91]
    v_mfma_f32_16x16x32_bf16 v[92:95], v[172:175], v[128:131], v[92:95]
    s_add_u32 m0, s13, 81920
    s_mov_b32 s56, 384
    s_mov_b64 exec, s[80:81]
    buffer_load_dwordx4 v4, s[36:39], s56 offen lds
    s_mov_b64 exec, -1
    s_waitcnt vmcnt(5) lgkmcnt(0)
    s_barrier
    s_setprio 3
    v_mfma_f32_16x16x32_bf16 v[16:19], v[176:179], v[136:139], v[16:19]
    ds_read_b128 v[112:115], v6 offset:45056
    v_mfma_f32_16x16x32_bf16 v[20:23], v[180:183], v[136:139], v[20:23]
    ds_read_b64_tr_b16 v[160:161], v10 offset:16384
    v_mfma_f32_16x16x32_bf16 v[24:27], v[184:187], v[136:139], v[24:27]
    ds_read_b64_tr_b16 v[162:163], v10 offset:17408
    v_mfma_f32_16x16x32_bf16 v[28:31], v[188:191], v[136:139], v[28:31]
    ds_read_b64_tr_b16 v[164:165], v11 offset:16384
    v_readfirstlane_b32 s68, v12
    v_readfirstlane_b32 s69, v13
    s_cmp_lg_u32 s68, 0
    s_cbranch_scc1 kk_nok_6
    s_mov_b32 s57, 0
kk_nsp_7:
    s_sleep 2
    buffer_load_dwordx2 v[12:13], v14, s[96:99], 0 offen sc0 sc1
    s_add_u32 s57, s57, 1
    s_waitcnt vmcnt(0)
    v_readfirstlane_b32 s68, v12
    v_readfirstlane_b32 s69, v13
    s_cmp_lg_u32 s68, 0
    s_cbranch_scc1 kk_nok_6
    s_cmp_lt_u32 s57, 32768
    s_cbranch_scc1 kk_nsp_7
kk_nok_6:
    s_lshl_b32 s56, s2, 3
    s_add_u32 s56, s56, s12
    s_lshl_b32 s56, s56, 4
    s_add_u32 s56, s56, 10485760
    v_mov_b32 v230, s68
    v_mov_b32 v231, s69
    s_mov_b64 exec, 1
    buffer_store_dwordx4 v[228:231], v14, s[48:51], s56 offen sc0 sc1
    s_mov_b64 exec, -1
    v_mfma_f32_16x16x32_bf16 v[32:35], v[176:179], v[140:143], v[32:35]
    ds_read_b64_tr_b16 v[166:167], v11 offset:17408
    s_setprio 2
    v_mfma_f32_16x16x32_bf16 v[36:39], v[180:183], v[140:143], v[36:39]
    ds_read_b64_tr_b16 v[168:169], v10 offset:24576
    v_mfma_f32_16x16x32_bf16 v[40:43], v[184:187], v[140:143], v[40:43]
    ds_read_b64_tr_b16 v[170:171], v10 offset:25600
    v_mfma_f32_16x16x32_bf16 v[44:47], v[188:191], v[140:143], v[44:47]
    ds_read_b64_tr_b16 v[172:173], v11 offset:24576
    s_add_u32 m0, s13, 90112
    s_add_u32 s56, s63, 384
    s_mov_b64 exec, s[82:83]
    buffer_load_dwordx4 v5, s[36:39], s56 offen lds
    s_mov_b64 exec, -1
    v_mfma_f32_16x16x32_bf16 v[48:51], v[176:179], v[144:147], v[48:51]
    ds_read_b64_tr_b16 v[174:175], v11 offset:25600
    v_mfma_f32_16x16x32_bf16 v[52:55], v[180:183], v[144:147], v[52:55]
    ds_read_b128 v[116:119], v6 offset:47104
    s_setprio 1
    v_mfma_f32_16x16x32_bf16 v[56:59], v[184:187], v[144:147], v[56:59]
    ds_read_b128 v[120:123], v6 offset:49152
    v_mfma_f32_16x16x32_bf16 v[60:63], v[188:191], v[144:147], v[60:63]
    ds_read_b128 v[124:127], v6 offset:51200
    s_mul_i32 s56, s66, 0
    s_add_u32 m0, s65, s56
    s_add_u32 s56, s64, 384
    buffer_load_dwordx4 v5, s[36:39], s56 offen lds
    v_mfma_f32_16x16x32_bf16 v[64:67], v[176:179], v[148:151], v[64:67]
    ds_read_b128 v[128:131], v6 offset:53248
    v_mfma_f32_16x16x32_bf16 v[68:71], v[180:183], v[148:151], v[68:71]
    v_mfma_f32_16x16x32_bf16 v[72:75], v[184:187], v[148:151], v[72:75]
    s_setprio 0
    v_mfma_f32_16x16x32_bf16 v[76:79], v[188:191], v[148:151], v[76:79]
    s_add_u32 m0, s13, 32768
    s_mov_b32 s56, 802816
    buffer_load_dwordx4 v2, s[40:43], s56 offen lds
    v_mfma_f32_16x16x32_bf16 v[80:83], v[176:179], v[152:155], v[80:83]
    v_mfma_f32_16x16x32_bf16 v[84:87], v[180:183], v[152:155], v[84:87]
    v_mfma_f32_16x16x32_bf16 v[88:91], v[184:187], v[152:155], v[88:91]
    v_mfma_f32_16x16x32_bf16 v[92:95], v[188:191], v[152:155], v[92:95]
    s_add_u32 m0, s13, 40960
    s_mov_b32 s56, 802816
    buffer_load_dwordx4 v2, s[44:47], s56 offen lds
    s_waitcnt vmcnt(8) lgkmcnt(0)
    s_barrier
    s_setprio 3
    v_mfma_f32_16x16x32_bf16 v[16:19], v[160:163], v[112:115], v[16:19]
    ds_read_b128 v[136:139], v7 offset:45056
    v_mfma_f32_16x16x32_bf16 v[20:23], v[164:167], v[112:115], v[20:23]
    ds_read_b64_tr_b16 v[176:177], v8 offset:0
    v_mfma_f32_16x16x32_bf16 v[24:27], v[168:171], v[112:115], v[24:27]
    ds_read_b64_tr_b16 v[178:179], v8 offset:1024
    v_mfma_f32_16x16x32_bf16 v[28:31], v[172:175], v[112:115], v[28:31]
    ds_read_b64_tr_b16 v[180:181], v9 offset:0
    v_mfma_f32_16x16x32_bf16 v[32:35], v[160:163], v[116:119], v[32:35]
    ds_read_b64_tr_b16 v[182:183], v9 offset:1024
    s_add_u32 m0, s13, 49152
    s_mov_b32 s56, 917504
    buffer_load_dwordx4 v2, s[40:43], s56 offen lds
    s_setprio 2
    v_mfma_f32_16x16x32_bf16 v[36:39], v[164:167], v[116:119], v[36:39]
    ds_read_b64_tr_b16 v[184:185], v8 offset:8192
    v_mfma_f32_16x16x32_bf16 v[40:43], v[168:171], v[116:119], v[40:43]
    ds_read_b64_tr_b16 v[186:187], v8 offset:9216
    v_mfma_f32_16x16x32_bf16 v[44:47], v[172:175], v[116:119], v[44:47]
    ds_read_b64_tr_b16 v[188:189], v9 offset:8192
    v_mfma_f32_16x16x32_bf16 v[48:51], v[160:163], v[120:123], v[48:51]
    ds_read_b64_tr_b16 v[190:191], v9 offset:9216
    v_mfma_f32_16x16x32_bf16 v[52:55], v[164:167], v[120:123], v[52:55]
    ds_read_b128 v[140:143], v7 offset:47104
    s_add_u32 m0, s13, 57344
    s_mov_b32 s56, 917504
    buffer_load_dwordx4 v2, s[44:47], s56 offen lds
    s_setprio 1
    v_mfma_f32_16x16x32_bf16 v[56:59], v[168:171], v[120:123], v[56:59]
    ds_read_b128 v[144:147], v7 offset:49152
    v_mfma_f32_16x16x32_bf16 v[60:63], v[172:175], v[120:123], v[60:63]
    ds_read_b128 v[148:151], v7 offset:51200
    v_mfma_f32_16x16x32_bf16 v[64:67], v[160:163], v[124:127], v[64:67]
    ds_read_b128 v[152:155], v7 offset:53248
    v_mfma_f32_16x16x32_bf16 v[68:71], v[164:167], v[124:127], v[68:71]
    v_mfma_f32_16x16x32_bf16 v[72:75], v[168:171], v[124:127], v[72:75]
    s_add_u32 m0, s13, 104448
    s_mov_b32 s56, 512
    s_mov_b64 exec, s[80:81]
    buffer_load_dwordx4 v4, s[36:39], s56 offen lds
    s_mov_b64 exec, -1
    s_setprio 0
    v_mfma_f32_16x16x32_bf16 v[76:79], v[172:175], v[124:127], v[76:79]
    v_mfma_f32_16x16x32_bf16 v[80:83], v[160:163], v[128:131], v[80:83]
    v_mfma_f32_16x16x32_bf16 v[84:87], v[164:167], v[128:131], v[84:87]
    v_mfma_f32_16x16x32_bf16 v[88:91], v[168:171], v[128:131], v[88:91]
    v_mfma_f32_16x16x32_bf16 v[92:95], v[172:175], v[128:131], v[92:95]
    s_add_u32 m0, s13, 112640
    s_add_u32 s56, s63, 512
    s_mov_b64 exec, s[82:83]
    buffer_load_dwordx4 v5, s[36:39], s56 offen lds
    s_mov_b64 exec, -1
    s_waitcnt vmcnt(6) lgkmcnt(0)
    s_barrier
    s_setprio 3
    v_mfma_f32_16x16x32_bf16 v[16:19], v[176:179], v[136:139], v[16:19]
    ds_read_b128 v[112:115], v6 offset:0
    v_mfma_f32_16x16x32_bf16 v[20:23], v[180:183], v[136:139], v[20:23]
    ds_read_b64_tr_b16 v[160:161], v8 offset:16384
    v_mfma_f32_16x16x32_bf16 v[24:27], v[184:187], v[136:139], v[24:27]
    ds_read_b64_tr_b16 v[162:163], v8 offset:17408
    v_mfma_f32_16x16x32_bf16 v[28:31], v[188:191], v[136:139], v[28:31]
    ds_read_b64_tr_b16 v[164:165], v9 offset:16384
    v_mfma_f32_16x16x32_bf16 v[32:35], v[176:179], v[140:143], v[32:35]
    ds_read_b64_tr_b16 v[166:167], v9 offset:17408
    s_mul_i32 s56, s66, 1
    s_add_u32 m0, s65, s56
    s_add_u32 s56, s64, 512
    buffer_load_dwordx4 v5, s[36:39], s56 offen lds
    s_setprio 2
    v_mfma_f32_16x16x32_bf16 v[36:39], v[180:183], v[140:143], v[36:39]
    ds_read_b64_tr_b16 v[168:169], v8 offset:24576
    v_mfma_f32_16x16x32_bf16 v[40:43], v[184:187], v[140:143], v[40:43]
    ds_read_b64_tr_b16 v[170:171], v8 offset:25600
    v_mfma_f32_16x16x32_bf16 v[44:47], v[188:191], v[140:143], v[44:47]
    ds_read_b64_tr_b16 v[172:173], v9 offset:24576
    v_mfma_f32_16x16x32_bf16 v[48:51], v[176:179], v[144:147], v[48:51]
    ds_read_b64_tr_b16 v[174:175], v9 offset:25600
    v_mfma_f32_16x16x32_bf16 v[52:55], v[180:183], v[144:147], v[52:55]
    ds_read_b128 v[116:119], v6 offset:2048
    s_add_u32 m0, s13, 65536
    s_mov_b32 s56, 1032192
    buffer_load_dwordx4 v2, s[40:43], s56 offen lds
    s_setprio 1
    v_mfma_f32_16x16x32_bf16 v[56:59], v[184:187], v[144:147], v[56:59]
    ds_read_b128 v[120:123], v6 offset:4096
    v_mfma_f32_16x16x32_bf16 v[60:63], v[188:191], v[144:147], v[60:63]
    ds_read_b128 v[124:127], v6 offset:6144
    v_mfma_f32_16x16x32_bf16 v[64:67], v[176:179], v[148:151], v[64:67]
    ds_read_b128 v[128:131], v6 offset:8192
    v_mfma_f32_16x16x32_bf16 v[68:71], v[180:183], v[148:151], v[68:71]
    v_mfma_f32_16x16x32_bf16 v[72:75], v[184:187], v[148:151], v[72:75]
    s_add_u32 m0, s13, 73728
    s_mov_b32 s56, 1032192
    buffer_load_dwordx4 v2, s[44:47], s56 offen lds
    s_setprio 0
    v_mfma_f32_16x16x32_bf16 v[76:79], v[188:191], v[148:151], v[76:79]
    v_mfma_f32_16x16x32_bf16 v[80:83], v[176:179], v[152:155], v[80:83]
    v_mfma_f32_16x16x32_bf16 v[84:87], v[180:183], v[152:155], v[84:87]
    v_mfma_f32_16x16x32_bf16 v[88:91], v[184:187], v[152:155], v[88:91]
    v_mfma_f32_16x16x32_bf16 v[92:95], v[188:191], v[152:155], v[92:95]
    s_add_u32 m0, s13, 0
    s_mov_b32 s56, 1146880
    buffer_load_dwordx4 v2, s[40:43], s56 offen lds
    s_waitcnt vmcnt(8) lgkmcnt(0)
    s_barrier
    s_setprio 3
    v_mfma_f32_16x16x32_bf16 v[16:19], v[160:163], v[112:115], v[16:19]
    ds_read_b128 v[136:139], v7 offset:0
    v_mfma_f32_16x16x32_bf16 v[20:23], v[164:167], v[112:115], v[20:23]
    ds_read_b64_tr_b16 v[176:177], v8 offset:32768
    v_mfma_f32_16x16x32_bf16 v[24:27], v[168:171], v[112:115], v[24:27]
    ds_read_b64_tr_b16 v[178:179], v8 offset:33792
    v_mfma_f32_16x16x32_bf16 v[28:31], v[172:175], v[112:115], v[28:31]
    ds_read_b64_tr_b16 v[180:181], v9 offset:32768
    v_mfma_f32_16x16x32_bf16 v[32:35], v[160:163], v[116:119], v[32:35]
    ds_read_b64_tr_b16 v[182:183], v9 offset:33792
    s_add_u32 m0, s13, 8192
    s_mov_b32 s56, 1146880
    buffer_load_dwordx4 v2, s[44:47], s56 offen lds
    s_setprio 2
    v_mfma_f32_16x16x32_bf16 v[36:39], v[164:167], v[116:119], v[36:39]
    ds_read_b64_tr_b16 v[184:185], v8 offset:40960
    v_mfma_f32_16x16x32_bf16 v[40:43], v[168:171], v[116:119], v[40:43]
    ds_read_b64_tr_b16 v[186:187], v8 offset:41984
    v_mfma_f32_16x16x32_bf16 v[44:47], v[172:175], v[116:119], v[44:47]
    ds_read_b64_tr_b16 v[188:189], v9 offset:40960
    v_mfma_f32_16x16x32_bf16 v[48:51], v[160:163], v[120:123], v[48:51]
    ds_read_b64_tr_b16 v[190:191], v9 offset:41984
    v_mfma_f32_16x16x32_bf16 v[52:55], v[164:167], v[120:123], v[52:55]
    ds_read_b128 v[140:143], v7 offset:2048
    s_add_u32 m0, s13, 126976
    s_mov_b32 s56, 640
    s_mov_b64 exec, s[80:81]
    buffer_load_dwordx4 v4, s[36:39], s56 offen lds
    s_mov_b64 exec, -1
    s_setprio 1
    v_mfma_f32_16x16x32_bf16 v[56:59], v[168:171], v[120:123], v[56:59]
    ds_read_b128 v[144:147], v7 offset:4096
    v_mfma_f32_16x16x32_bf16 v[60:63], v[172:175], v[120:123], v[60:63]
    ds_read_b128 v[148:151], v7 offset:6144
    v_mfma_f32_16x16x32_bf16 v[64:67], v[160:163], v[124:127], v[64:67]
    ds_read_b128 v[152:155], v7 offset:8192
    v_mfma_f32_16x16x32_bf16 v[68:71], v[164:167], v[124:127], v[68:71]
    v_mfma_f32_16x16x32_bf16 v[72:75], v[168:171], v[124:127], v[72:75]
    s_add_u32 m0, s13, 135168
    s_add_u32 s56, s63, 640
    s_mov_b64 exec, s[82:83]
    buffer_load_dwordx4 v5, s[36:39], s56 offen lds
    s_mov_b64 exec, -1
    s_setprio 0
    v_mfma_f32_16x16x32_bf16 v[76:79], v[172:175], v[124:127], v[76:79]
    v_mfma_f32_16x16x32_bf16 v[80:83], v[160:163], v[128:131], v[80:83]
    v_mfma_f32_16x16x32_bf16 v[84:87], v[164:167], v[128:131], v[84:87]
    v_mfma_f32_16x16x32_bf16 v[88:91], v[168:171], v[128:131], v[88:91]
    v_mfma_f32_16x16x32_bf16 v[92:95], v[172:175], v[128:131], v[92:95]
    s_mul_i32 s56, s66, 2
    s_add_u32 m0, s65, s56
    s_add_u32 s56, s64, 640
    buffer_load_dwordx4 v5, s[36:39], s56 offen lds
    s_waitcnt vmcnt(7) lgkmcnt(0)
    s_barrier
    s_setprio 3
    v_mfma_f32_16x16x32_bf16 v[16:19], v[176:179], v[136:139], v[16:19]
    ds_read_b128 v[112:115], v6 offset:22528
    v_mfma_f32_16x16x32_bf16 v[20:23], v[180:183], v[136:139], v[20:23]
    ds_read_b64_tr_b16 v[160:161], v10 offset:0
    v_mfma_f32_16x16x32_bf16 v[24:27], v[184:187], v[136:139], v[24:27]
    ds_read_b64_tr_b16 v[162:163], v10 offset:1024
    v_mfma_f32_16x16x32_bf16 v[28:31], v[188:191], v[136:139], v[28:31]
    ds_read_b64_tr_b16 v[164:165], v11 offset:0
    v_mfma_f32_16x16x32_bf16 v[32:35], v[176:179], v[140:143], v[32:35]
    ds_read_b64_tr_b16 v[166:167], v11 offset:1024
    s_add_u32 m0, s13, 16384
    s_mov_b32 s56, 1261568
    buffer_load_dwordx4 v2, s[40:43], s56 offen lds
    s_setprio 2
    v_mfma_f32_16x16x32_bf16 v[36:39], v[180:183], v[140:143], v[36:39]
    ds_read_b64_tr_b16 v[168:169], v10 offset:8192
    v_mfma_f32_16x16x32_bf16 v[40:43], v[184:187], v[140:143], v[40:43]
    ds_read_b64_tr_b16 v[170:171], v10 offset:9216
    v_mfma_f32_16x16x32_bf16 v[44:47], v[188:191], v[140:143], v[44:47]
    ds_read_b64_tr_b16 v[172:173], v11 offset:8192
    v_mfma_f32_16x16x32_bf16 v[48:51], v[176:179], v[144:147], v[48:51]
    ds_read_b64_tr_b16 v[174:175], v11 offset:9216
    v_mfma_f32_16x16x32_bf16 v[52:55], v[180:183], v[144:147], v[52:55]
    ds_read_b128 v[116:119], v6 offset:24576
    s_add_u32 m0, s13, 24576
    s_mov_b32 s56, 1261568
    buffer_load_dwordx4 v2, s[44:47], s56 offen lds
    s_setprio 1
    v_mfma_f32_16x16x32_bf16 v[56:59], v[184:187], v[144:147], v[56:59]
    ds_read_b128 v[120:123], v6 offset:26624
    v_mfma_f32_16x16x32_bf16 v[60:63], v[188:191], v[144:147], v[60:63]
    ds_read_b128 v[124:127], v6 offset:28672
    v_mfma_f32_16x16x32_bf16 v[64:67], v[176:179], v[148:151], v[64:67]
    ds_read_b128 v[128:131], v6 offset:30720
    v_mfma_f32_16x16x32_bf16 v[68:71], v[180:183], v[148:151], v[68:71]
    v_mfma_f32_16x16x32_bf16 v[72:75], v[184:187], v[148:151], v[72:75]
    s_add_u32 m0, s13, 32768
    s_mov_b32 s56, 1376256
    buffer_load_dwordx4 v2, s[40:43], s56 offen lds
    s_setprio 0
    v_mfma_f32_16x16x32_bf16 v[76:79], v[188:191], v[148:151], v[76:79]
    v_mfma_f32_16x16x32_bf16 v[80:83], v[176:179], v[152:155], v[80:83]
    v_mfma_f32_16x16x32_bf16 v[84:87], v[180:183], v[152:155], v[84:87]
    v_mfma_f32_16x16x32_bf16 v[88:91], v[184:187], v[152:155], v[88:91]
    v_mfma_f32_16x16x32_bf16 v[92:95], v[188:191], v[152:155], v[92:95]
    s_add_u32 m0, s13, 40960
    s_mov_b32 s56, 1376256
    buffer_load_dwordx4 v2, s[44:47], s56 offen lds
    s_waitcnt vmcnt(9) lgkmcnt(0)
    s_barrier
    s_setprio 3
    v_mfma_f32_16x16x32_bf16 v[16:19], v[160:163], v[112:115], v[16:19]
    ds_read_b128 v[136:139], v7 offset:22528
    v_mfma_f32_16x16x32_bf16 v[20:23], v[164:167], v[112:115], v[20:23]
    ds_read_b64_tr_b16 v[176:177], v10 offset:16384
    v_mfma_f32_16x16x32_bf16 v[24:27], v[168:171], v[112:115], v[24:27]
    ds_read_b64_tr_b16 v[178:179], v10 offset:17408
    v_mfma_f32_16x16x32_bf16 v[28:31], v[172:175], v[112:115], v[28:31]
    ds_read_b64_tr_b16 v[180:181], v11 offset:16384
    v_mfma_f32_16x16x32_bf16 v[32:35], v[160:163], v[116:119], v[32:35]
    ds_read_b64_tr_b16 v[182:183], v11 offset:17408
    s_add_u32 m0, s13, 81920
    s_mov_b32 s56, 768
    s_mov_b64 exec, s[80:81]
    buffer_load_dwordx4 v4, s[36:39], s56 offen lds
    s_mov_b64 exec, -1
    s_setprio 2
    v_mfma_f32_16x16x32_bf16 v[36:39], v[164:167], v[116:119], v[36:39]
    ds_read_b64_tr_b16 v[184:185], v10 offset:24576
    v_mfma_f32_16x16x32_bf16 v[40:43], v[168:171], v[116:119], v[40:43]
    ds_read_b64_tr_b16 v[186:187], v10 offset:25600
    v_mfma_f32_16x16x32_bf16 v[44:47], v[172:175], v[116:119], v[44:47]
    ds_read_b64_tr_b16 v[188:189], v11 offset:24576
    v_mfma_f32_16x16x32_bf16 v[48:51], v[160:163], v[120:123], v[48:51]
    ds_read_b64_tr_b16 v[190:191], v11 offset:25600
    v_mfma_f32_16x16x32_bf16 v[52:55], v[164:167], v[120:123], v[52:55]
    ds_read_b128 v[140:143], v7 offset:24576
    s_add_u32 m0, s13, 90112
    s_add_u32 s56, s63, 768
    s_mov_b64 exec, s[82:83]
    buffer_load_dwordx4 v5, s[36:39], s56 offen lds
    s_mov_b64 exec, -1
    s_setprio 1
    v_mfma_f32_16x16x32_bf16 v[56:59], v[168:171], v[120:123], v[56:59]
    ds_read_b128 v[144:147], v7 offset:26624
    v_mfma_f32_16x16x32_bf16 v[60:63], v[172:175], v[120:123], v[60:63]
    ds_read_b128 v[148:151], v7 offset:28672
    v_mfma_f32_16x16x32_bf16 v[64:67], v[160:163], v[124:127], v[64:67]
    ds_read_b128 v[152:155], v7 offset:30720
    v_mfma_f32_16x16x32_bf16 v[68:71], v[164:167], v[124:127], v[68:71]
    v_mfma_f32_16x16x32_bf16 v[72:75], v[168:171], v[124:127], v[72:75]
    s_mul_i32 s56, s66, 0
    s_add_u32 m0, s65, s56
    s_add_u32 s56, s64, 768
    buffer_load_dwordx4 v5, s[36:39], s56 offen lds
    s_setprio 0
    v_mfma_f32_16x16x32_bf16 v[76:79], v[172:175], v[124:127], v[76:79]
    v_mfma_f32_16x16x32_bf16 v[80:83], v[160:163], v[128:131], v[80:83]
    v_mfma_f32_16x16x32_bf16 v[84:87], v[164:167], v[128:131], v[84:87]
    v_mfma_f32_16x16x32_bf16 v[88:91], v[168:171], v[128:131], v[88:91]
    v_mfma_f32_16x16x32_bf16 v[92:95], v[172:175], v[128:131], v[92:95]
    s_add_u32 m0, s13, 49152
    s_mov_b32 s56, 1490944
    buffer_load_dwordx4 v2, s[40:43], s56 offen lds
    s_waitcnt vmcnt(8) lgkmcnt(0)
    s_barrier
    s_setprio 3
    v_mfma_f32_16x16x32_bf16 v[16:19], v[176:179], v[136:139], v[16:19]
    ds_read_b128 v[112:115], v6 offset:45056
    v_mfma_f32_16x16x32_bf16 v[20:23], v[180:183], v[136:139], v[20:23]
    ds_read_b64_tr_b16 v[160:161], v8 offset:0
    v_mfma_f32_16x16x32_bf16 v[24:27], v[184:187], v[136:139], v[24:27]
    ds_read_b64_tr_b16 v[162:163], v8 offset:1024
    v_mfma_f32_16x16x32_bf16 v[28:31], v[188:191], v[136:139], v[28:31]
    ds_read_b64_tr_b16 v[164:165], v9 offset:0
    s_add_u32 s77, s77, 1
    s_cmp_eq_u32 s77, 7
    s_cselect_b32 s77, 0, s77
    s_mul_i32 s67, s77, 28672
    s_add_u32 s67, s67, s78
    s_lshl_b32 s9, s12, 12
    s_add_u32 s9, s9, s7
    s_add_u32 m0, s9, 0
    s_add_u32 s56, s67, 0
    buffer_load_dwordx4 v244, s[52:55], s56 offen lds
    v_mfma_f32_16x16x32_bf16 v[32:35], v[176:179], v[140:143], v[32:35]
    ds_read_b64_tr_b16 v[166:167], v9 offset:1024
    s_setprio 2
    v_mfma_f32_16x16x32_bf16 v[36:39], v[180:183], v[140:143], v[36:39]
    ds_read_b64_tr_b16 v[168:169], v8 offset:8192
    v_mfma_f32_16x16x32_bf16 v[40:43], v[184:187], v[140:143], v[40:43]
    ds_read_b64_tr_b16 v[170:171], v8 offset:9216
    s_add_u32 m0, s9, 1024
    s_add_u32 s56, s67, 7168
    buffer_load_dwordx4 v244, s[52:55], s56 offen lds
    v_mfma_f32_16x16x32_bf16 v[44:47], v[188:191], v[140:143], v[44:47]
    ds_read_b64_tr_b16 v[172:173], v9 offset:8192
    v_mfma_f32_16x16x32_bf16 v[48:51], v[176:179], v[144:147], v[48:51]
    ds_read_b64_tr_b16 v[174:175], v9 offset:9216
    v_mfma_f32_16x16x32_bf16 v[52:55], v[180:183], v[144:147], v[52:55]
    ds_read_b128 v[116:119], v6 offset:47104
    s_add_u32 m0, s9, 2048
    s_add_u32 s56, s67, 14336
    buffer_load_dwordx4 v244, s[52:55], s56 offen lds
    s_setprio 1
    v_mfma_f32_16x16x32_bf16 v[56:59], v[184:187], v[144:147], v[56:59]
    ds_read_b128 v[120:123], v6 offset:49152
    v_mfma_f32_16x16x32_bf16 v[60:63], v[188:191], v[144:147], v[60:63]
    ds_read_b128 v[124:127], v6 offset:51200
    v_mfma_f32_16x16x32_bf16 v[64:67], v[176:179], v[148:151], v[64:67]
    ds_read_b128 v[128:131], v6 offset:53248
    v_mfma_f32_16x16x32_bf16 v[68:71], v[180:183], v[148:151], v[68:71]
    s_add_u32 m0, s9, 3072
    s_add_u32 s56, s67, 21504
    buffer_load_dwordx4 v244, s[52:55], s56 offen lds
    v_mfma_f32_16x16x32_bf16 v[72:75], v[184:187], v[148:151], v[72:75]
    s_setprio 0
    v_mfma_f32_16x16x32_bf16 v[76:79], v[188:191], v[148:151], v[76:79]
    v_mfma_f32_16x16x32_bf16 v[80:83], v[176:179], v[152:155], v[80:83]
    s_add_u32 m0, s13, 57344
    s_mov_b32 s56, 1490944
    buffer_load_dwordx4 v2, s[44:47], s56 offen lds
    v_mfma_f32_16x16x32_bf16 v[84:87], v[180:183], v[152:155], v[84:87]
    v_mfma_f32_16x16x32_bf16 v[88:91], v[184:187], v[152:155], v[88:91]
    v_mfma_f32_16x16x32_bf16 v[92:95], v[188:191], v[152:155], v[92:95]
    buffer_load_dwordx4 v[12:15], v248, s[48:51], 0 offen sc0 sc1
    s_waitcnt vmcnt(12) lgkmcnt(0)
    s_barrier
    s_setprio 3
    v_mfma_f32_16x16x32_bf16 v[16:19], v[160:163], v[112:115], v[16:19]
    ds_read_b128 v[136:139], v7 offset:45056
    v_mfma_f32_16x16x32_bf16 v[20:23], v[164:167], v[112:115], v[20:23]
    ds_read_b64_tr_b16 v[176:177], v8 offset:16384
    v_mfma_f32_16x16x32_bf16 v[24:27], v[168:171], v[112:115], v[24:27]
    ds_read_b64_tr_b16 v[178:179], v8 offset:17408
    v_mfma_f32_16x16x32_bf16 v[28:31], v[172:175], v[112:115], v[28:31]
    ds_read_b64_tr_b16 v[180:181], v9 offset:16384
    v_mfma_f32_16x16x32_bf16 v[32:35], v[160:163], v[116:119], v[32:35]
    ds_read_b64_tr_b16 v[182:183], v9 offset:17408
    s_setprio 2
    v_mfma_f32_16x16x32_bf16 v[36:39], v[164:167], v[116:119], v[36:39]
    ds_read_b64_tr_b16 v[184:185], v8 offset:24576
    v_mfma_f32_16x16x32_bf16 v[40:43], v[168:171], v[116:119], v[40:43]
    ds_read_b64_tr_b16 v[186:187], v8 offset:25600
    v_mfma_f32_16x16x32_bf16 v[44:47], v[172:175], v[116:119], v[44:47]
    ds_read_b64_tr_b16 v[188:189], v9 offset:24576
    v_mfma_f32_16x16x32_bf16 v[48:51], v[160:163], v[120:123], v[48:51]
    ds_read_b64_tr_b16 v[190:191], v9 offset:25600
    v_mfma_f32_16x16x32_bf16 v[52:55], v[164:167], v[120:123], v[52:55]
    ds_read_b128 v[140:143], v7 offset:47104
    s_setprio 1
    v_mfma_f32_16x16x32_bf16 v[56:59], v[168:171], v[120:123], v[56:59]
    ds_read_b128 v[144:147], v7 offset:49152
    v_mfma_f32_16x16x32_bf16 v[60:63], v[172:175], v[120:123], v[60:63]
    ds_read_b128 v[148:151], v7 offset:51200
    v_mfma_f32_16x16x32_bf16 v[64:67], v[160:163], v[124:127], v[64:67]
    ds_read_b128 v[152:155], v7 offset:53248
    v_mfma_f32_16x16x32_bf16 v[68:71], v[164:167], v[124:127], v[68:71]
    v_mfma_f32_16x16x32_bf16 v[72:75], v[168:171], v[124:127], v[72:75]
    s_setprio 0
    v_mfma_f32_16x16x32_bf16 v[76:79], v[172:175], v[124:127], v[76:79]
    v_mfma_f32_16x16x32_bf16 v[80:83], v[160:163], v[128:131], v[80:83]
    v_mfma_f32_16x16x32_bf16 v[84:87], v[164:167], v[128:131], v[84:87]
    v_mfma_f32_16x16x32_bf16 v[88:91], v[168:171], v[128:131], v[88:91]
    v_mfma_f32_16x16x32_bf16 v[92:95], v[172:175], v[128:131], v[92:95]
    s_waitcnt vmcnt(7) lgkmcnt(0)
    s_barrier
    s_setprio 3
    v_mfma_f32_16x16x32_bf16 v[16:19], v[176:179], v[136:139], v[16:19]
    ds_read_b128 v[112:115], v6 offset:0
    v_mfma_f32_16x16x32_bf16 v[20:23], v[180:183], v[136:139], v[20:23]
    ds_read_b64_tr_b16 v[160:161], v8 offset:32768
    v_mfma_f32_16x16x32_bf16 v[24:27], v[184:187], v[136:139], v[24:27]
    ds_read_b64_tr_b16 v[162:163], v8 offset:33792
    v_mfma_f32_16x16x32_bf16 v[28:31], v[188:191], v[136:139], v[28:31]
    ds_read_b64_tr_b16 v[164:165], v9 offset:32768
    s_add_u32 s77, s77, 1
    s_cmp_eq_u32 s77, 7
    s_cselect_b32 s77, 0, s77
    s_mul_i32 s67, s77, 28672
    s_add_u32 s67, s67, s78
    s_lshl_b32 s9, s12, 12
    s_add_u32 s9, s9, 0
    s_add_u32 m0, s9, 0
    s_add_u32 s56, s67, 0
    buffer_load_dwordx4 v244, s[52:55], s56 offen lds
    v_mfma_f32_16x16x32_bf16 v[32:35], v[176:179], v[140:143], v[32:35]
    ds_read_b64_tr_b16 v[166:167], v9 offset:33792
    s_setprio 2
    v_mfma_f32_16x16x32_bf16 v[36:39], v[180:183], v[140:143], v[36:39]
    ds_read_b64_tr_b16 v[168:169], v8 offset:40960
    v_mfma_f32_16x16x32_bf16 v[40:43], v[184:187], v[140:143], v[40:43]
    ds_read_b64_tr_b16 v[170:171], v8 offset:41984
    v_mfma_f32_16x16x32_bf16 v[44:47], v[188:191], v[140:143], v[44:47]
    ds_read_b64_tr_b16 v[172:173], v9 offset:40960
    s_add_u32 m0, s9, 1024
    s_add_u32 s56, s67, 7168
    buffer_load_dwordx4 v244, s[52:55], s56 offen lds
    v_mfma_f32_16x16x32_bf16 v[48:51], v[176:179], v[144:147], v[48:51]
    ds_read_b64_tr_b16 v[174:175], v9 offset:41984
    v_mfma_f32_16x16x32_bf16 v[52:55], v[180:183], v[144:147], v[52:55]
    ds_read_b128 v[116:119], v6 offset:2048
    s_setprio 1
    v_mfma_f32_16x16x32_bf16 v[56:59], v[184:187], v[144:147], v[56:59]
    ds_read_b128 v[120:123], v6 offset:4096
    v_mfma_f32_16x16x32_bf16 v[60:63], v[188:191], v[144:147], v[60:63]
    ds_read_b128 v[124:127], v6 offset:6144
    s_add_u32 m0, s9, 2048
    s_add_u32 s56, s67, 14336
    buffer_load_dwordx4 v244, s[52:55], s56 offen lds
    v_mfma_f32_16x16x32_bf16 v[64:67], v[176:179], v[148:151], v[64:67]
    ds_read_b128 v[128:131], v6 offset:8192
    v_mfma_f32_16x16x32_bf16 v[68:71], v[180:183], v[148:151], v[68:71]
    v_mfma_f32_16x16x32_bf16 v[72:75], v[184:187], v[148:151], v[72:75]
    s_setprio 0
    v_mfma_f32_16x16x32_bf16 v[76:79], v[188:191], v[148:151], v[76:79]
    s_add_u32 m0, s9, 3072
    s_add_u32 s56, s67, 21504
    buffer_load_dwordx4 v244, s[52:55], s56 offen lds
    v_mfma_f32_16x16x32_bf16 v[80:83], v[176:179], v[152:155], v[80:83]
    v_mfma_f32_16x16x32_bf16 v[84:87], v[180:183], v[152:155], v[84:87]
    v_mfma_f32_16x16x32_bf16 v[88:91], v[184:187], v[152:155], v[88:91]
    v_mfma_f32_16x16x32_bf16 v[92:95], v[188:191], v[152:155], v[92:95]
    s_waitcnt vmcnt(4)
    v_cmp_ne_u64 vcc, s[68:69], v[14:15]
    s_and_b64 vcc, vcc, s[84:85]
    s_cbranch_scc0 kk_gok_8
    s_mov_b32 s57, 0
kk_gsp_9:
    s_sleep 2
    buffer_load_dwordx4 v[12:15], v248, s[48:51], 0 offen sc0 sc1
    s_add_u32 s57, s57, 1
    s_waitcnt vmcnt(0)
    v_cmp_ne_u64 vcc, s[68:69], v[14:15]
    s_and_b64 vcc, vcc, s[84:85]
    s_cbranch_scc0 kk_gok_8
    s_cmp_lt_u32 s57, 32768
    s_cbranch_scc1 kk_gsp_9
kk_gok_8:
    v_rcp_f32 v14, v13
    v_mul_f32 v15, v13, v13
    v_sub_f32 v12, 0, v12
    v_mul_f32 v13, 0xc0135761, v14
    v_mul_f32 v248, v14, v14
    v_mul_f32 v14, v14, v248
    v_mul_f32 v14, 0xbdd2d3e8, v14
    ds_write_b128 v249, v[12:15]
    s_waitcnt lgkmcnt(0)
    s_barrier
    s_setprio 3
    v_mfma_f32_16x16x32_bf16 v[16:19], v[160:163], v[112:115], v[16:19]
    ds_read_b128 v[136:139], v7 offset:0
    v_mfma_f32_16x16x32_bf16 v[20:23], v[164:167], v[112:115], v[20:23]
    ds_read_b64_tr_b16 v[176:177], v10 offset:0
    v_mfma_f32_16x16x32_bf16 v[24:27], v[168:171], v[112:115], v[24:27]
    ds_read_b64_tr_b16 v[178:179], v10 offset:1024
    v_mfma_f32_16x16x32_bf16 v[28:31], v[172:175], v[112:115], v[28:31]
    ds_read_b64_tr_b16 v[180:181], v11 offset:0
    v_mfma_f32_16x16x32_bf16 v[32:35], v[160:163], v[116:119], v[32:35]
    ds_read_b64_tr_b16 v[182:183], v11 offset:1024
    s_add_u32 s77, s77, 1
    s_cmp_eq_u32 s77, 7
    s_cselect_b32 s77, 0, s77
    s_mul_i32 s67, s77, 28672
    s_add_u32 s67, s67, s78
    s_lshl_b32 s9, s12, 12
    s_add_u32 s9, s9, s8
    s_add_u32 m0, s9, 0
    s_add_u32 s56, s67, 0
    buffer_load_dwordx4 v244, s[52:55], s56 offen lds
    s_setprio 2
    v_mfma_f32_16x16x32_bf16 v[36:39], v[164:167], v[116:119], v[36:39]
    ds_read_b64_tr_b16 v[184:185], v10 offset:8192
    v_mfma_f32_16x16x32_bf16 v[40:43], v[168:171], v[116:119], v[40:43]
    ds_read_b64_tr_b16 v[186:187], v10 offset:9216
    v_mfma_f32_16x16x32_bf16 v[44:47], v[172:175], v[116:119], v[44:47]
    ds_read_b64_tr_b16 v[188:189], v11 offset:8192
    v_mfma_f32_16x16x32_bf16 v[48:51], v[160:163], v[120:123], v[48:51]
    ds_read_b64_tr_b16 v[190:191], v11 offset:9216
    v_mfma_f32_16x16x32_bf16 v[52:55], v[164:167], v[120:123], v[52:55]
    ds_read_b128 v[140:143], v7 offset:2048
    s_add_u32 m0, s9, 1024
    s_add_u32 s56, s67, 7168
    buffer_load_dwordx4 v244, s[52:55], s56 offen lds
    s_setprio 1
    v_mfma_f32_16x16x32_bf16 v[56:59], v[168:171], v[120:123], v[56:59]
    ds_read_b128 v[144:147], v7 offset:4096
    v_mfma_f32_16x16x32_bf16 v[60:63], v[172:175], v[120:123], v[60:63]
    ds_read_b128 v[148:151], v7 offset:6144
    v_mfma_f32_16x16x32_bf16 v[64:67], v[160:163], v[124:127], v[64:67]
    ds_read_b128 v[152:155], v7 offset:8192
    v_mfma_f32_16x16x32_bf16 v[68:71], v[164:167], v[124:127], v[68:71]
    v_mfma_f32_16x16x32_bf16 v[72:75], v[168:171], v[124:127], v[72:75]
    s_add_u32 m0, s9, 2048
    s_add_u32 s56, s67, 14336
    buffer_load_dwordx4 v244, s[52:55], s56 offen lds
    s_setprio 0
    v_mfma_f32_16x16x32_bf16 v[76:79], v[172:175], v[124:127], v[76:79]
    v_mfma_f32_16x16x32_bf16 v[80:83], v[160:163], v[128:131], v[80:83]
    v_mfma_f32_16x16x32_bf16 v[84:87], v[164:167], v[128:131], v[84:87]
    v_mfma_f32_16x16x32_bf16 v[88:91], v[168:171], v[128:131], v[88:91]
    v_mfma_f32_16x16x32_bf16 v[92:95], v[172:175], v[128:131], v[92:95]
    s_add_u32 m0, s9, 3072
    s_add_u32 s56, s67, 21504
    buffer_load_dwordx4 v244, s[52:55], s56 offen lds
    s_waitcnt lgkmcnt(0)
    s_barrier
    s_setprio 3
    v_mfma_f32_16x16x32_bf16 v[16:19], v[176:179], v[136:139], v[16:19]
    v_mfma_f32_16x16x32_bf16 v[20:23], v[180:183], v[136:139], v[20:23]
    v_mfma_f32_16x16x32_bf16 v[24:27], v[184:187], v[136:139], v[24:27]
    v_mfma_f32_16x16x32_bf16 v[28:31], v[188:191], v[136:139], v[28:31]
    v_mfma_f32_16x16x32_bf16 v[32:35], v[176:179], v[140:143], v[32:35]
    s_add_u32 s77, s77, 1
    s_cmp_eq_u32 s77, 7
    s_cselect_b32 s77, 0, s77
    s_mul_i32 s67, s77, 28672
    s_add_u32 s67, s67, s78
    s_lshl_b32 s9, s12, 12
    s_add_u32 s9, s9, s10
    s_add_u32 m0, s9, 0
    s_add_u32 s56, s67, 0
    buffer_load_dwordx4 v244, s[52:55], s56 offen lds
    s_setprio 2
    v_mfma_f32_16x16x32_bf16 v[36:39], v[180:183], v[140:143], v[36:39]
    v_mfma_f32_16x16x32_bf16 v[40:43], v[184:187], v[140:143], v[40:43]
    v_mfma_f32_16x16x32_bf16 v[44:47], v[188:191], v[140:143], v[44:47]
    v_mfma_f32_16x16x32_bf16 v[48:51], v[176:179], v[144:147], v[48:51]
    v_mfma_f32_16x16x32_bf16 v[52:55], v[180:183], v[144:147], v[52:55]
    s_add_u32 m0, s9, 1024
    s_add_u32 s56, s67, 7168
    buffer_load_dwordx4 v244, s[52:55], s56 offen lds
    s_setprio 1
    v_mfma_f32_16x16x32_bf16 v[56:59], v[184:187], v[144:147], v[56:59]
    v_mfma_f32_16x16x32_bf16 v[60:63], v[188:191], v[144:147], v[60:63]
    v_mfma_f32_16x16x32_bf16 v[64:67], v[176:179], v[148:151], v[64:67]
    v_mfma_f32_16x16x32_bf16 v[68:71], v[180:183], v[148:151], v[68:71]
    v_mfma_f32_16x16x32_bf16 v[72:75], v[184:187], v[148:151], v[72:75]
    s_add_u32 m0, s9, 2048
    s_add_u32 s56, s67, 14336
    buffer_load_dwordx4 v244, s[52:55], s56 offen lds
    s_setprio 0
    v_mfma_f32_16x16x32_bf16 v[76:79], v[188:191], v[148:151], v[76:79]
    v_mfma_f32_16x16x32_bf16 v[80:83], v[176:179], v[152:155], v[80:83]
    v_mfma_f32_16x16x32_bf16 v[84:87], v[180:183], v[152:155], v[84:87]
    v_mfma_f32_16x16x32_bf16 v[88:91], v[184:187], v[152:155], v[88:91]
    v_mfma_f32_16x16x32_bf16 v[92:95], v[188:191], v[152:155], v[92:95]
    s_add_u32 m0, s9, 3072
    s_add_u32 s56, s67, 21504
    buffer_load_dwordx4 v244, s[52:55], s56 offen lds
    s_setprio 0
    s_barrier
    s_mov_b32 s40, s20
    s_mov_b32 s41, s21
    s_mov_b32 s42, 401408
    s_mov_b32 s43, 0x20000
    v_and_b32 v4, 15, v1
    v_lshlrev_b32 v4, 4, v4
    v_add_u32 v4, 151040, v4
    ds_read_b128 v[12:15], v4
    v_lshlrev_b32 v5, 4, v1
    s_mul_i32 s62, s14, 811008
    s_lshl_b32 s63, s15, 2
    s_and_b32 s56, s12, 3
    s_add_u32 s63, s63, s56
    s_lshl_b32 s63, s63, 10
    s_add_u32 s62, s62, s63
    s_add_u32 s62, s62, 442368
    s_lshl_b32 s63, s14, 7
    s_lshl_b32 s56, s15, 3
    s_add_u32 s63, s63, s56
    s_add_u32 s63, s63, 10551296
    v_mov_b32_dpp v224, v16 row_newbcast:0 row_mask:0xf bank_mask:0xf
    v_mov_b32_dpp v225, v17 row_newbcast:0 row_mask:0xf bank_mask:0xf
    v_mov_b32_dpp v226, v18 row_newbcast:0 row_mask:0xf bank_mask:0xf
    v_mov_b32_dpp v227, v19 row_newbcast:0 row_mask:0xf bank_mask:0xf
    v_mov_b32_dpp v228, v20 row_newbcast:0 row_mask:0xf bank_mask:0xf
    v_mov_b32_dpp v229, v21 row_newbcast:0 row_mask:0xf bank_mask:0xf
    v_mov_b32_dpp v230, v22 row_newbcast:0 row_mask:0xf bank_mask:0xf
    v_mov_b32_dpp v231, v23 row_newbcast:0 row_mask:0xf bank_mask:0xf
    v_mov_b32_dpp v232, v24 row_newbcast:0 row_mask:0xf bank_mask:0xf
    v_mov_b32_dpp v233, v25 row_newbcast:0 row_mask:0xf bank_mask:0xf
    v_mov_b32_dpp v234, v26 row_newbcast:0 row_mask:0xf bank_mask:0xf
    v_mov_b32_dpp v235, v27 row_newbcast:0 row_mask:0xf bank_mask:0xf
    v_mov_b32_dpp v236, v28 row_newbcast:0 row_mask:0xf bank_mask:0xf
    v_mov_b32_dpp v237, v29 row_newbcast:0 row_mask:0xf bank_mask:0xf
    v_mov_b32_dpp v238, v30 row_newbcast:0 row_mask:0xf bank_mask:0xf
    v_mov_b32_dpp v239, v31 row_newbcast:0 row_mask:0xf bank_mask:0xf
    s_waitcnt lgkmcnt(0)
    v_mov_b32 v176, v13
    v_mov_b32 v178, v15
    v_pk_fma_f32 v[16:17], v[12:13], v[224:225], v[16:17] op_sel_hi:[0,1,1]
    v_pk_fma_f32 v[18:19], v[12:13], v[226:227], v[18:19] op_sel_hi:[0,1,1]
    v_pk_fma_f32 v[20:21], v[12:13], v[228:229], v[20:21] op_sel_hi:[0,1,1]
    v_pk_fma_f32 v[22:23], v[12:13], v[230:231], v[22:23] op_sel_hi:[0,1,1]
    v_pk_mul_f32 v[2:3], v[16:17], v[16:17]
    v_pk_mul_f32 v[6:7], v[18:19], v[18:19]
    v_pk_mul_f32 v[8:9], v[20:21], v[20:21]
    v_pk_mul_f32 v[10:11], v[22:23], v[22:23]
    v_pk_fma_f32 v[2:3], v[2:3], v[14:15], v[176:177] op_sel_hi:[1,0,0]
    v_pk_fma_f32 v[6:7], v[6:7], v[14:15], v[176:177] op_sel_hi:[1,0,0]
    v_pk_fma_f32 v[8:9], v[8:9], v[14:15], v[176:177] op_sel_hi:[1,0,0]
    v_pk_fma_f32 v[10:11], v[10:11], v[14:15], v[176:177] op_sel_hi:[1,0,0]
    v_pk_mul_f32 v[2:3], v[2:3], v[16:17]
    v_pk_mul_f32 v[6:7], v[6:7], v[18:19]
    v_pk_mul_f32 v[8:9], v[8:9], v[20:21]
    v_pk_mul_f32 v[10:11], v[10:11], v[22:23]
    v_exp_f32 v2, v2
    v_exp_f32 v3, v3
    v_pk_fma_f32 v[24:25], v[12:13], v[232:233], v[24:25] op_sel_hi:[0,1,1]
    v_exp_f32 v6, v6
    v_exp_f32 v7, v7
    v_pk_fma_f32 v[26:27], v[12:13], v[234:235], v[26:27] op_sel_hi:[0,1,1]
    v_exp_f32 v8, v8
    v_exp_f32 v9, v9
    v_pk_fma_f32 v[28:29], v[12:13], v[236:237], v[28:29] op_sel_hi:[0,1,1]
    v_exp_f32 v10, v10
    v_exp_f32 v11, v11
    v_pk_fma_f32 v[30:31], v[12:13], v[238:239], v[30:31] op_sel_hi:[0,1,1]
    v_pk_fma_f32 v[2:3], v[2:3], v[178:179], v[178:179] op_sel_hi:[1,0,0]
    v_pk_fma_f32 v[6:7], v[6:7], v[178:179], v[178:179] op_sel_hi:[1,0,0]
    v_pk_fma_f32 v[8:9], v[8:9], v[178:179], v[178:179] op_sel_hi:[1,0,0]
    v_pk_fma_f32 v[10:11], v[10:11], v[178:179], v[178:179] op_sel_hi:[1,0,0]
    v_rcp_f32 v2, v2
    v_rcp_f32 v3, v3
    v_pk_mul_f32 v[16:17], v[16:17], v[24:25]
    v_rcp_f32 v6, v6
    v_rcp_f32 v7, v7
    v_pk_mul_f32 v[18:19], v[18:19], v[26:27]
    v_rcp_f32 v8, v8
    v_rcp_f32 v9, v9
    v_pk_mul_f32 v[20:21], v[20:21], v[28:29]
    v_rcp_f32 v10, v10
    v_rcp_f32 v11, v11
    v_pk_mul_f32 v[22:23], v[22:23], v[30:31]
    v_pk_mul_f32 v[16:17], v[16:17], v[2:3]
    v_pk_mul_f32 v[18:19], v[18:19], v[6:7]
    v_pk_mul_f32 v[20:21], v[20:21], v[8:9]
    v_pk_mul_f32 v[22:23], v[22:23], v[10:11]
    ds_read_b128 v[12:15], v4 offset:256
    v_cvt_pk_bf16_f32 v24, v16, v17
    v_cvt_pk_bf16_f32 v25, v18, v19
    v_cvt_pk_bf16_f32 v26, v20, v21
    v_cvt_pk_bf16_f32 v27, v22, v23
    s_add_u32 s56, s62, 0
    buffer_store_dwordx4 v[24:27], v5, s[48:51], s56 offen sc1
    s_waitcnt lgkmcnt(0)
    v_mov_b32 v176, v13
    v_mov_b32 v178, v15
    v_pk_fma_f32 v[32:33], v[12:13], v[224:225], v[32:33] op_sel_hi:[0,1,1]
    v_pk_fma_f32 v[34:35], v[12:13], v[226:227], v[34:35] op_sel_hi:[0,1,1]
    v_pk_fma_f32 v[36:37], v[12:13], v[228:229], v[36:37] op_sel_hi:[0,1,1]
    v_pk_fma_f32 v[38:39], v[12:13], v[230:231], v[38:39] op_sel_hi:[0,1,1]
    v_pk_mul_f32 v[2:3], v[32:33], v[32:33]
    v_pk_mul_f32 v[6:7], v[34:35], v[34:35]
    v_pk_mul_f32 v[8:9], v[36:37], v[36:37]
    v_pk_mul_f32 v[10:11], v[38:39], v[38:39]
    v_pk_fma_f32 v[2:3], v[2:3], v[14:15], v[176:177] op_sel_hi:[1,0,0]
    v_pk_fma_f32 v[6:7], v[6:7], v[14:15], v[176:177] op_sel_hi:[1,0,0]
    v_pk_fma_f32 v[8:9], v[8:9], v[14:15], v[176:177] op_sel_hi:[1,0,0]
    v_pk_fma_f32 v[10:11], v[10:11], v[14:15], v[176:177] op_sel_hi:[1,0,0]
    v_pk_mul_f32 v[2:3], v[2:3], v[32:33]
    v_pk_mul_f32 v[6:7], v[6:7], v[34:35]
    v_pk_mul_f32 v[8:9], v[8:9], v[36:37]
    v_pk_mul_f32 v[10:11], v[10:11], v[38:39]
    v_exp_f32 v2, v2
    v_exp_f32 v3, v3
    v_pk_fma_f32 v[40:41], v[12:13], v[232:233], v[40:41] op_sel_hi:[0,1,1]
    v_exp_f32 v6, v6
    v_exp_f32 v7, v7
    v_pk_fma_f32 v[42:43], v[12:13], v[234:235], v[42:43] op_sel_hi:[0,1,1]
    v_exp_f32 v8, v8
    v_exp_f32 v9, v9
    v_pk_fma_f32 v[44:45], v[12:13], v[236:237], v[44:45] op_sel_hi:[0,1,1]
    v_exp_f32 v10, v10
    v_exp_f32 v11, v11
    v_pk_fma_f32 v[46:47], v[12:13], v[238:239], v[46:47] op_sel_hi:[0,1,1]
    v_pk_fma_f32 v[2:3], v[2:3], v[178:179], v[178:179] op_sel_hi:[1,0,0]
    v_pk_fma_f32 v[6:7], v[6:7], v[178:179], v[178:179] op_sel_hi:[1,0,0]
    v_pk_fma_f32 v[8:9], v[8:9], v[178:179], v[178:179] op_sel_hi:[1,0,0]
    v_pk_fma_f32 v[10:11], v[10:11], v[178:179], v[178:179] op_sel_hi:[1,0,0]
    v_rcp_f32 v2, v2
    v_rcp_f32 v3, v3
    v_pk_mul_f32 v[32:33], v[32:33], v[40:41]
    v_rcp_f32 v6, v6
    v_rcp_f32 v7, v7
    v_pk_mul_f32 v[34:35], v[34:35], v[42:43]
    v_rcp_f32 v8, v8
    v_rcp_f32 v9, v9
    v_pk_mul_f32 v[36:37], v[36:37], v[44:45]
    v_rcp_f32 v10, v10
    v_rcp_f32 v11, v11
    v_pk_mul_f32 v[38:39], v[38:39], v[46:47]
    v_pk_mul_f32 v[32:33], v[32:33], v[2:3]
    v_pk_mul_f32 v[34:35], v[34:35], v[6:7]
    v_pk_mul_f32 v[36:37], v[36:37], v[8:9]
    v_pk_mul_f32 v[38:39], v[38:39], v[10:11]
    ds_read_b128 v[12:15], v4 offset:512
    v_cvt_pk_bf16_f32 v40, v32, v33
    v_cvt_pk_bf16_f32 v41, v34, v35
    v_cvt_pk_bf16_f32 v42, v36, v37
    v_cvt_pk_bf16_f32 v43, v38, v39
    s_add_u32 s56, s62, 73728
    buffer_store_dwordx4 v[40:43], v5, s[48:51], s56 offen sc1
    s_waitcnt lgkmcnt(7)
    v_add_u32 v240, s7, v246
    v_xor_b32 v241, 32, v240
    v_xor_b32 v242, 64, v240
    v_xor_b32 v243, 96, v240
    ds_read_b64_tr_b16 v[192:193], v240 offset:0
    ds_read_b64_tr_b16 v[194:195], v240 offset:2048
    ds_read_b64_tr_b16 v[196:197], v241 offset:0
    ds_read_b64_tr_b16 v[198:199], v241 offset:2048
    ds_read_b64_tr_b16 v[200:201], v242 offset:0
    ds_read_b64_tr_b16 v[202:203], v242 offset:2048
    ds_read_b64_tr_b16 v[204:205], v243 offset:0
    ds_read_b64_tr_b16 v[206:207], v243 offset:2048
    s_waitcnt vmcnt(10) lgkmcnt(7)
    v_add_u32 v240, 0, v246
    v_xor_b32 v241, 32, v240
    v_xor_b32 v242, 64, v240
    v_xor_b32 v243, 96, v240
    ds_read_b64_tr_b16 v[208:209], v240 offset:0
    ds_read_b64_tr_b16 v[210:211], v240 offset:2048
    ds_read_b64_tr_b16 v[212:213], v241 offset:0
    ds_read_b64_tr_b16 v[214:215], v241 offset:2048
    ds_read_b64_tr_b16 v[216:217], v242 offset:0
    ds_read_b64_tr_b16 v[218:219], v242 offset:2048
    ds_read_b64_tr_b16 v[220:221], v243 offset:0
    ds_read_b64_tr_b16 v[222:223], v243 offset:2048
    s_waitcnt lgkmcnt(0)
    v_mov_b32 v176, v13
    v_mov_b32 v178, v15
    v_pk_fma_f32 v[48:49], v[12:13], v[224:225], v[48:49] op_sel_hi:[0,1,1]
    s_add_u32 s77, s77, 1
    s_cmp_eq_u32 s77, 7
    s_cselect_b32 s77, 0, s77
    s_mul_i32 s67, s77, 28672
    s_add_u32 s67, s67, s78
    s_lshl_b32 s9, s12, 12
    s_add_u32 s9, s9, s7
    s_add_u32 m0, s9, 0
    s_add_u32 s56, s67, 0
    buffer_load_dwordx4 v244, s[52:55], s56 offen lds
    v_pk_fma_f32 v[50:51], v[12:13], v[226:227], v[50:51] op_sel_hi:[0,1,1]
    v_pk_fma_f32 v[52:53], v[12:13], v[228:229], v[52:53] op_sel_hi:[0,1,1]
    v_pk_fma_f32 v[54:55], v[12:13], v[230:231], v[54:55] op_sel_hi:[0,1,1]
    v_pk_mul_f32 v[2:3], v[48:49], v[48:49]
    v_pk_mul_f32 v[6:7], v[50:51], v[50:51]
    v_pk_mul_f32 v[8:9], v[52:53], v[52:53]
    s_add_u32 m0, s9, 1024
    s_add_u32 s56, s67, 7168
    buffer_load_dwordx4 v244, s[52:55], s56 offen lds
    v_pk_mul_f32 v[10:11], v[54:55], v[54:55]
    v_pk_fma_f32 v[2:3], v[2:3], v[14:15], v[176:177] op_sel_hi:[1,0,0]
    v_pk_fma_f32 v[6:7], v[6:7], v[14:15], v[176:177] op_sel_hi:[1,0,0]
    v_pk_fma_f32 v[8:9], v[8:9], v[14:15], v[176:177] op_sel_hi:[1,0,0]
    v_pk_fma_f32 v[10:11], v[10:11], v[14:15], v[176:177] op_sel_hi:[1,0,0]
    v_pk_mul_f32 v[2:3], v[2:3], v[48:49]
    s_add_u32 m0, s9, 2048
    s_add_u32 s56, s67, 14336
    buffer_load_dwordx4 v244, s[52:55], s56 offen lds
    v_pk_mul_f32 v[6:7], v[6:7], v[50:51]
    v_pk_mul_f32 v[8:9], v[8:9], v[52:53]
    v_pk_mul_f32 v[10:11], v[10:11], v[54:55]
    v_exp_f32 v2, v2
    v_exp_f32 v3, v3
    v_pk_fma_f32 v[56:57], v[12:13], v[232:233], v[56:57] op_sel_hi:[0,1,1]
    s_add_u32 m0, s9, 3072
    s_add_u32 s56, s67, 21504
    buffer_load_dwordx4 v244, s[52:55], s56 offen lds
    v_exp_f32 v6, v6
    v_exp_f32 v7, v7
    v_pk_fma_f32 v[58:59], v[12:13], v[234:235], v[58:59] op_sel_hi:[0,1,1]
    v_exp_f32 v8, v8
    v_exp_f32 v9, v9
    v_pk_fma_f32 v[60:61], v[12:13], v[236:237], v[60:61] op_sel_hi:[0,1,1]
    s_add_u32 s77, s77, 1
    s_cmp_eq_u32 s77, 7
    s_cselect_b32 s77, 0, s77
    s_mul_i32 s67, s77, 28672
    s_add_u32 s67, s67, s78
    s_lshl_b32 s9, s12, 12
    s_add_u32 s9, s9, 0
    s_add_u32 m0, s9, 0
    s_add_u32 s56, s67, 0
    buffer_load_dwordx4 v244, s[52:55], s56 offen lds
    v_exp_f32 v10, v10
    v_exp_f32 v11, v11
    v_pk_fma_f32 v[62:63], v[12:13], v[238:239], v[62:63] op_sel_hi:[0,1,1]
    v_pk_fma_f32 v[2:3], v[2:3], v[178:179], v[178:179] op_sel_hi:[1,0,0]
    v_pk_fma_f32 v[6:7], v[6:7], v[178:179], v[178:179] op_sel_hi:[1,0,0]
    v_pk_fma_f32 v[8:9], v[8:9], v[178:179], v[178:179] op_sel_hi:[1,0,0]
    s_add_u32 m0, s9, 1024
    s_add_u32 s56, s67, 7168
    buffer_load_dwordx4 v244, s[52:55], s56 offen lds
    v_pk_fma_f32 v[10:11], v[10:11], v[178:179], v[178:179] op_sel_hi:[1,0,0]
    v_rcp_f32 v2, v2
    v_rcp_f32 v3, v3
    v_pk_mul_f32 v[48:49], v[48:49], v[56:57]
    v_rcp_f32 v6, v6
    v_rcp_f32 v7, v7
    s_add_u32 m0, s9, 2048
    s_add_u32 s56, s67, 14336
    buffer_load_dwordx4 v244, s[52:55], s56 offen lds
    v_pk_mul_f32 v[50:51], v[50:51], v[58:59]
    v_rcp_f32 v8, v8
    v_rcp_f32 v9, v9
    v_pk_mul_f32 v[52:53], v[52:53], v[60:61]
    v_rcp_f32 v10, v10
    v_rcp_f32 v11, v11
    s_add_u32 m0, s9, 3072
    s_add_u32 s56, s67, 21504
    buffer_load_dwordx4 v244, s[52:55], s56 offen lds
    v_pk_mul_f32 v[54:55], v[54:55], v[62:63]
    v_pk_mul_f32 v[48:49], v[48:49], v[2:3]
    v_pk_mul_f32 v[50:51], v[50:51], v[6:7]
    v_pk_mul_f32 v[52:53], v[52:53], v[8:9]
    v_pk_mul_f32 v[54:55], v[54:55], v[10:11]
    ds_read_b128 v[12:15], v4 offset:768
    v_cvt_pk_bf16_f32 v56, v48, v49
    v_cvt_pk_bf16_f32 v57, v50, v51
    v_cvt_pk_bf16_f32 v58, v52, v53
    v_cvt_pk_bf16_f32 v59, v54, v55
    s_add_u32 s56, s62, 147456
    buffer_store_dwordx4 v[56:59], v5, s[48:51], s56 offen sc1
    s_waitcnt lgkmcnt(0)
    v_mov_b32 v176, v13
    v_mov_b32 v178, v15
    v_pk_fma_f32 v[64:65], v[12:13], v[224:225], v[64:65] op_sel_hi:[0,1,1]
    v_pk_fma_f32 v[66:67], v[12:13], v[226:227], v[66:67] op_sel_hi:[0,1,1]
    v_pk_fma_f32 v[68:69], v[12:13], v[228:229], v[68:69] op_sel_hi:[0,1,1]
    v_pk_fma_f32 v[70:71], v[12:13], v[230:231], v[70:71] op_sel_hi:[0,1,1]
    v_pk_mul_f32 v[2:3], v[64:65], v[64:65]
    v_pk_mul_f32 v[6:7], v[66:67], v[66:67]
    v_pk_mul_f32 v[8:9], v[68:69], v[68:69]
    v_pk_mul_f32 v[10:11], v[70:71], v[70:71]
    v_pk_fma_f32 v[2:3], v[2:3], v[14:15], v[176:177] op_sel_hi:[1,0,0]
    v_pk_fma_f32 v[6:7], v[6:7], v[14:15], v[176:177] op_sel_hi:[1,0,0]
    v_pk_fma_f32 v[8:9], v[8:9], v[14:15], v[176:177] op_sel_hi:[1,0,0]
    v_pk_fma_f32 v[10:11], v[10:11], v[14:15], v[176:177] op_sel_hi:[1,0,0]
    v_pk_mul_f32 v[2:3], v[2:3], v[64:65]
    v_pk_mul_f32 v[6:7], v[6:7], v[66:67]
    v_pk_mul_f32 v[8:9], v[8:9], v[68:69]
    v_pk_mul_f32 v[10:11], v[10:11], v[70:71]
    v_exp_f32 v2, v2
    v_exp_f32 v3, v3
    v_pk_fma_f32 v[72:73], v[12:13], v[232:233], v[72:73] op_sel_hi:[0,1,1]
    v_exp_f32 v6, v6
    v_exp_f32 v7, v7
    v_pk_fma_f32 v[74:75], v[12:13], v[234:235], v[74:75] op_sel_hi:[0,1,1]
    v_exp_f32 v8, v8
    v_exp_f32 v9, v9
    v_pk_fma_f32 v[76:77], v[12:13], v[236:237], v[76:77] op_sel_hi:[0,1,1]
    v_exp_f32 v10, v10
    v_exp_f32 v11, v11
    v_pk_fma_f32 v[78:79], v[12:13], v[238:239], v[78:79] op_sel_hi:[0,1,1]
    v_pk_fma_f32 v[2:3], v[2:3], v[178:179], v[178:179] op_sel_hi:[1,0,0]
    v_pk_fma_f32 v[6:7], v[6:7], v[178:179], v[178:179] op_sel_hi:[1,0,0]
    v_pk_fma_f32 v[8:9], v[8:9], v[178:179], v[178:179] op_sel_hi:[1,0,0]
    v_pk_fma_f32 v[10:11], v[10:11], v[178:179], v[178:179] op_sel_hi:[1,0,0]
    v_rcp_f32 v2, v2
    v_rcp_f32 v3, v3
    v_pk_mul_f32 v[64:65], v[64:65], v[72:73]
    v_rcp_f32 v6, v6
    v_rcp_f32 v7, v7
    v_pk_mul_f32 v[66:67], v[66:67], v[74:75]
    v_rcp_f32 v8, v8
    v_rcp_f32 v9, v9
    v_pk_mul_f32 v[68:69], v[68:69], v[76:77]
    v_rcp_f32 v10, v10
    v_rcp_f32 v11, v11
    v_pk_mul_f32 v[70:71], v[70:71], v[78:79]
    v_pk_mul_f32 v[64:65], v[64:65], v[2:3]
    v_pk_mul_f32 v[66:67], v[66:67], v[6:7]
    v_pk_mul_f32 v[68:69], v[68:69], v[8:9]
    v_pk_mul_f32 v[70:71], v[70:71], v[10:11]
    ds_read_b128 v[12:15], v4 offset:1024
    v_cvt_pk_bf16_f32 v72, v64, v65
    v_cvt_pk_bf16_f32 v73, v66, v67
    v_cvt_pk_bf16_f32 v74, v68, v69
    v_cvt_pk_bf16_f32 v75, v70, v71
    s_add_u32 s56, s62, 221184
    buffer_store_dwordx4 v[72:75], v5, s[48:51], s56 offen sc1
    s_waitcnt lgkmcnt(0)
    v_mov_b32 v176, v13
    v_mov_b32 v178, v15
    v_pk_fma_f32 v[80:81], v[12:13], v[224:225], v[80:81] op_sel_hi:[0,1,1]
    v_pk_fma_f32 v[82:83], v[12:13], v[226:227], v[82:83] op_sel_hi:[0,1,1]
    v_pk_fma_f32 v[84:85], v[12:13], v[228:229], v[84:85] op_sel_hi:[0,1,1]
    v_pk_fma_f32 v[86:87], v[12:13], v[230:231], v[86:87] op_sel_hi:[0,1,1]
    v_pk_mul_f32 v[2:3], v[80:81], v[80:81]
    v_pk_mul_f32 v[6:7], v[82:83], v[82:83]
    v_pk_mul_f32 v[8:9], v[84:85], v[84:85]
    v_pk_mul_f32 v[10:11], v[86:87], v[86:87]
    v_pk_fma_f32 v[2:3], v[2:3], v[14:15], v[176:177] op_sel_hi:[1,0,0]
    v_pk_fma_f32 v[6:7], v[6:7], v[14:15], v[176:177] op_sel_hi:[1,0,0]
    v_pk_fma_f32 v[8:9], v[8:9], v[14:15], v[176:177] op_sel_hi:[1,0,0]
    v_pk_fma_f32 v[10:11], v[10:11], v[14:15], v[176:177] op_sel_hi:[1,0,0]
    v_pk_mul_f32 v[2:3], v[2:3], v[80:81]
    v_pk_mul_f32 v[6:7], v[6:7], v[82:83]
    v_pk_mul_f32 v[8:9], v[8:9], v[84:85]
    v_pk_mul_f32 v[10:11], v[10:11], v[86:87]
    v_exp_f32 v2, v2
    v_exp_f32 v3, v3
    v_pk_fma_f32 v[88:89], v[12:13], v[232:233], v[88:89] op_sel_hi:[0,1,1]
    v_exp_f32 v6, v6
    v_exp_f32 v7, v7
    v_pk_fma_f32 v[90:91], v[12:13], v[234:235], v[90:91] op_sel_hi:[0,1,1]
    v_exp_f32 v8, v8
    v_exp_f32 v9, v9
    v_pk_fma_f32 v[92:93], v[12:13], v[236:237], v[92:93] op_sel_hi:[0,1,1]
    v_exp_f32 v10, v10
    v_exp_f32 v11, v11
    v_pk_fma_f32 v[94:95], v[12:13], v[238:239], v[94:95] op_sel_hi:[0,1,1]
    v_pk_fma_f32 v[2:3], v[2:3], v[178:179], v[178:179] op_sel_hi:[1,0,0]
    v_pk_fma_f32 v[6:7], v[6:7], v[178:179], v[178:179] op_sel_hi:[1,0,0]
    v_pk_fma_f32 v[8:9], v[8:9], v[178:179], v[178:179] op_sel_hi:[1,0,0]
    v_pk_fma_f32 v[10:11], v[10:11], v[178:179], v[178:179] op_sel_hi:[1,0,0]
    v_rcp_f32 v2, v2
    v_rcp_f32 v3, v3
    v_pk_mul_f32 v[80:81], v[80:81], v[88:89]
    v_rcp_f32 v6, v6
    v_rcp_f32 v7, v7
    v_pk_mul_f32 v[82:83], v[82:83], v[90:91]
    v_rcp_f32 v8, v8
    v_rcp_f32 v9, v9
    v_pk_mul_f32 v[84:85], v[84:85], v[92:93]
    v_rcp_f32 v10, v10
    v_rcp_f32 v11, v11
    v_pk_mul_f32 v[86:87], v[86:87], v[94:95]
    v_pk_mul_f32 v[80:81], v[80:81], v[2:3]
    v_pk_mul_f32 v[82:83], v[82:83], v[6:7]
    v_pk_mul_f32 v[84:85], v[84:85], v[8:9]
    v_pk_mul_f32 v[86:87], v[86:87], v[10:11]
    v_cvt_pk_bf16_f32 v88, v80, v81
    v_cvt_pk_bf16_f32 v89, v82, v83
    v_cvt_pk_bf16_f32 v90, v84, v85
    v_cvt_pk_bf16_f32 v91, v86, v87
    s_add_u32 s56, s62, 294912
    buffer_store_dwordx4 v[88:91], v5, s[48:51], s56 offen sc1
kF_join:
    s_setprio 0
    s_waitcnt vmcnt(17) lgkmcnt(7)
    v_add_u32 v240, s8, v246
    v_xor_b32 v241, 32, v240
    v_xor_b32 v242, 64, v240
    v_xor_b32 v243, 96, v240
    ds_read_b64_tr_b16 v[112:113], v240 offset:0
    ds_read_b64_tr_b16 v[114:115], v240 offset:2048
    ds_read_b64_tr_b16 v[116:117], v241 offset:0
    ds_read_b64_tr_b16 v[118:119], v241 offset:2048
    ds_read_b64_tr_b16 v[120:121], v242 offset:0
    ds_read_b64_tr_b16 v[122:123], v242 offset:2048
    ds_read_b64_tr_b16 v[124:125], v243 offset:0
    ds_read_b64_tr_b16 v[126:127], v243 offset:2048
    s_waitcnt vmcnt(13) lgkmcnt(7)
    v_add_u32 v240, s10, v246
    v_xor_b32 v241, 32, v240
    v_xor_b32 v242, 64, v240
    v_xor_b32 v243, 96, v240
    ds_read_b64_tr_b16 v[128:129], v240 offset:0
    ds_read_b64_tr_b16 v[130:131], v240 offset:2048
    ds_read_b64_tr_b16 v[132:133], v241 offset:0
    ds_read_b64_tr_b16 v[134:135], v241 offset:2048
    ds_read_b64_tr_b16 v[136:137], v242 offset:0
    ds_read_b64_tr_b16 v[138:139], v242 offset:2048
    ds_read_b64_tr_b16 v[140:141], v243 offset:0
    ds_read_b64_tr_b16 v[142:143], v243 offset:2048
    s_waitcnt lgkmcnt(0)
    s_waitcnt vmcnt(0)
    s_barrier
    v_mov_b32 v6, v250
    v_mov_b32 v7, v247
    s_cmp_lg_u32 s12, 0
    s_cbranch_scc1 kk_w0_10
    v_mov_b32 v2, s68
    v_mov_b32 v3, s69
    v_mov_b32 v4, 0
    s_mov_b64 exec, 1
    buffer_store_dwordx2 v[2:3], v4, s[48:51], s63 offen sc0 sc1
    s_mov_b64 exec, -1
kk_w0_10:
    s_add_u32 s77, s77, 1
    s_cmp_eq_u32 s77, 7
    s_cselect_b32 s77, 0, s77
    s_mul_i32 s67, s77, 28672
    s_add_u32 s67, s67, s78
    s_lshl_b32 s9, s12, 12
    s_add_u32 s9, s9, s8
    s_add_u32 m0, s9, 0
    s_add_u32 s56, s67, 0
    buffer_load_dwordx4 v244, s[52:55], s56 offen lds
    s_add_u32 m0, s9, 1024
    s_add_u32 s56, s67, 7168
    buffer_load_dwordx4 v244, s[52:55], s56 offen lds
    s_add_u32 m0, s9, 2048
    s_add_u32 s56, s67, 14336
    buffer_load_dwordx4 v244, s[52:55], s56 offen lds
    s_add_u32 m0, s9, 3072
    s_add_u32 s56, s67, 21504
    buffer_load_dwordx4 v244, s[52:55], s56 offen lds
    s_add_u32 s67, s79, 0
    s_lshl_b32 s9, s12, 12
    s_add_u32 s9, s9, s10
    s_add_u32 m0, s9, 0
    s_add_u32 s56, s67, 0
    buffer_load_dwordx4 v244, s[40:43], s56 offen lds
    s_add_u32 m0, s9, 1024
    s_add_u32 s56, s67, 7168
    buffer_load_dwordx4 v244, s[40:43], s56 offen lds
    s_add_u32 m0, s9, 2048
    s_add_u32 s56, s67, 14336
    buffer_load_dwordx4 v244, s[40:43], s56 offen lds
    s_add_u32 m0, s9, 3072
    s_add_u32 s56, s67, 21504
    buffer_load_dwordx4 v245, s[40:43], s56 offen lds
    s_waitcnt lgkmcnt(7)
    v_add_u32 v240, s7, v246
    v_xor_b32 v241, 32, v240
    v_xor_b32 v242, 64, v240
    v_xor_b32 v243, 96, v240
    ds_read_b64_tr_b16 v[144:145], v240 offset:0
    ds_read_b64_tr_b16 v[146:147], v240 offset:2048
    ds_read_b64_tr_b16 v[148:149], v241 offset:0
    ds_read_b64_tr_b16 v[150:151], v241 offset:2048
    ds_read_b64_tr_b16 v[152:153], v242 offset:0
    ds_read_b64_tr_b16 v[154:155], v242 offset:2048
    ds_read_b64_tr_b16 v[156:157], v243 offset:0
    ds_read_b64_tr_b16 v[158:159], v243 offset:2048
    s_waitcnt lgkmcnt(0)
    s_add_u32 s67, s79, 25088
    s_lshl_b32 s9, s12, 12
    s_add_u32 s9, s9, s7
    s_add_u32 m0, s9, 0
    s_add_u32 s56, s67, 0
    buffer_load_dwordx4 v244, s[40:43], s56 offen lds
    s_add_u32 m0, s9, 1024
    s_add_u32 s56, s67, 7168
    buffer_load_dwordx4 v244, s[40:43], s56 offen lds
    s_add_u32 m0, s9, 2048
    s_add_u32 s56, s67, 14336
    buffer_load_dwordx4 v244, s[40:43], s56 offen lds
    s_add_u32 m0, s9, 3072
    s_add_u32 s56, s67, 21504
    buffer_load_dwordx4 v245, s[40:43], s56 offen lds
    s_mul_i32 s56, s70, 174
    s_movk_i32 s57, 96
    s_movk_i32 s58, 2048
    v_lshrrev_b32 v4, 4, v1
    v_lshlrev_b32 v4, 8, v4
    v_add_u32 v4, 12582912, v4
    s_lshl_b32 s59, s92, 4
    v_and_b32 v108, 15, v1
    v_add_u32 v108, s59, v108
    v_cmp_lt_u32 vcc, 95, v108
    v_cmp_ne_u32 s[60:61], 0, v108
    v_cmp_ne_u32 s[64:65], s57, v108
    v_subbrev_co_u32 v108, vcc, 1, v108, vcc
    s_and_b64 s[60:61], s[60:61], s[64:65]
    v_add_u32 v108, s56, v108
    v_cmp_gt_u32 vcc, s58, v108
    v_lshrrev_b32 v5, 4, v108
    v_and_b32 v108, 15, v108
    s_and_b64 s[60:61], s[60:61], vcc
    v_lshl_add_u32 v108, v108, 4, v4
    v_lshl_add_u32 v108, v5, 14, v108
    v_mov_b32 v5, 2147483648
    v_cndmask_b32 v108, v5, v108, s[60:61]
    s_lshl_b32 s59, s93, 4
    v_and_b32 v109, 15, v1
    v_add_u32 v109, s59, v109
    v_cmp_lt_u32 vcc, 95, v109
    v_cmp_ne_u32 s[60:61], 0, v109
    v_cmp_ne_u32 s[64:65], s57, v109
    v_subbrev_co_u32 v109, vcc, 1, v109, vcc
    s_and_b64 s[60:61], s[60:61], s[64:65]
    v_add_u32 v109, s56, v109
    v_cmp_gt_u32 vcc, s58, v109
    v_lshrrev_b32 v5, 4, v109
    v_and_b32 v109, 15, v109
    s_and_b64 s[60:61], s[60:61], vcc
    v_lshl_add_u32 v109, v109, 4, v4
    v_lshl_add_u32 v109, v5, 14, v109
    v_mov_b32 v5, 2147483648
    v_cndmask_b32 v109, v5, v109, s[60:61]
    s_lshl_b32 s59, s94, 4
    v_and_b32 v110, 15, v1
    v_add_u32 v110, s59, v110
    v_cmp_lt_u32 vcc, 95, v110
    v_cmp_ne_u32 s[60:61], 0, v110
    v_cmp_ne_u32 s[64:65], s57, v110
    v_subbrev_co_u32 v110, vcc, 1, v110, vcc
    s_and_b64 s[60:61], s[60:61], s[64:65]
    v_add_u32 v110, s56, v110
    v_cmp_gt_u32 vcc, s58, v110
    v_lshrrev_b32 v5, 4, v110
    v_and_b32 v110, 15, v110
    s_and_b64 s[60:61], s[60:61], vcc
    v_lshl_add_u32 v110, v110, 4, v4
    v_lshl_add_u32 v110, v5, 14, v110
    v_mov_b32 v5, 2147483648
    v_cndmask_b32 v110, v5, v110, s[60:61]
    s_lshl_b32 s59, s95, 4
    v_and_b32 v111, 15, v1
    v_add_u32 v111, s59, v111
    v_cmp_lt_u32 vcc, 95, v111
    v_cmp_ne_u32 s[60:61], 0, v111
    v_cmp_ne_u32 s[64:65], s57, v111
    v_subbrev_co_u32 v111, vcc, 1, v111, vcc
    s_and_b64 s[60:61], s[60:61], s[64:65]
    v_add_u32 v111, s56, v111
    v_cmp_gt_u32 vcc, s58, v111
    v_lshrrev_b32 v5, 4, v111
    v_and_b32 v111, 15, v111
    s_and_b64 s[60:61], s[60:61], vcc
    v_lshl_add_u32 v111, v111, 4, v4
    v_lshl_add_u32 v111, v5, 14, v111
    v_mov_b32 v5, 2147483648
    v_cndmask_b32 v111, v5, v111, s[60:61]
    v_lshlrev_b32 v5, 4, v1
    s_mul_i32 s64, s12, 7168
    s_add_u32 s66, s64, 7168
    s_lshl_b32 s65, s76, 10
    s_add_u32 s65, s65, s64
    s_sub_u32 s65, s65, 1024
    s_lshl_b32 s63, s12, 11
    s_cmp_lg_u32 s12, 0
    s_cbranch_scc1 kk_pok_11
    s_mov_b32 s57, 0
    s_mov_b32 exec_hi, 0
kk_psp_12:
    buffer_load_dwordx2 v[2:3], v7, s[48:51], 0 offen sc0 sc1
    s_add_u32 s57, s57, 1
    s_waitcnt vmcnt(0)
    v_cmp_ne_u64 vcc, s[68:69], v[2:3]
    s_cmp_eq_u64 vcc, 0
    s_cbranch_scc1 kk_pok_11
    s_sleep 2
    s_cmp_lt_u32 s57, 32768
    s_cbranch_scc1 kk_psp_12
kk_pok_11:
    s_mov_b32 exec_hi, -1
    s_barrier
    s_add_u32 s65, s65, 1024
    s_cmp_eq_u32 s65, s66
    s_cselect_b32 s65, s64, s65
    s_add_u32 s56, s72, s65
    buffer_load_dwordx4 v[80:83], v5, s[48:51], s56 offen sc1
    s_add_u32 s56, s73, s65
    buffer_load_dwordx4 v[84:87], v5, s[48:51], s56 offen sc1
    s_add_u32 s56, s74, s65
    buffer_load_dwordx4 v[88:91], v5, s[48:51], s56 offen sc1
    s_add_u32 s56, s75, s65
    buffer_load_dwordx4 v[92:95], v5, s[48:51], s56 offen sc1
    s_add_u32 s65, s65, 1024
    s_cmp_eq_u32 s65, s66
    s_cselect_b32 s65, s64, s65
    s_add_u32 s56, s72, s65
    buffer_load_dwordx4 v[96:99], v5, s[48:51], s56 offen sc1
    s_add_u32 s56, s73, s65
    buffer_load_dwordx4 v[100:103], v5, s[48:51], s56 offen sc1
    s_add_u32 s56, s74, s65
    buffer_load_dwordx4 v[104:107], v5, s[48:51], s56 offen sc1
    buffer_load_dwordx4 v[12:15], v6, s[36:39], 0 offen
    s_waitcnt lgkmcnt(7)
    v_add_u32 v8, 0, v246
    v_xor_b32 v9, 32, v8
    v_xor_b32 v10, 64, v8
    v_xor_b32 v11, 96, v8
    ds_read_b64_tr_b16 v[160:161], v8 offset:0
    ds_read_b64_tr_b16 v[162:163], v8 offset:2048
    ds_read_b64_tr_b16 v[164:165], v9 offset:0
    ds_read_b64_tr_b16 v[166:167], v9 offset:2048
    ds_read_b64_tr_b16 v[168:169], v10 offset:0
    ds_read_b64_tr_b16 v[170:171], v10 offset:2048
    ds_read_b64_tr_b16 v[172:173], v11 offset:0
    ds_read_b64_tr_b16 v[174:175], v11 offset:2048
    s_waitcnt vmcnt(16) lgkmcnt(7)
    v_add_u32 v8, s8, v246
    v_xor_b32 v9, 32, v8
    v_xor_b32 v10, 64, v8
    v_xor_b32 v11, 96, v8
    ds_read_b64_tr_b16 v[176:177], v8 offset:0
    ds_read_b64_tr_b16 v[178:179], v8 offset:2048
    ds_read_b64_tr_b16 v[180:181], v9 offset:0
    ds_read_b64_tr_b16 v[182:183], v9 offset:2048
    ds_read_b64_tr_b16 v[184:185], v10 offset:0
    ds_read_b64_tr_b16 v[186:187], v10 offset:2048
    ds_read_b64_tr_b16 v[188:189], v11 offset:0
    ds_read_b64_tr_b16 v[190:191], v11 offset:2048
    s_waitcnt vmcnt(12) lgkmcnt(7)
    v_add_u32 v8, s10, v246
    v_xor_b32 v9, 32, v8
    v_xor_b32 v10, 64, v8
    v_xor_b32 v11, 96, v8
    ds_read_b64_tr_b16 v[224:225], v8 offset:0
    ds_read_b64_tr_b16 v[226:227], v8 offset:2048
    ds_read_b64_tr_b16 v[228:229], v9 offset:0
    ds_read_b64_tr_b16 v[230:231], v9 offset:2048
    ds_read_b64_tr_b16 v[232:233], v10 offset:0
    ds_read_b64_tr_b16 v[234:235], v10 offset:2048
    ds_read_b64_tr_b16 v[236:237], v11 offset:0
    ds_read_b64_tr_b16 v[238:239], v11 offset:2048
    s_waitcnt vmcnt(8) lgkmcnt(7)
    v_add_u32 v8, s7, v246
    v_xor_b32 v9, 32, v8
    v_xor_b32 v10, 64, v8
    v_xor_b32 v11, 96, v8
    ds_read_b64_tr_b16 v[240:241], v8 offset:0
    ds_read_b64_tr_b16 v[242:243], v8 offset:2048
    ds_read_b64_tr_b16 v[244:245], v9 offset:0
    ds_read_b64_tr_b16 v[246:247], v9 offset:2048
    ds_read_b64_tr_b16 v[248:249], v10 offset:0
    ds_read_b64_tr_b16 v[250:251], v10 offset:2048
    ds_read_b64_tr_b16 v[252:253], v11 offset:0
    ds_read_b64_tr_b16 v[254:255], v11 offset:2048
    v_and_b32 v8, 15, v1
    v_lshrrev_b32 v9, 4, v1
    v_and_b32 v10, 2, v9
    v_xor_b32 v8, v8, v10
    v_lshlrev_b32 v8, 4, v8
    v_lshl_add_u32 v8, v9, 8, v8
    s_lshl_b32 s56, s12, 14
    v_add_u32 v8, s56, v8
    v_xor_b32 v9, 64, v8
    v_xor_b32 v10, 0x80, v8
    v_xor_b32 v11, 0xc0, v8
    s_lshr_b32 s60, s12, 1
    s_and_b32 s61, s12, 1
    s_lshl_b32 s61, s61, 3
    v_lshrrev_b32 v2, 3, v1
    v_add_u32 v2, s61, v2
    v_and_b32 v3, 7, v1
    v_lshlrev_b32 v7, 1, v3
    v_xor_b32 v2, v2, v7
    v_lshlrev_b32 v3, 9, v3
    v_lshl_add_u32 v2, v2, 4, v3
    s_lshl_b32 s56, s60, 12
    v_add_u32 v2, s56, v2
    v_add_u32 v3, 0x10000, v2
    s_waitcnt lgkmcnt(0)
    s_mov_b32 s52, s30
    s_mov_b32 s53, s31
    s_mov_b32 s54, 1835008
    s_mov_b32 s55, 0x20000
    s_waitcnt vmcnt(7)
    v_mfma_f32_16x16x32_bf16 v[16:19], v[192:195], v[80:83], 0
    v_mfma_f32_16x16x32_bf16 v[20:23], v[196:199], v[80:83], 0
    v_mfma_f32_16x16x32_bf16 v[24:27], v[200:203], v[80:83], 0
    v_mfma_f32_16x16x32_bf16 v[28:31], v[204:207], v[80:83], 0
    s_add_u32 s56, s75, s65
    buffer_load_dwordx4 v[80:83], v5, s[48:51], s56 offen sc1
    s_waitcnt vmcnt(7)
    v_mfma_f32_16x16x32_bf16 v[32:35], v[192:195], v[84:87], 0
    v_mfma_f32_16x16x32_bf16 v[36:39], v[196:199], v[84:87], 0
    v_mfma_f32_16x16x32_bf16 v[40:43], v[200:203], v[84:87], 0
    v_mfma_f32_16x16x32_bf16 v[44:47], v[204:207], v[84:87], 0
    s_add_u32 s65, s65, 1024
    s_cmp_eq_u32 s65, s66
    s_cselect_b32 s65, s64, s65
    s_add_u32 s56, s72, s65
    buffer_load_dwordx4 v[84:87], v5, s[48:51], s56 offen sc1
    s_waitcnt vmcnt(7)
    v_mfma_f32_16x16x32_bf16 v[48:51], v[192:195], v[88:91], 0
    v_mfma_f32_16x16x32_bf16 v[52:55], v[196:199], v[88:91], 0
    v_mfma_f32_16x16x32_bf16 v[56:59], v[200:203], v[88:91], 0
    v_mfma_f32_16x16x32_bf16 v[60:63], v[204:207], v[88:91], 0
    s_add_u32 s56, s73, s65
    buffer_load_dwordx4 v[88:91], v5, s[48:51], s56 offen sc1
    s_waitcnt vmcnt(7)
    v_mfma_f32_16x16x32_bf16 v[64:67], v[192:195], v[92:95], 0
    v_mfma_f32_16x16x32_bf16 v[68:71], v[196:199], v[92:95], 0
    v_mfma_f32_16x16x32_bf16 v[72:75], v[200:203], v[92:95], 0
    v_mfma_f32_16x16x32_bf16 v[76:79], v[204:207], v[92:95], 0
    s_add_u32 s56, s74, s65
    buffer_load_dwordx4 v[92:95], v5, s[48:51], s56 offen sc1
    s_waitcnt vmcnt(7)
    v_mfma_f32_16x16x32_bf16 v[16:19], v[208:211], v[96:99], v[16:19]
    v_mfma_f32_16x16x32_bf16 v[20:23], v[212:215], v[96:99], v[20:23]
    v_mfma_f32_16x16x32_bf16 v[24:27], v[216:219], v[96:99], v[24:27]
    v_mfma_f32_16x16x32_bf16 v[28:31], v[220:223], v[96:99], v[28:31]
    s_add_u32 s56, s75, s65
    buffer_load_dwordx4 v[96:99], v5, s[48:51], s56 offen sc1
    s_waitcnt vmcnt(7)
    v_mfma_f32_16x16x32_bf16 v[32:35], v[208:211], v[100:103], v[32:35]
    v_mfma_f32_16x16x32_bf16 v[36:39], v[212:215], v[100:103], v[36:39]
    v_mfma_f32_16x16x32_bf16 v[40:43], v[216:219], v[100:103], v[40:43]
    v_mfma_f32_16x16x32_bf16 v[44:47], v[220:223], v[100:103], v[44:47]
    s_add_u32 s65, s65, 1024
    s_cmp_eq_u32 s65, s66
    s_cselect_b32 s65, s64, s65
    s_add_u32 s56, s72, s65
    buffer_load_dwordx4 v[100:103], v5, s[48:51], s56 offen sc1
    s_waitcnt vmcnt(7)
    v_mfma_f32_16x16x32_bf16 v[48:51], v[208:211], v[104:107], v[48:51]
    v_mfma_f32_16x16x32_bf16 v[52:55], v[212:215], v[104:107], v[52:55]
    v_mfma_f32_16x16x32_bf16 v[56:59], v[216:219], v[104:107], v[56:59]
    v_mfma_f32_16x16x32_bf16 v[60:63], v[220:223], v[104:107], v[60:63]
    s_add_u32 s56, s73, s65
    buffer_load_dwordx4 v[104:107], v5, s[48:51], s56 offen sc1
    s_waitcnt vmcnt(6)
    v_mfma_f32_16x16x32_bf16 v[64:67], v[208:211], v[80:83], v[64:67]
    v_mfma_f32_16x16x32_bf16 v[68:71], v[212:215], v[80:83], v[68:71]
    v_mfma_f32_16x16x32_bf16 v[72:75], v[216:219], v[80:83], v[72:75]
    v_mfma_f32_16x16x32_bf16 v[76:79], v[220:223], v[80:83], v[76:79]
    s_add_u32 s56, s74, s65
    buffer_load_dwordx4 v[80:83], v5, s[48:51], s56 offen sc1
    s_barrier
    s_waitcnt vmcnt(6)
    v_mfma_f32_16x16x32_bf16 v[16:19], v[112:115], v[84:87], v[16:19]
    v_mfma_f32_16x16x32_bf16 v[20:23], v[116:119], v[84:87], v[20:23]
    v_mfma_f32_16x16x32_bf16 v[24:27], v[120:123], v[84:87], v[24:27]
    v_mfma_f32_16x16x32_bf16 v[28:31], v[124:127], v[84:87], v[28:31]
    s_add_u32 s56, s75, s65
    buffer_load_dwordx4 v[84:87], v5, s[48:51], s56 offen sc1
    s_waitcnt vmcnt(6)
    v_mfma_f32_16x16x32_bf16 v[32:35], v[112:115], v[88:91], v[32:35]
    v_mfma_f32_16x16x32_bf16 v[36:39], v[116:119], v[88:91], v[36:39]
    v_mfma_f32_16x16x32_bf16 v[40:43], v[120:123], v[88:91], v[40:43]
    v_mfma_f32_16x16x32_bf16 v[44:47], v[124:127], v[88:91], v[44:47]
    s_add_u32 s65, s65, 1024
    s_cmp_eq_u32 s65, s66
    s_cselect_b32 s65, s64, s65
    s_add_u32 s56, s72, s65
    buffer_load_dwordx4 v[88:91], v5, s[48:51], s56 offen sc1
    s_waitcnt vmcnt(6)
    v_mfma_f32_16x16x32_bf16 v[48:51], v[112:115], v[92:95], v[48:51]
    v_mfma_f32_16x16x32_bf16 v[52:55], v[116:119], v[92:95], v[52:55]
    v_mfma_f32_16x16x32_bf16 v[56:59], v[120:123], v[92:95], v[56:59]
    v_mfma_f32_16x16x32_bf16 v[60:63], v[124:127], v[92:95], v[60:63]
    s_add_u32 s56, s73, s65
    buffer_load_dwordx4 v[92:95], v5, s[48:51], s56 offen sc1
    s_waitcnt vmcnt(6)
    v_mfma_f32_16x16x32_bf16 v[64:67], v[112:115], v[96:99], v[64:67]
    v_mfma_f32_16x16x32_bf16 v[68:71], v[116:119], v[96:99], v[68:71]
    v_mfma_f32_16x16x32_bf16 v[72:75], v[120:123], v[96:99], v[72:75]
    v_mfma_f32_16x16x32_bf16 v[76:79], v[124:127], v[96:99], v[76:79]
    s_add_u32 s56, s74, s65
    buffer_load_dwordx4 v[96:99], v5, s[48:51], s56 offen sc1
    s_waitcnt vmcnt(6)
    v_mfma_f32_16x16x32_bf16 v[16:19], v[128:131], v[100:103], v[16:19]
    v_mfma_f32_16x16x32_bf16 v[20:23], v[132:135], v[100:103], v[20:23]
    v_mfma_f32_16x16x32_bf16 v[24:27], v[136:139], v[100:103], v[24:27]
    v_mfma_f32_16x16x32_bf16 v[28:31], v[140:143], v[100:103], v[28:31]
    s_add_u32 s56, s75, s65
    buffer_load_dwordx4 v[100:103], v5, s[48:51], s56 offen sc1
    s_waitcnt vmcnt(6)
    v_mfma_f32_16x16x32_bf16 v[32:35], v[128:131], v[104:107], v[32:35]
    v_mfma_f32_16x16x32_bf16 v[36:39], v[132:135], v[104:107], v[36:39]
    v_mfma_f32_16x16x32_bf16 v[40:43], v[136:139], v[104:107], v[40:43]
    v_mfma_f32_16x16x32_bf16 v[44:47], v[140:143], v[104:107], v[44:47]
    s_add_u32 s65, s65, 1024
    s_cmp_eq_u32 s65, s66
    s_cselect_b32 s65, s64, s65
    s_mov_b32 s58, s65
    s_add_u32 s56, s72, s58
    buffer_load_dwordx4 v[104:107], v5, s[48:51], s56 offen sc1
    s_waitcnt vmcnt(6)
    v_mfma_f32_16x16x32_bf16 v[48:51], v[128:131], v[80:83], v[48:51]
    v_mfma_f32_16x16x32_bf16 v[52:55], v[132:135], v[80:83], v[52:55]
    v_mfma_f32_16x16x32_bf16 v[56:59], v[136:139], v[80:83], v[56:59]
    v_mfma_f32_16x16x32_bf16 v[60:63], v[140:143], v[80:83], v[60:63]
    s_add_u32 s65, s65, 1024
    s_cmp_eq_u32 s65, s66
    s_cselect_b32 s65, s64, s65
    s_mov_b32 s59, s65
    s_add_u32 s56, s72, s59
    buffer_load_dwordx4 v[80:83], v5, s[48:51], s56 offen sc1
    s_waitcnt vmcnt(6)
    v_mfma_f32_16x16x32_bf16 v[64:67], v[128:131], v[84:87], v[64:67]
    v_mfma_f32_16x16x32_bf16 v[68:71], v[132:135], v[84:87], v[68:71]
    v_mfma_f32_16x16x32_bf16 v[72:75], v[136:139], v[84:87], v[72:75]
    v_mfma_f32_16x16x32_bf16 v[76:79], v[140:143], v[84:87], v[76:79]
    buffer_load_dwordx4 v[84:87], v108, s[48:51], s63 offen offset:0 sc1
    s_waitcnt vmcnt(6)
    v_mfma_f32_16x16x32_bf16 v[16:19], v[144:147], v[88:91], v[16:19]
    v_mfma_f32_16x16x32_bf16 v[20:23], v[148:151], v[88:91], v[20:23]
    v_mfma_f32_16x16x32_bf16 v[24:27], v[152:155], v[88:91], v[24:27]
    v_mfma_f32_16x16x32_bf16 v[28:31], v[156:159], v[88:91], v[28:31]
    buffer_load_dwordx4 v[88:91], v108, s[48:51], s63 offen offset:1024 sc1
    s_waitcnt vmcnt(6)
    v_mfma_f32_16x16x32_bf16 v[32:35], v[144:147], v[92:95], v[32:35]
    v_mfma_f32_16x16x32_bf16 v[36:39], v[148:151], v[92:95], v[36:39]
    v_mfma_f32_16x16x32_bf16 v[40:43], v[152:155], v[92:95], v[40:43]
    v_mfma_f32_16x16x32_bf16 v[44:47], v[156:159], v[92:95], v[44:47]
    s_add_u32 s56, s73, s58
    buffer_load_dwordx4 v[92:95], v5, s[48:51], s56 offen sc1
    s_waitcnt vmcnt(6)
    v_mfma_f32_16x16x32_bf16 v[48:51], v[144:147], v[96:99], v[48:51]
    v_mfma_f32_16x16x32_bf16 v[52:55], v[148:151], v[96:99], v[52:55]
    v_mfma_f32_16x16x32_bf16 v[56:59], v[152:155], v[96:99], v[56:59]
    v_mfma_f32_16x16x32_bf16 v[60:63], v[156:159], v[96:99], v[60:63]
    s_add_u32 s56, s73, s59
    buffer_load_dwordx4 v[96:99], v5, s[48:51], s56 offen sc1
    s_waitcnt vmcnt(6)
    v_mfma_f32_16x16x32_bf16 v[64:67], v[144:147], v[100:103], v[64:67]
    v_mfma_f32_16x16x32_bf16 v[68:71], v[148:151], v[100:103], v[68:71]
    v_mfma_f32_16x16x32_bf16 v[72:75], v[152:155], v[100:103], v[72:75]
    v_mfma_f32_16x16x32_bf16 v[76:79], v[156:159], v[100:103], v[76:79]
    buffer_load_dwordx4 v[100:103], v109, s[48:51], s63 offen offset:0 sc1
    s_waitcnt vmcnt(6)
    v_mfma_f32_16x16x32_bf16 v[16:19], v[160:163], v[104:107], v[16:19]
    v_mfma_f32_16x16x32_bf16 v[20:23], v[164:167], v[104:107], v[20:23]
    v_mfma_f32_16x16x32_bf16 v[24:27], v[168:171], v[104:107], v[24:27]
    v_mfma_f32_16x16x32_bf16 v[28:31], v[172:175], v[104:107], v[28:31]
    buffer_load_dwordx4 v[104:107], v109, s[48:51], s63 offen offset:1024 sc1
    s_waitcnt vmcnt(6)
    v_mfma_f32_16x16x32_bf16 v[16:19], v[176:179], v[80:83], v[16:19]
    v_mfma_f32_16x16x32_bf16 v[20:23], v[180:183], v[80:83], v[20:23]
    v_mfma_f32_16x16x32_bf16 v[24:27], v[184:187], v[80:83], v[24:27]
    v_mfma_f32_16x16x32_bf16 v[28:31], v[188:191], v[80:83], v[28:31]
    s_add_u32 s56, s74, s58
    buffer_load_dwordx4 v[80:83], v5, s[48:51], s56 offen sc1
    s_waitcnt vmcnt(6)
    v_mfma_f32_16x16x32_bf16 v[16:19], v[224:227], v[84:87], v[16:19]
    v_mfma_f32_16x16x32_bf16 v[20:23], v[228:231], v[84:87], v[20:23]
    v_mfma_f32_16x16x32_bf16 v[24:27], v[232:235], v[84:87], v[24:27]
    v_mfma_f32_16x16x32_bf16 v[28:31], v[236:239], v[84:87], v[28:31]
    s_add_u32 s56, s74, s59
    buffer_load_dwordx4 v[84:87], v5, s[48:51], s56 offen sc1
    s_waitcnt vmcnt(6)
    v_mfma_f32_16x16x32_bf16 v[16:19], v[240:243], v[88:91], v[16:19]
    v_mfma_f32_16x16x32_bf16 v[20:23], v[244:247], v[88:91], v[20:23]
    v_mfma_f32_16x16x32_bf16 v[24:27], v[248:251], v[88:91], v[24:27]
    v_mfma_f32_16x16x32_bf16 v[28:31], v[252:255], v[88:91], v[28:31]
    buffer_load_dwordx4 v[88:91], v110, s[48:51], s63 offen offset:0 sc1
    s_waitcnt vmcnt(6)
    v_mfma_f32_16x16x32_bf16 v[32:35], v[160:163], v[92:95], v[32:35]
    v_mfma_f32_16x16x32_bf16 v[36:39], v[164:167], v[92:95], v[36:39]
    v_mfma_f32_16x16x32_bf16 v[40:43], v[168:171], v[92:95], v[40:43]
    v_mfma_f32_16x16x32_bf16 v[44:47], v[172:175], v[92:95], v[44:47]
    buffer_load_dwordx4 v[92:95], v110, s[48:51], s63 offen offset:1024 sc1
    s_waitcnt vmcnt(6)
    v_mfma_f32_16x16x32_bf16 v[32:35], v[176:179], v[96:99], v[32:35]
    v_mfma_f32_16x16x32_bf16 v[36:39], v[180:183], v[96:99], v[36:39]
    v_mfma_f32_16x16x32_bf16 v[40:43], v[184:187], v[96:99], v[40:43]
    v_mfma_f32_16x16x32_bf16 v[44:47], v[188:191], v[96:99], v[44:47]
    s_add_u32 s56, s75, s58
    buffer_load_dwordx4 v[96:99], v5, s[48:51], s56 offen sc1
    ds_write_b128 v8, v[16:19] offset:0
    ds_write_b128 v9, v[20:23] offset:1024
    ds_write_b128 v10, v[24:27] offset:2048
    ds_write_b128 v11, v[28:31] offset:3072
    s_waitcnt vmcnt(6)
    v_mfma_f32_16x16x32_bf16 v[32:35], v[224:227], v[100:103], v[32:35]
    v_mfma_f32_16x16x32_bf16 v[36:39], v[228:231], v[100:103], v[36:39]
    v_mfma_f32_16x16x32_bf16 v[40:43], v[232:235], v[100:103], v[40:43]
    v_mfma_f32_16x16x32_bf16 v[44:47], v[236:239], v[100:103], v[44:47]
    s_add_u32 s56, s75, s59
    buffer_load_dwordx4 v[100:103], v5, s[48:51], s56 offen sc1
    s_waitcnt vmcnt(6)
    v_mfma_f32_16x16x32_bf16 v[32:35], v[240:243], v[104:107], v[32:35]
    v_mfma_f32_16x16x32_bf16 v[36:39], v[244:247], v[104:107], v[36:39]
    v_mfma_f32_16x16x32_bf16 v[40:43], v[248:251], v[104:107], v[40:43]
    v_mfma_f32_16x16x32_bf16 v[44:47], v[252:255], v[104:107], v[44:47]
    buffer_load_dwordx4 v[104:107], v111, s[48:51], s63 offen offset:0 sc1
    s_waitcnt vmcnt(6)
    v_mfma_f32_16x16x32_bf16 v[48:51], v[160:163], v[80:83], v[48:51]
    v_mfma_f32_16x16x32_bf16 v[52:55], v[164:167], v[80:83], v[52:55]
    v_mfma_f32_16x16x32_bf16 v[56:59], v[168:171], v[80:83], v[56:59]
    v_mfma_f32_16x16x32_bf16 v[60:63], v[172:175], v[80:83], v[60:63]
    buffer_load_dwordx4 v[80:83], v111, s[48:51], s63 offen offset:1024 sc1
    s_waitcnt vmcnt(6)
    v_mfma_f32_16x16x32_bf16 v[48:51], v[176:179], v[84:87], v[48:51]
    v_mfma_f32_16x16x32_bf16 v[52:55], v[180:183], v[84:87], v[52:55]
    v_mfma_f32_16x16x32_bf16 v[56:59], v[184:187], v[84:87], v[56:59]
    v_mfma_f32_16x16x32_bf16 v[60:63], v[188:191], v[84:87], v[60:63]
    ds_write_b128 v8, v[32:35] offset:4096
    ds_write_b128 v9, v[36:39] offset:5120
    ds_write_b128 v10, v[40:43] offset:6144
    ds_write_b128 v11, v[44:47] offset:7168
    s_waitcnt vmcnt(5)
    v_mfma_f32_16x16x32_bf16 v[48:51], v[224:227], v[88:91], v[48:51]
    v_mfma_f32_16x16x32_bf16 v[52:55], v[228:231], v[88:91], v[52:55]
    v_mfma_f32_16x16x32_bf16 v[56:59], v[232:235], v[88:91], v[56:59]
    v_mfma_f32_16x16x32_bf16 v[60:63], v[236:239], v[88:91], v[60:63]
    s_waitcnt vmcnt(4)
    v_mfma_f32_16x16x32_bf16 v[48:51], v[240:243], v[92:95], v[48:51]
    v_mfma_f32_16x16x32_bf16 v[52:55], v[244:247], v[92:95], v[52:55]
    v_mfma_f32_16x16x32_bf16 v[56:59], v[248:251], v[92:95], v[56:59]
    v_mfma_f32_16x16x32_bf16 v[60:63], v[252:255], v[92:95], v[60:63]
    s_waitcnt vmcnt(3)
    v_mfma_f32_16x16x32_bf16 v[64:67], v[160:163], v[96:99], v[64:67]
    v_mfma_f32_16x16x32_bf16 v[68:71], v[164:167], v[96:99], v[68:71]
    v_mfma_f32_16x16x32_bf16 v[72:75], v[168:171], v[96:99], v[72:75]
    v_mfma_f32_16x16x32_bf16 v[76:79], v[172:175], v[96:99], v[76:79]
    s_waitcnt vmcnt(2)
    v_mfma_f32_16x16x32_bf16 v[64:67], v[176:179], v[100:103], v[64:67]
    v_mfma_f32_16x16x32_bf16 v[68:71], v[180:183], v[100:103], v[68:71]
    v_mfma_f32_16x16x32_bf16 v[72:75], v[184:187], v[100:103], v[72:75]
    v_mfma_f32_16x16x32_bf16 v[76:79], v[188:191], v[100:103], v[76:79]
    ds_write_b128 v8, v[48:51] offset:8192
    ds_write_b128 v9, v[52:55] offset:9216
    ds_write_b128 v10, v[56:59] offset:10240
    ds_write_b128 v11, v[60:63] offset:11264
    s_waitcnt vmcnt(1)
    v_mfma_f32_16x16x32_bf16 v[64:67], v[224:227], v[104:107], v[64:67]
    v_mfma_f32_16x16x32_bf16 v[68:71], v[228:231], v[104:107], v[68:71]
    v_mfma_f32_16x16x32_bf16 v[72:75], v[232:235], v[104:107], v[72:75]
    v_mfma_f32_16x16x32_bf16 v[76:79], v[236:239], v[104:107], v[76:79]
    s_waitcnt vmcnt(0)
    v_mfma_f32_16x16x32_bf16 v[64:67], v[240:243], v[80:83], v[64:67]
    v_mfma_f32_16x16x32_bf16 v[68:71], v[244:247], v[80:83], v[68:71]
    v_mfma_f32_16x16x32_bf16 v[72:75], v[248:251], v[80:83], v[72:75]
    v_mfma_f32_16x16x32_bf16 v[76:79], v[252:255], v[80:83], v[76:79]
    v_lshlrev_b32 v144, 16, v12
    v_and_b32 v145, 0xffff0000, v12
    v_lshlrev_b32 v146, 16, v13
    v_and_b32 v147, 0xffff0000, v13
    v_lshlrev_b32 v148, 16, v14
    v_and_b32 v149, 0xffff0000, v14
    v_lshlrev_b32 v150, 16, v15
    v_and_b32 v151, 0xffff0000, v15
    ds_write_b128 v8, v[64:67] offset:12288
    ds_write_b128 v9, v[68:71] offset:13312
    ds_write_b128 v10, v[72:75] offset:14336
    ds_write_b128 v11, v[76:79] offset:15360
    s_waitcnt lgkmcnt(0)
    s_barrier
    ds_read_b128 v[192:195], v2 offset:0
    ds_read_b128 v[196:199], v2 offset:256
    ds_read_b128 v[200:203], v2 offset:16384
    ds_read_b128 v[204:207], v2 offset:16640
    ds_read_b128 v[208:211], v2 offset:32768
    ds_read_b128 v[212:215], v2 offset:33024
    ds_read_b128 v[216:219], v2 offset:49152
    ds_read_b128 v[220:223], v2 offset:49408
    ds_read_b128 v[112:115], v3 offset:0
    ds_read_b128 v[116:119], v3 offset:256
    ds_read_b128 v[120:123], v3 offset:16384
    ds_read_b128 v[124:127], v3 offset:16640
    ds_read_b128 v[128:131], v3 offset:32768
    ds_read_b128 v[132:135], v3 offset:33024
    s_waitcnt lgkmcnt(12)
    ds_read_b128 v[136:139], v3 offset:49152
    ds_read_b128 v[140:143], v3 offset:49408
    s_waitcnt lgkmcnt(14)
    v_pk_add_f32 v[144:145], v[144:145], v[192:193]
    v_pk_add_f32 v[146:147], v[146:147], v[194:195]
    v_pk_add_f32 v[148:149], v[148:149], v[196:197]
    v_pk_add_f32 v[150:151], v[150:151], v[198:199]
    s_waitcnt lgkmcnt(12)
    v_pk_add_f32 v[144:145], v[144:145], v[200:201]
    v_pk_add_f32 v[146:147], v[146:147], v[202:203]
    v_pk_add_f32 v[148:149], v[148:149], v[204:205]
    v_pk_add_f32 v[150:151], v[150:151], v[206:207]
    s_waitcnt lgkmcnt(10)
    v_pk_add_f32 v[144:145], v[144:145], v[208:209]
    v_pk_add_f32 v[146:147], v[146:147], v[210:211]
    v_pk_add_f32 v[148:149], v[148:149], v[212:213]
    v_pk_add_f32 v[150:151], v[150:151], v[214:215]
    s_waitcnt lgkmcnt(8)
    v_pk_add_f32 v[144:145], v[144:145], v[216:217]
    v_pk_add_f32 v[146:147], v[146:147], v[218:219]
    v_pk_add_f32 v[148:149], v[148:149], v[220:221]
    v_pk_add_f32 v[150:151], v[150:151], v[222:223]
    s_waitcnt lgkmcnt(6)
    v_pk_add_f32 v[144:145], v[144:145], v[112:113]
    v_pk_add_f32 v[146:147], v[146:147], v[114:115]
    v_pk_add_f32 v[148:149], v[148:149], v[116:117]
    v_pk_add_f32 v[150:151], v[150:151], v[118:119]
    s_waitcnt lgkmcnt(4)
    v_pk_add_f32 v[144:145], v[144:145], v[120:121]
    v_pk_add_f32 v[146:147], v[146:147], v[122:123]
    v_pk_add_f32 v[148:149], v[148:149], v[124:125]
    v_pk_add_f32 v[150:151], v[150:151], v[126:127]
    s_waitcnt lgkmcnt(2)
    v_pk_add_f32 v[144:145], v[144:145], v[128:129]
    v_pk_add_f32 v[146:147], v[146:147], v[130:131]
    v_pk_add_f32 v[148:149], v[148:149], v[132:133]
    v_pk_add_f32 v[150:151], v[150:151], v[134:135]
    s_waitcnt lgkmcnt(0)
    v_pk_add_f32 v[144:145], v[144:145], v[136:137]
    v_pk_add_f32 v[146:147], v[146:147], v[138:139]
    v_pk_add_f32 v[148:149], v[148:149], v[140:141]
    v_pk_add_f32 v[150:151], v[150:151], v[142:143]
    v_cvt_pk_bf16_f32 v152, v144, v145
    v_cvt_pk_bf16_f32 v153, v146, v147
    v_cvt_pk_bf16_f32 v154, v148, v149
    v_cvt_pk_bf16_f32 v155, v150, v151
    buffer_store_dwordx4 v[152:155], v6, s[52:55], 0 offen
    s_endpgm
kA:
    s_mul_i32 s60, s58, 11
    s_add_u32 s60, s60, s57
    s_sub_u32 s60, s60, 21
    s_lshr_b32 s14, s60, 2
    s_and_b32 s60, s60, 3
    s_lshl_b32 s15, s59, 2
    s_add_u32 s15, s15, s60
    s_mul_i32 s62, s14, 192
    s_mul_i32 s60, s56, 11
    s_add_u32 s60, s60, s57
    s_sub_u32 s60, s60, 21
    s_mul_i32 s70, s60, 293
    s_lshr_b32 s70, s70, 11
    s_mul_i32 s63, s70, 7
    s_sub_u32 s71, s60, s63
    v_lshrrev_b32 v10, 3, v1
    v_and_b32 v11, 7, v1
    v_lshrrev_b32 v12, 4, v1
    s_and_b32 s60, s12, 1
    s_lshl_b32 s60, s60, 2
    v_xor_b32 v13, v11, v12
    v_xor_b32 v13, s60, v13
    s_lshl_b32 s60, s12, 3
    s_add_u32 s60, s60, s62
    s_sub_u32 s60, s60, 16
    v_add_u32 v10, s60, v10
    s_movk_i32 s63, 896
    v_mul_lo_u32 v4, v10, s63
    v_lshl_add_u32 v4, v13, 4, v4
    v_add_u32 v5, 57344, v4
    v_mov_b32 v14, 2147483648
    v_cmp_gt_i32 vcc, 0, v10
    s_mov_b64 s[80:81], -1
    s_cmp_eq_u32 s12, 0
    s_cselect_b32 s80, 0xffffff00, s80
    v_cndmask_b32 v4, v4, v14, vcc
    s_mov_b32 s64, 195225787
    s_mul_i32 s63, s15, 112
    s_add_u32 s3, s14, s15
    s_mul_i32 s10, s3, 86
    s_lshr_b32 s10, s10, 8
    s_mul_i32 s10, s10, 3
    s_sub_u32 s3, s3, s10
    s_lshl_b32 s10, s3, 1
    s_cmp_eq_u32 s3, 2
    s_cselect_b32 s3, 5, s10
    s_sub_u32 s3, s3, 1
    s_lshl_b32 s60, s12, 6
    s_add_i32 s60, s60, -128
    v_add_u32 v10, s60, v1
    v_mul_hi_u32 v11, v10, s64
    v_mul_u32_u24 v12, 22, v11
    v_sub_u32 v12, v10, v12
    v_and_b32 v13, 0x33, v11
    v_bfe_u32 v14, v11, 2, 1
    v_lshl_or_b32 v13, v14, 3, v13
    v_bfe_u32 v14, v11, 3, 1
    v_lshl_or_b32 v13, v14, 2, v13
    v_mul_u32_u24 v13, 2688, v13
    v_mul_u32_u24 v14, 37, v12
    v_lshrrev_b32 v14, 8, v14
    v_mul_u32_u24 v15, 784, v14
    v_lshl_add_u32 v15, v12, 4, v15
    v_add3_u32 v13, v13, v15, s63
    v_cmp_gt_u32 vcc, 21, v12
    v_mov_b32 v14, 2147483648
    s_nop 0
    v_cndmask_b32 v6, v14, v13, vcc
    s_waitcnt lgkmcnt(0)
    s_mov_b32 s36, s16
    s_mov_b32 s37, s17
    s_mov_b32 s38, 1835008
    s_mov_b32 s39, 0x20000
    s_mov_b32 s40, s18
    s_mov_b32 s41, s19
    s_mov_b32 s42, 1204224
    s_mov_b32 s43, 0x20000
    s_mov_b32 exec_hi, 0x00ffffff
    buffer_load_dwordx4 v[224:227], v228, s[36:39], s61 offen
    s_mov_b32 exec_hi, -1
    s_add_u32 s3, s3, 1
    s_cmp_eq_u32 s3, 7
    s_cselect_b32 s3, 0, s3
    s_lshl_b32 s10, s3, 7
    s_mul_i32 s11, s3, 172032
    s_add_u32 m0, s13, 0
    s_mov_b64 exec, s[80:81]
    buffer_load_dwordx4 v4, s[36:39], s10 offen lds
    s_mov_b64 exec, -1
    s_add_u32 m0, s13, 8192
    s_add_u32 s56, s10, 0
    buffer_load_dwordx4 v5, s[36:39], s56 offen lds
    s_add_u32 m0, s13, 16384
    s_add_u32 s56, s10, 57344
    buffer_load_dwordx4 v5, s[36:39], s56 offen lds
    v_add_u32 v10, 114688, v5
    s_cmp_lt_u32 s12, 2
    s_cselect_b64 vcc, -1, 0
    v_cndmask_b32 v6, v6, v10, vcc
    s_movk_i32 s65, 128
    s_cselect_b32 s65, s65, 172032
    s_cselect_b32 s52, s16, s18
    s_cselect_b32 s53, s17, s19
    s_cselect_b32 s54, s38, s42
    s_mov_b32 s55, 0x20000
    s_add_u32 m0, s13, 24576
    s_mul_i32 s56, s65, s3
    buffer_load_dwordx4 v6, s[52:55], s56 offen lds
    s_lshl_b32 s60, s12, 6
    s_add_i32 s60, s60, 384
    v_add_u32 v10, s60, v1
    v_mul_hi_u32 v11, v10, s64
    v_mul_u32_u24 v12, 22, v11
    v_sub_u32 v12, v10, v12
    v_and_b32 v13, 0x33, v11
    v_bfe_u32 v14, v11, 2, 1
    v_lshl_or_b32 v13, v14, 3, v13
    v_bfe_u32 v14, v11, 3, 1
    v_lshl_or_b32 v13, v14, 2, v13
    v_mul_u32_u24 v13, 2688, v13
    v_mul_u32_u24 v14, 37, v12
    v_lshrrev_b32 v14, 8, v14
    v_mul_u32_u24 v15, 784, v14
    v_lshl_add_u32 v15, v12, 4, v15
    v_add3_u32 v13, v13, v15, s63
    v_cmp_gt_u32 vcc, 21, v12
    v_mov_b32 v14, 2147483648
    s_nop 0
    v_cndmask_b32 v2, v14, v13, vcc
    s_add_u32 m0, s13, 32768
    s_nop 0
    buffer_load_dwordx4 v2, s[40:43], s11 offen lds
    s_lshl_b32 s60, s12, 6
    s_add_i32 s60, s60, 896
    v_add_u32 v10, s60, v1
    v_mul_hi_u32 v11, v10, s64
    v_mul_u32_u24 v12, 22, v11
    v_sub_u32 v12, v10, v12
    v_and_b32 v13, 0x33, v11
    v_bfe_u32 v14, v11, 2, 1
    v_lshl_or_b32 v13, v14, 3, v13
    v_bfe_u32 v14, v11, 3, 1
    v_lshl_or_b32 v13, v14, 2, v13
    v_mul_u32_u24 v13, 2688, v13
    v_mul_u32_u24 v14, 37, v12
    v_lshrrev_b32 v14, 8, v14
    v_mul_u32_u24 v15, 784, v14
    v_lshl_add_u32 v15, v12, 4, v15
    v_add3_u32 v13, v13, v15, s63
    v_cmp_gt_u32 vcc, 21, v12
    v_mov_b32 v14, 2147483648
    s_nop 0
    v_cndmask_b32 v3, v14, v13, vcc
    s_add_u32 m0, s13, 40960
    s_nop 0
    buffer_load_dwordx4 v3, s[40:43], s11 offen lds
    s_mov_b32 s48, s34
    s_mov_b32 s49, s35
    s_mov_b32 s50, 268435456
    s_mov_b32 s51, 0x20000
    s_mov_b32 s96, s32
    s_mov_b32 s97, s33
    s_mov_b32 s98, 256
    s_mov_b32 s99, 0x20000
    s_mov_b32 s44, s28
    s_mov_b32 s45, s29
    s_mov_b32 s46, 1605632
    s_mov_b32 s47, 0x20000
    s_lshr_b32 s66, s12, 1
    s_and_b32 s64, s12, 1
    s_mul_i32 s60, s66, 6144
    v_and_b32 v16, 15, v1
    v_lshrrev_b32 v17, 4, v1
    v_lshrrev_b32 v18, 1, v16
    v_xor_b32 v19, v17, v18
    v_xor_b32 v20, 4, v19
    v_lshlrev_b32 v18, 7, v16
    v_lshl_add_u32 v7, v19, 4, v18
    v_lshl_add_u32 v8, v20, 4, v18
    v_add_u32 v192, s60, v7
    v_add_u32 v193, s60, v8
    v_lshrrev_b32 v18, 2, v16
    v_and_b32 v19, 3, v16
    v_lshrrev_b32 v20, 1, v17
    v_lshl_add_u32 v18, v20, 4, v18
    v_and_b32 v20, 1, v17
    v_lshl_add_u32 v18, v20, 2, v18
    v_mul_u32_u24 v18, 352, v18
    s_mul_i32 s60, s64, 56
    s_add_u32 s60, s60, 26624
    v_add_u32 v18, s60, v18
    v_lshl_add_u32 v9, v19, 3, v18
    v_min_u32 v19, 2, v19
    v_lshl_add_u32 v194, v19, 3, v18
    v_add_u32 v194, 32, v194
    s_bitcmp1_b32 s66, 0
    s_cselect_b64 vcc, -1, 0
    v_cndmask_b32 v195, v9, v194, vcc
    v_add_u32 v196, 224, v195
    s_lshr_b32 s60, s66, 1
    s_mul_i32 s60, s60, 112
    v_add_u32 v195, s60, v195
    v_lshrrev_b32 v16, 3, v1
    v_mul_u32_u24 v16, 49152, v16
    v_and_b32 v17, 7, v1
    v_lshl_add_u32 v16, v17, 4, v16
    v_mov_b32 v20, 0x3f803f80
    v_mov_b32 v21, 0x3f803f80
    v_mov_b32 v22, 0x3f803f80
    v_mov_b32 v23, 0x3f803f80
    s_mov_b64 exec, 0xffffff
    ds_write_b128 v16, v[20:23]
    s_mov_b64 exec, -1
    s_mov_b32 s92, 7
    s_mov_b32 s93, 9
    s_mov_b32 s94, 10
    s_mov_b32 s95, 10
    s_lshl_b32 s56, s12, 6
    v_add_u32 v249, s56, v1
    s_sub_u32 s56, s62, 16
    v_add_u32 v248, s56, v249
    v_cmp_gt_u32 vcc, 208, v249
    s_movk_i32 s56, 2048
    v_cmp_gt_u32 s[60:61], s56, v248
    v_lshlrev_b32 v248, 4, v248
    v_add_u32 v248, 10485760, v248
    s_and_b64 s[84:85], vcc, s[60:61]
    v_lshlrev_b32 v249, 2, v249
    v_add_u32 v249, 147456, v249
    v_mov_b32 v16, 149504
    v_cndmask_b32 v249, v16, v249, vcc
    s_mov_b32 s77, 1
    v_lshrrev_b32 v16, 3, v1
    v_and_b32 v17, 7, v1
    v_lshrrev_b32 v18, 4, v1
    v_lshlrev_b32 v19, 1, v18
    v_xor_b32 v17, v17, v19
    v_mul_u32_u24 v244, 896, v16
    v_lshl_add_u32 v244, v17, 4, v244
    s_lshl_b32 s56, s71, 7
    v_add_u32 v244, s56, v244
    v_mov_b32 v17, 2147483648
    v_cmp_gt_u32 vcc, 4, v16
    s_mul_i32 s78, s12, 200704
    s_mul_i32 s79, s12, 50176
    v_cndmask_b32 v245, v17, v244, vcc
    v_bfe_u32 v16, v1, 2, 2
    v_lshl_add_u32 v16, v18, 2, v16
    v_bfe_u32 v17, v16, 1, 2
    v_lshlrev_b32 v16, 7, v16
    v_and_b32 v18, 3, v1
    v_lshl_add_u32 v16, v18, 3, v16
    v_lshl_add_u32 v246, v17, 5, v16
    s_lshl_b32 s56, s12, 12
    v_add_u32 v246, s56, v246
    s_lshl_b32 s76, s77, 1
    s_add_u32 s76, s76, s71
    s_sub_u32 s56, s76, 7
    s_cmp_ge_u32 s76, 7
    s_cselect_b32 s76, s56, s76
    s_sub_u32 s77, s76, 1
    s_mul_i32 s56, s70, 11
    s_add_u32 s72, s56, s92
    s_mul_i32 s72, s72, 73728
    s_add_u32 s73, s56, s93
    s_mul_i32 s73, s73, 73728
    s_add_u32 s74, s56, s94
    s_mul_i32 s74, s74, 73728
    s_add_u32 s75, s56, s95
    s_mul_i32 s75, s75, 73728
    v_and_b32 v16, 15, v1
    v_min_u32 v247, 13, v16
    v_lshlrev_b32 v247, 3, v247
    s_lshl_b32 s56, s70, 7
    s_add_u32 s56, s56, 10551296
    v_add_u32 v247, s56, v247
    s_mul_i32 s56, s70, 174
    s_mul_i32 s57, s56, 342
    s_lshr_b32 s57, s57, 16
    s_add_u32 s58, s56, 173
    s_min_u32 s58, s58, 2047
    s_mul_i32 s58, s58, 342
    s_lshr_b32 s58, s58, 16
    s_cmp_lg_u32 s58, s57
    s_cselect_b32 s58, 15, 7
    v_min_u32 v16, s58, v16
    s_lshl_b32 s58, s57, 6
    s_add_u32 s58, s58, 10559488
    v_lshl_add_u32 v16, v16, 3, s58
    v_cmp_lt_u32 vcc, 15, v1
    s_lshr_b32 s58, s12, 1
    s_and_b32 s59, s12, 1
    v_cndmask_b32 v247, v247, v16, vcc
    s_lshl_b32 s59, s59, 3
    s_cmp_eq_u32 s58, 1
    s_cselect_b32 s60, s93, s92
    s_cmp_eq_u32 s58, 2
    s_cselect_b32 s60, s94, s60
    s_cmp_eq_u32 s58, 3
    s_cselect_b32 s60, s95, s60
    s_lshl_b32 s60, s60, 4
    s_add_u32 s60, s60, s59
    v_lshrrev_b32 v250, 3, v1
    v_add_u32 v250, s60, v250
    v_cmp_lt_u32 vcc, 95, v250
    v_cmp_ne_u32 s[60:61], 0, v250
    s_movk_i32 s59, 96
    v_cmp_ne_u32 s[86:87], s59, v250
    v_subbrev_co_u32 v250, vcc, 1, v250, vcc
    s_and_b64 s[60:61], s[60:61], s[86:87]
    v_add_u32 v250, s56, v250
    s_cmp_lt_u32 s58, 3
    s_cselect_b64 s[86:87], -1, 0
    s_and_b64 s[60:61], s[60:61], s[86:87]
    v_mul_u32_u24 v250, 896, v250
    v_and_b32 v16, 7, v1
    v_lshl_add_u32 v250, v16, 4, v250
    s_lshl_b32 s56, s71, 7
    v_add_u32 v250, s56, v250
    v_mov_b32 v16, 2147483648
    v_cndmask_b32 v250, v16, v250, s[60:61]
    s_mov_b32 s7, 81920
    s_cmp_ge_u32 s12, 4
    s_cselect_b32 s7, 114688, s7
    v_lshlrev_b32 v16, 4, v1
    v_lshrrev_b32 v17, 4, v1
    v_and_b32 v18, 15, v1
    s_mul_i32 s60, s64, 6144
    s_add_u32 s60, s60, 149504
    s_lshl_b32 s61, s66, 10
    s_add_u32 s61, s61, s60
    v_add_u32 v219, s61, v16
    s_and_b32 s61, s66, 1
    s_lshl_b32 s61, s61, 10
    s_add_u32 s61, s61, s60
    s_add_u32 s61, s61, 4096
    v_add_u32 v220, s61, v16
    s_lshl_b32 s61, s12, 12
    s_add_u32 s61, s61, s7
    v_add_u32 v221, s61, v16
    v_lshl_add_u32 v222, v17, 8, s60
    v_lshl_add_u32 v223, v18, 4, s60
    s_lshl_b32 s61, s12, 12
    s_add_u32 s58, s61, 73728
    s_add_u32 s59, s61, 106496
    s_cmp_ge_u32 s12, 6
    s_cselect_b32 s61, s59, s58
    s_add_u32 s58, s60, 2048
    s_cmp_eq_u32 s66, 0
    s_cselect_b32 s61, s58, s61
    v_add_u32 v208, s61, v16
    s_mul_i32 s61, s66, 192
    s_add_u32 s61, s61, 147456
    v_lshl_add_u32 v210, v18, 2, s61
    v_lshl_add_u32 v212, v17, 4, s61
    v_and_b32 v19, 1, v18
    v_cmp_eq_u32 s[86:87], 1, v19
    v_lshl_add_u32 v20, v17, 2, v19
    v_cmp_le_u32 s[88:89], v20, v18
    v_add_u32 v20, 2, v20
    v_cmp_le_u32 s[90:91], v20, v18
    v_cmp_eq_u32 s[82:83], 3, v17
    s_or_b32 s61, s14, s66
    s_cmp_eq_u32 s61, 0
    s_cselect_b64 s[92:93], -1, 0
    v_mov_b32 v19, 0x0c0c0100
    v_mov_b32 v20, 0x01000c0c
    v_cndmask_b32 v19, v19, v20, s[86:87]
    v_mov_b32 v20, 0x0c0c0302
    v_mov_b32 v21, 0x03020c0c
    v_cndmask_b32 v20, v20, v21, s[86:87]
    v_mov_b32 v21, 0x0c0c0c0c
    v_cndmask_b32 v209, v19, v21, s[88:89]
    v_cndmask_b32 v211, v20, v21, s[90:91]
    v_cndmask_b32 v213, v21, v19, s[88:89]
    v_cndmask_b32 v215, v21, v20, s[90:91]
    s_mul_i32 s94, s14, 12
    s_mul_i32 s61, s66, 3
    s_add_u32 s94, s94, s61
    s_lshl_b32 s94, s94, 4
    s_lshl_b32 s61, s15, 1
    s_add_u32 s94, s94, s61
    s_add_u32 s94, s94, s64
    s_lshl_b32 s94, s94, 10
    s_add_u32 s94, s94, 12582912
    v_mov_b32 v216, v16
    s_lshl_b32 s95, s14, 6
    s_lshl_b32 s56, s15, 3
    s_add_u32 s95, s95, s56
    s_add_u32 s95, s95, 10559488
    s_waitcnt vmcnt(6)
    v_lshlrev_b32 v230, 16, v224
    v_and_b32 v231, 0xffff0000, v224
    v_lshlrev_b32 v232, 16, v225
    v_and_b32 v233, 0xffff0000, v225
    v_lshlrev_b32 v234, 16, v226
    v_and_b32 v235, 0xffff0000, v226
    v_lshlrev_b32 v236, 16, v227
    v_and_b32 v237, 0xffff0000, v227
    v_add_f32 v228, v230, v231
    v_add_f32 v229, v232, v233
    v_add_f32 v224, v234, v235
    v_add_f32 v225, v236, v237
    v_add_f32 v228, v228, v229
    v_add_f32 v224, v224, v225
    v_add_f32 v228, v228, v224
    s_nop 1
    v_add_f32_dpp v228, v228, v228 quad_perm:[1,0,3,2] row_mask:0xf bank_mask:0xf
    s_nop 1
    v_add_f32_dpp v228, v228, v228 quad_perm:[2,3,0,1] row_mask:0xf bank_mask:0xf
    s_nop 1
    v_add_f32_dpp v228, v228, v228 row_half_mirror row_mask:0xf bank_mask:0xf
    s_nop 1
    v_add_f32_dpp v228, v228, v228 row_mirror row_mask:0xf bank_mask:0xf
    v_mov_b32 v238, v228
    s_nop 1
    v_permlane16_swap_b32 v228, v238
    s_nop 1
    v_add_f32 v228, v228, v238
    v_mov_b32 v238, v228
    s_nop 1
    v_permlane32_swap_b32 v228, v238
    s_nop 1
    v_add_f32 v228, v228, v238
    v_mul_f32 v228, 0x3b124925, v228
    v_cmp_gt_u32 vcc, 56, v1
    v_sub_f32 v230, v230, v228
    v_sub_f32 v231, v231, v228
    v_sub_f32 v232, v232, v228
    v_sub_f32 v233, v233, v228
    v_sub_f32 v234, v234, v228
    v_sub_f32 v235, v235, v228
    v_sub_f32 v236, v236, v228
    v_sub_f32 v237, v237, v228
    v_mul_f32 v229, v230, v230
    v_mul_f32 v224, v231, v231
    v_fmac_f32 v229, v232, v232
    v_fmac_f32 v224, v233, v233
    v_fmac_f32 v229, v234, v234
    v_fmac_f32 v224, v235, v235
    v_fmac_f32 v229, v236, v236
    v_fmac_f32 v224, v237, v237
    v_add_f32 v229, v229, v224
    v_cndmask_b32 v229, 0, v229, vcc
    s_nop 1
    v_add_f32_dpp v229, v229, v229 quad_perm:[1,0,3,2] row_mask:0xf bank_mask:0xf
    s_nop 1
    v_add_f32_dpp v229, v229, v229 quad_perm:[2,3,0,1] row_mask:0xf bank_mask:0xf
    s_nop 1
    v_add_f32_dpp v229, v229, v229 row_half_mirror row_mask:0xf bank_mask:0xf
    s_nop 1
    v_add_f32_dpp v229, v229, v229 row_mirror row_mask:0xf bank_mask:0xf
    v_mov_b32 v238, v229
    s_nop 1
    v_permlane16_swap_b32 v229, v238
    s_nop 1
    v_add_f32 v229, v229, v238
    v_mov_b32 v238, v229
    s_nop 1
    v_permlane32_swap_b32 v229, v238
    s_nop 1
    v_add_f32 v229, v229, v238
    v_mul_f32 v229, 0x3b124925, v229
    v_cvt_pk_bf16_f32 v228, v228, v228
    v_lshlrev_b32 v228, 16, v228
    v_cvt_pk_bf16_f32 v229, v229, v229
    v_lshlrev_b32 v229, 16, v229
    v_add_f32 v229, 0x3727c5ac, v229
    v_cvt_pk_bf16_f32 v229, v229, v229
    v_lshlrev_b32 v229, 16, v229
    v_sqrt_f32 v229, v229
    s_nop 0
    v_cvt_pk_bf16_f32 v229, v229, v229
    v_lshlrev_b32 v229, 16, v229
    s_add_u32 s3, s3, 1
    s_cmp_eq_u32 s3, 7
    s_cselect_b32 s3, 0, s3
    s_lshl_b32 s10, s3, 7
    s_mul_i32 s11, s3, 172032
    s_add_u32 m0, s13, 49152
    s_mov_b64 exec, s[80:81]
    buffer_load_dwordx4 v4, s[36:39], s10 offen lds
    s_mov_b64 exec, -1
    s_add_u32 m0, s13, 57344
    s_add_u32 s56, s10, 0
    buffer_load_dwordx4 v5, s[36:39], s56 offen lds
    s_add_u32 m0, s13, 65536
    s_add_u32 s56, s10, 57344
    buffer_load_dwordx4 v5, s[36:39], s56 offen lds
    s_waitcnt vmcnt(3) lgkmcnt(0)
    s_barrier
    ds_read_b128 v[96:99], v192 offset:2048
    ds_read_b64_tr_b16 v[128:129], v9 offset:0
    ds_read_b64_tr_b16 v[130:131], v9 offset:2816
    ds_read_b64_tr_b16 v[132:133], v194 offset:0
    ds_read_b64_tr_b16 v[134:135], v194 offset:2816
    ds_read_b64_tr_b16 v[136:137], v9 offset:112
    ds_read_b64_tr_b16 v[138:139], v9 offset:2928
    ds_read_b64_tr_b16 v[140:141], v194 offset:112
    ds_read_b64_tr_b16 v[142:143], v194 offset:2928
    ds_read_b64_tr_b16 v[144:145], v9 offset:224
    ds_read_b64_tr_b16 v[146:147], v9 offset:3040
    ds_read_b64_tr_b16 v[148:149], v194 offset:224
    ds_read_b64_tr_b16 v[150:151], v194 offset:3040
    ds_read_b128 v[100:103], v192 offset:4096
    s_waitcnt lgkmcnt(6)
    ds_read_b128 v[104:107], v192 offset:6144
    ds_read_b128 v[108:111], v7 offset:0
    ds_read_b64_tr_b16 v[152:153], v195 offset:0
    ds_read_b64_tr_b16 v[154:155], v195 offset:2816
    ds_read_b64_tr_b16 v[156:157], v196 offset:0
    ds_read_b64_tr_b16 v[158:159], v196 offset:2816
    s_waitcnt lgkmcnt(0)
    s_setprio 1
    v_mfma_f32_16x16x32_bf16 v[16:19], v[128:131], v[96:99], 0
    ds_read_b128 v[112:115], v193 offset:2048
    ds_read_b64_tr_b16 v[160:161], v9 offset:11264
    v_mfma_f32_16x16x32_bf16 v[20:23], v[132:135], v[96:99], 0
    ds_read_b64_tr_b16 v[162:163], v9 offset:14080
    ds_read_b64_tr_b16 v[164:165], v194 offset:11264
    v_mfma_f32_16x16x32_bf16 v[24:27], v[136:139], v[96:99], 0
    ds_read_b64_tr_b16 v[166:167], v194 offset:14080
    ds_read_b64_tr_b16 v[168:169], v9 offset:11376
    v_mfma_f32_16x16x32_bf16 v[28:31], v[140:143], v[96:99], 0
    ds_read_b64_tr_b16 v[170:171], v9 offset:14192
    ds_read_b64_tr_b16 v[172:173], v194 offset:11376
    s_add_u32 m0, s13, 73728
    s_mul_i32 s56, s65, s3
    buffer_load_dwordx4 v6, s[52:55], s56 offen lds
    v_mfma_f32_16x16x32_bf16 v[32:35], v[96:99], v[144:147], 0
    ds_read_b64_tr_b16 v[174:175], v194 offset:14192
    ds_read_b64_tr_b16 v[176:177], v9 offset:11488
    v_mfma_f32_16x16x32_bf16 v[36:39], v[96:99], v[148:151], 0
    ds_read_b64_tr_b16 v[178:179], v9 offset:14304
    ds_read_b64_tr_b16 v[180:181], v194 offset:11488
    v_mfma_f32_16x16x32_bf16 v[40:43], v[128:131], v[100:103], 0
    ds_read_b64_tr_b16 v[182:183], v194 offset:14304
    v_mfma_f32_16x16x32_bf16 v[44:47], v[132:135], v[100:103], 0
    s_waitcnt lgkmcnt(8)
    ds_read_b128 v[116:119], v193 offset:4096
    s_add_u32 m0, s13, 81920
    s_nop 0
    buffer_load_dwordx4 v2, s[40:43], s11 offen lds
    v_mfma_f32_16x16x32_bf16 v[48:51], v[136:139], v[100:103], 0
    ds_read_b128 v[120:123], v193 offset:6144
    v_mfma_f32_16x16x32_bf16 v[52:55], v[140:143], v[100:103], 0
    ds_read_b128 v[124:127], v8 offset:0
    s_setprio 0
    v_mfma_f32_16x16x32_bf16 v[56:59], v[100:103], v[144:147], 0
    ds_read_b64_tr_b16 v[184:185], v195 offset:11264
    v_mfma_f32_16x16x32_bf16 v[60:63], v[100:103], v[148:151], 0
    ds_read_b64_tr_b16 v[186:187], v195 offset:14080
    s_add_u32 m0, s13, 90112
    s_nop 0
    buffer_load_dwordx4 v3, s[40:43], s11 offen lds
    v_mfma_f32_16x16x32_bf16 v[64:67], v[128:131], v[104:107], 0
    ds_read_b64_tr_b16 v[188:189], v196 offset:11264
    v_mfma_f32_16x16x32_bf16 v[68:71], v[132:135], v[104:107], 0
    ds_read_b64_tr_b16 v[190:191], v196 offset:14080
    v_mfma_f32_16x16x32_bf16 v[72:75], v[136:139], v[104:107], 0
    v_mfma_f32_16x16x32_bf16 v[76:79], v[140:143], v[104:107], 0
    s_add_u32 s3, s3, 1
    s_cmp_eq_u32 s3, 7
    s_cselect_b32 s3, 0, s3
    s_lshl_b32 s10, s3, 7
    s_mul_i32 s11, s3, 172032
    s_add_u32 m0, s13, 98304
    s_mov_b64 exec, s[80:81]
    buffer_load_dwordx4 v4, s[36:39], s10 offen lds
    s_mov_b64 exec, -1
    v_mfma_f32_16x16x32_bf16 v[80:83], v[104:107], v[144:147], 0
    v_mfma_f32_16x16x32_bf16 v[84:87], v[104:107], v[148:151], 0
    v_mfma_f32_16x16x32_bf16 v[88:91], v[152:155], v[108:111], 0
    v_mfma_f32_16x16x32_bf16 v[92:95], v[108:111], v[156:159], 0
    v_mov_b32 v14, 0
    buffer_load_dwordx2 v[12:13], v14, s[96:99], 0 offen sc0 sc1
    s_waitcnt vmcnt(2) lgkmcnt(0)
    s_barrier
    v_add_u32 v7, 49152, v7
    v_add_u32 v8, 49152, v8
    v_add_u32 v192, 49152, v192
    v_add_u32 v193, 49152, v193
    v_add_u32 v9, 49152, v9
    v_add_u32 v194, 49152, v194
    v_add_u32 v195, 49152, v195
    v_add_u32 v196, 49152, v196
    s_setprio 3
    v_mfma_f32_16x16x32_bf16 v[16:19], v[160:163], v[112:115], v[16:19]
    ds_read_b128 v[96:99], v192 offset:2048
    ds_read_b64_tr_b16 v[128:129], v9 offset:0
    v_mfma_f32_16x16x32_bf16 v[20:23], v[164:167], v[112:115], v[20:23]
    ds_read_b64_tr_b16 v[130:131], v9 offset:2816
    ds_read_b64_tr_b16 v[132:133], v194 offset:0
    v_mfma_f32_16x16x32_bf16 v[24:27], v[168:171], v[112:115], v[24:27]
    ds_read_b64_tr_b16 v[134:135], v194 offset:2816
    ds_read_b64_tr_b16 v[136:137], v9 offset:112
    v_mfma_f32_16x16x32_bf16 v[28:31], v[172:175], v[112:115], v[28:31]
    ds_read_b64_tr_b16 v[138:139], v9 offset:2928
    ds_read_b64_tr_b16 v[140:141], v194 offset:112
    v_mfma_f32_16x16x32_bf16 v[32:35], v[112:115], v[176:179], v[32:35]
    ds_read_b64_tr_b16 v[142:143], v194 offset:2928
    ds_read_b64_tr_b16 v[144:145], v9 offset:224
    s_add_u32 m0, s13, 106496
    s_add_u32 s56, s10, 0
    buffer_load_dwordx4 v5, s[36:39], s56 offen lds
    v_mfma_f32_16x16x32_bf16 v[36:39], v[112:115], v[180:183], v[36:39]
    ds_read_b64_tr_b16 v[146:147], v9 offset:3040
    ds_read_b64_tr_b16 v[148:149], v194 offset:224
    v_mfma_f32_16x16x32_bf16 v[40:43], v[160:163], v[116:119], v[40:43]
    ds_read_b64_tr_b16 v[150:151], v194 offset:3040
    v_mfma_f32_16x16x32_bf16 v[44:47], v[164:167], v[116:119], v[44:47]
    s_waitcnt lgkmcnt(8)
    ds_read_b128 v[100:103], v192 offset:4096
    v_mfma_f32_16x16x32_bf16 v[48:51], v[168:171], v[116:119], v[48:51]
    ds_read_b128 v[104:107], v192 offset:6144
    v_mfma_f32_16x16x32_bf16 v[52:55], v[172:175], v[116:119], v[52:55]
    ds_read_b128 v[108:111], v7 offset:0
    s_add_u32 m0, s13, 114688
    s_add_u32 s56, s10, 57344
    buffer_load_dwordx4 v5, s[36:39], s56 offen lds
    s_setprio 2
    v_mfma_f32_16x16x32_bf16 v[56:59], v[116:119], v[176:179], v[56:59]
    ds_read_b64_tr_b16 v[152:153], v195 offset:0
    v_mfma_f32_16x16x32_bf16 v[60:63], v[116:119], v[180:183], v[60:63]
    ds_read_b64_tr_b16 v[154:155], v195 offset:2816
    v_mfma_f32_16x16x32_bf16 v[64:67], v[160:163], v[120:123], v[64:67]
    ds_read_b64_tr_b16 v[156:157], v196 offset:0
    v_mfma_f32_16x16x32_bf16 v[68:71], v[164:167], v[120:123], v[68:71]
    ds_read_b64_tr_b16 v[158:159], v196 offset:2816
    v_mfma_f32_16x16x32_bf16 v[72:75], v[168:171], v[120:123], v[72:75]
    s_add_u32 m0, s13, 122880
    s_mul_i32 s56, s65, s3
    buffer_load_dwordx4 v6, s[52:55], s56 offen lds
    v_mfma_f32_16x16x32_bf16 v[76:79], v[172:175], v[120:123], v[76:79]
    v_mfma_f32_16x16x32_bf16 v[80:83], v[120:123], v[176:179], v[80:83]
    v_mfma_f32_16x16x32_bf16 v[84:87], v[120:123], v[180:183], v[84:87]
    v_mfma_f32_16x16x32_bf16 v[88:91], v[184:187], v[124:127], v[88:91]
    v_mfma_f32_16x16x32_bf16 v[92:95], v[124:127], v[188:191], v[92:95]
    s_add_u32 m0, s13, 131072
    s_nop 0
    buffer_load_dwordx4 v2, s[40:43], s11 offen lds
    s_waitcnt lgkmcnt(0)
    s_setprio 1
    v_mfma_f32_16x16x32_bf16 v[16:19], v[128:131], v[96:99], v[16:19]
    ds_read_b128 v[112:115], v193 offset:2048
    ds_read_b64_tr_b16 v[160:161], v9 offset:11264
    v_mfma_f32_16x16x32_bf16 v[20:23], v[132:135], v[96:99], v[20:23]
    ds_read_b64_tr_b16 v[162:163], v9 offset:14080
    ds_read_b64_tr_b16 v[164:165], v194 offset:11264
    v_mfma_f32_16x16x32_bf16 v[24:27], v[136:139], v[96:99], v[24:27]
    ds_read_b64_tr_b16 v[166:167], v194 offset:14080
    ds_read_b64_tr_b16 v[168:169], v9 offset:11376
    v_mfma_f32_16x16x32_bf16 v[28:31], v[140:143], v[96:99], v[28:31]
    ds_read_b64_tr_b16 v[170:171], v9 offset:14192
    ds_read_b64_tr_b16 v[172:173], v194 offset:11376
    v_mfma_f32_16x16x32_bf16 v[32:35], v[96:99], v[144:147], v[32:35]
    ds_read_b64_tr_b16 v[174:175], v194 offset:14192
    ds_read_b64_tr_b16 v[176:177], v9 offset:11488
    s_add_u32 m0, s13, 139264
    s_nop 0
    buffer_load_dwordx4 v3, s[40:43], s11 offen lds
    v_mfma_f32_16x16x32_bf16 v[36:39], v[96:99], v[148:151], v[36:39]
    ds_read_b64_tr_b16 v[178:179], v9 offset:14304
    ds_read_b64_tr_b16 v[180:181], v194 offset:11488
    v_mfma_f32_16x16x32_bf16 v[40:43], v[128:131], v[100:103], v[40:43]
    ds_read_b64_tr_b16 v[182:183], v194 offset:14304
    v_mfma_f32_16x16x32_bf16 v[44:47], v[132:135], v[100:103], v[44:47]
    s_waitcnt lgkmcnt(8)
    ds_read_b128 v[116:119], v193 offset:4096
    v_mfma_f32_16x16x32_bf16 v[48:51], v[136:139], v[100:103], v[48:51]
    ds_read_b128 v[120:123], v193 offset:6144
    v_mfma_f32_16x16x32_bf16 v[52:55], v[140:143], v[100:103], v[52:55]
    ds_read_b128 v[124:127], v8 offset:0
    s_add_u32 s3, s3, 1
    s_cmp_eq_u32 s3, 7
    s_cselect_b32 s3, 0, s3
    s_lshl_b32 s10, s3, 7
    s_mul_i32 s11, s3, 172032
    s_add_u32 m0, s13, 0
    s_mov_b64 exec, s[80:81]
    buffer_load_dwordx4 v4, s[36:39], s10 offen lds
    s_mov_b64 exec, -1
    s_setprio 0
    v_mfma_f32_16x16x32_bf16 v[56:59], v[100:103], v[144:147], v[56:59]
    ds_read_b64_tr_b16 v[184:185], v195 offset:11264
    v_mfma_f32_16x16x32_bf16 v[60:63], v[100:103], v[148:151], v[60:63]
    ds_read_b64_tr_b16 v[186:187], v195 offset:14080
    v_mfma_f32_16x16x32_bf16 v[64:67], v[128:131], v[104:107], v[64:67]
    ds_read_b64_tr_b16 v[188:189], v196 offset:11264
    v_mfma_f32_16x16x32_bf16 v[68:71], v[132:135], v[104:107], v[68:71]
    ds_read_b64_tr_b16 v[190:191], v196 offset:14080
    v_mfma_f32_16x16x32_bf16 v[72:75], v[136:139], v[104:107], v[72:75]
    s_add_u32 m0, s13, 8192
    s_add_u32 s56, s10, 0
    buffer_load_dwordx4 v5, s[36:39], s56 offen lds
    v_mfma_f32_16x16x32_bf16 v[76:79], v[140:143], v[104:107], v[76:79]
    v_mfma_f32_16x16x32_bf16 v[80:83], v[104:107], v[144:147], v[80:83]
    v_mfma_f32_16x16x32_bf16 v[84:87], v[104:107], v[148:151], v[84:87]
    v_mfma_f32_16x16x32_bf16 v[88:91], v[152:155], v[108:111], v[88:91]
    v_mfma_f32_16x16x32_bf16 v[92:95], v[108:111], v[156:159], v[92:95]
    s_add_u32 m0, s13, 16384
    s_add_u32 s56, s10, 57344
    buffer_load_dwordx4 v5, s[36:39], s56 offen lds
    s_waitcnt vmcnt(3) lgkmcnt(0)
    s_barrier
    v_add_u32 v7, 49152, v7
    v_add_u32 v8, 49152, v8
    v_add_u32 v192, 49152, v192
    v_add_u32 v193, 49152, v193
    v_add_u32 v9, 49152, v9
    v_add_u32 v194, 49152, v194
    v_add_u32 v195, 49152, v195
    v_add_u32 v196, 49152, v196
    s_setprio 3
    v_mfma_f32_16x16x32_bf16 v[16:19], v[160:163], v[112:115], v[16:19]
    ds_read_b128 v[96:99], v192 offset:2048
    ds_read_b64_tr_b16 v[128:129], v9 offset:0
    v_mfma_f32_16x16x32_bf16 v[20:23], v[164:167], v[112:115], v[20:23]
    ds_read_b64_tr_b16 v[130:131], v9 offset:2816
    ds_read_b64_tr_b16 v[132:133], v194 offset:0
    v_mfma_f32_16x16x32_bf16 v[24:27], v[168:171], v[112:115], v[24:27]
    ds_read_b64_tr_b16 v[134:135], v194 offset:2816
    ds_read_b64_tr_b16 v[136:137], v9 offset:112
    v_mfma_f32_16x16x32_bf16 v[28:31], v[172:175], v[112:115], v[28:31]
    ds_read_b64_tr_b16 v[138:139], v9 offset:2928
    ds_read_b64_tr_b16 v[140:141], v194 offset:112
    v_readfirstlane_b32 s68, v12
    v_readfirstlane_b32 s69, v13
    s_cmp_lg_u32 s68, 0
    s_cbranch_scc1 kk_nok_13
    s_mov_b32 s57, 0
kk_nsp_14:
    s_sleep 2
    buffer_load_dwordx2 v[12:13], v14, s[96:99], 0 offen sc0 sc1
    s_add_u32 s57, s57, 1
    s_waitcnt vmcnt(0)
    v_readfirstlane_b32 s68, v12
    v_readfirstlane_b32 s69, v13
    s_cmp_lg_u32 s68, 0
    s_cbranch_scc1 kk_nok_13
    s_cmp_lt_u32 s57, 32768
    s_cbranch_scc1 kk_nsp_14
kk_nok_13:
    s_lshl_b32 s56, s2, 3
    s_add_u32 s56, s56, s12
    s_lshl_b32 s56, s56, 4
    s_add_u32 s56, s56, 10485760
    v_mov_b32 v230, s68
    v_mov_b32 v231, s69
    s_mov_b64 exec, 1
    buffer_store_dwordx4 v[228:231], v14, s[48:51], s56 offen sc0 sc1
    s_mov_b64 exec, -1
    v_mfma_f32_16x16x32_bf16 v[32:35], v[112:115], v[176:179], v[32:35]
    ds_read_b64_tr_b16 v[142:143], v194 offset:2928
    ds_read_b64_tr_b16 v[144:145], v9 offset:224
    v_mfma_f32_16x16x32_bf16 v[36:39], v[112:115], v[180:183], v[36:39]
    ds_read_b64_tr_b16 v[146:147], v9 offset:3040
    ds_read_b64_tr_b16 v[148:149], v194 offset:224
    v_mfma_f32_16x16x32_bf16 v[40:43], v[160:163], v[116:119], v[40:43]
    ds_read_b64_tr_b16 v[150:151], v194 offset:3040
    v_mfma_f32_16x16x32_bf16 v[44:47], v[164:167], v[116:119], v[44:47]
    s_waitcnt lgkmcnt(8)
    ds_read_b128 v[100:103], v192 offset:4096
    s_add_u32 m0, s13, 24576
    s_mul_i32 s56, s65, s3
    buffer_load_dwordx4 v6, s[52:55], s56 offen lds
    v_mfma_f32_16x16x32_bf16 v[48:51], v[168:171], v[116:119], v[48:51]
    ds_read_b128 v[104:107], v192 offset:6144
    v_mfma_f32_16x16x32_bf16 v[52:55], v[172:175], v[116:119], v[52:55]
    ds_read_b128 v[108:111], v7 offset:0
    s_setprio 2
    v_mfma_f32_16x16x32_bf16 v[56:59], v[116:119], v[176:179], v[56:59]
    ds_read_b64_tr_b16 v[152:153], v195 offset:0
    v_mfma_f32_16x16x32_bf16 v[60:63], v[116:119], v[180:183], v[60:63]
    ds_read_b64_tr_b16 v[154:155], v195 offset:2816
    s_add_u32 m0, s13, 32768
    s_nop 0
    buffer_load_dwordx4 v2, s[40:43], s11 offen lds
    v_mfma_f32_16x16x32_bf16 v[64:67], v[160:163], v[120:123], v[64:67]
    ds_read_b64_tr_b16 v[156:157], v196 offset:0
    v_mfma_f32_16x16x32_bf16 v[68:71], v[164:167], v[120:123], v[68:71]
    ds_read_b64_tr_b16 v[158:159], v196 offset:2816
    v_mfma_f32_16x16x32_bf16 v[72:75], v[168:171], v[120:123], v[72:75]
    v_mfma_f32_16x16x32_bf16 v[76:79], v[172:175], v[120:123], v[76:79]
    s_add_u32 m0, s13, 40960
    s_nop 0
    buffer_load_dwordx4 v3, s[40:43], s11 offen lds
    v_mfma_f32_16x16x32_bf16 v[80:83], v[120:123], v[176:179], v[80:83]
    v_mfma_f32_16x16x32_bf16 v[84:87], v[120:123], v[180:183], v[84:87]
    v_mfma_f32_16x16x32_bf16 v[88:91], v[184:187], v[124:127], v[88:91]
    v_mfma_f32_16x16x32_bf16 v[92:95], v[124:127], v[188:191], v[92:95]
    s_add_u32 s3, s3, 1
    s_cmp_eq_u32 s3, 7
    s_cselect_b32 s3, 0, s3
    s_lshl_b32 s10, s3, 7
    s_mul_i32 s11, s3, 172032
    s_add_u32 m0, s13, 49152
    s_mov_b64 exec, s[80:81]
    buffer_load_dwordx4 v4, s[36:39], s10 offen lds
    s_mov_b64 exec, -1
    s_waitcnt lgkmcnt(0)
    s_setprio 1
    v_mfma_f32_16x16x32_bf16 v[16:19], v[128:131], v[96:99], v[16:19]
    ds_read_b128 v[112:115], v193 offset:2048
    ds_read_b64_tr_b16 v[160:161], v9 offset:11264
    v_mfma_f32_16x16x32_bf16 v[20:23], v[132:135], v[96:99], v[20:23]
    ds_read_b64_tr_b16 v[162:163], v9 offset:14080
    ds_read_b64_tr_b16 v[164:165], v194 offset:11264
    v_mfma_f32_16x16x32_bf16 v[24:27], v[136:139], v[96:99], v[24:27]
    ds_read_b64_tr_b16 v[166:167], v194 offset:14080
    ds_read_b64_tr_b16 v[168:169], v9 offset:11376
    v_mfma_f32_16x16x32_bf16 v[28:31], v[140:143], v[96:99], v[28:31]
    ds_read_b64_tr_b16 v[170:171], v9 offset:14192
    ds_read_b64_tr_b16 v[172:173], v194 offset:11376
    v_mfma_f32_16x16x32_bf16 v[32:35], v[96:99], v[144:147], v[32:35]
    ds_read_b64_tr_b16 v[174:175], v194 offset:14192
    ds_read_b64_tr_b16 v[176:177], v9 offset:11488
    s_add_u32 m0, s13, 57344
    s_add_u32 s56, s10, 0
    buffer_load_dwordx4 v5, s[36:39], s56 offen lds
    v_mfma_f32_16x16x32_bf16 v[36:39], v[96:99], v[148:151], v[36:39]
    ds_read_b64_tr_b16 v[178:179], v9 offset:14304
    ds_read_b64_tr_b16 v[180:181], v194 offset:11488
    v_mfma_f32_16x16x32_bf16 v[40:43], v[128:131], v[100:103], v[40:43]
    ds_read_b64_tr_b16 v[182:183], v194 offset:14304
    v_mfma_f32_16x16x32_bf16 v[44:47], v[132:135], v[100:103], v[44:47]
    s_waitcnt lgkmcnt(8)
    ds_read_b128 v[116:119], v193 offset:4096
    v_mfma_f32_16x16x32_bf16 v[48:51], v[136:139], v[100:103], v[48:51]
    ds_read_b128 v[120:123], v193 offset:6144
    v_mfma_f32_16x16x32_bf16 v[52:55], v[140:143], v[100:103], v[52:55]
    ds_read_b128 v[124:127], v8 offset:0
    s_add_u32 m0, s13, 65536
    s_add_u32 s56, s10, 57344
    buffer_load_dwordx4 v5, s[36:39], s56 offen lds
    s_setprio 0
    v_mfma_f32_16x16x32_bf16 v[56:59], v[100:103], v[144:147], v[56:59]
    ds_read_b64_tr_b16 v[184:185], v195 offset:11264
    v_mfma_f32_16x16x32_bf16 v[60:63], v[100:103], v[148:151], v[60:63]
    ds_read_b64_tr_b16 v[186:187], v195 offset:14080
    v_mfma_f32_16x16x32_bf16 v[64:67], v[128:131], v[104:107], v[64:67]
    ds_read_b64_tr_b16 v[188:189], v196 offset:11264
    v_mfma_f32_16x16x32_bf16 v[68:71], v[132:135], v[104:107], v[68:71]
    ds_read_b64_tr_b16 v[190:191], v196 offset:14080
    v_mfma_f32_16x16x32_bf16 v[72:75], v[136:139], v[104:107], v[72:75]
    s_add_u32 m0, s13, 73728
    s_mul_i32 s56, s65, s3
    buffer_load_dwordx4 v6, s[52:55], s56 offen lds
    v_mfma_f32_16x16x32_bf16 v[76:79], v[140:143], v[104:107], v[76:79]
    v_mfma_f32_16x16x32_bf16 v[80:83], v[104:107], v[144:147], v[80:83]
    v_mfma_f32_16x16x32_bf16 v[84:87], v[104:107], v[148:151], v[84:87]
    v_mfma_f32_16x16x32_bf16 v[88:91], v[152:155], v[108:111], v[88:91]
    v_mfma_f32_16x16x32_bf16 v[92:95], v[108:111], v[156:159], v[92:95]
    s_add_u32 m0, s13, 81920
    s_nop 0
    buffer_load_dwordx4 v2, s[40:43], s11 offen lds
    s_waitcnt vmcnt(5) lgkmcnt(0)
    s_barrier
    v_add_u32 v7, 4294868992, v7
    v_add_u32 v8, 4294868992, v8
    v_add_u32 v192, 4294868992, v192
    v_add_u32 v193, 4294868992, v193
    v_add_u32 v9, 4294868992, v9
    v_add_u32 v194, 4294868992, v194
    v_add_u32 v195, 4294868992, v195
    v_add_u32 v196, 4294868992, v196
    s_setprio 3
    v_mfma_f32_16x16x32_bf16 v[16:19], v[160:163], v[112:115], v[16:19]
    ds_read_b128 v[96:99], v192 offset:2048
    ds_read_b64_tr_b16 v[128:129], v9 offset:0
    v_mfma_f32_16x16x32_bf16 v[20:23], v[164:167], v[112:115], v[20:23]
    ds_read_b64_tr_b16 v[130:131], v9 offset:2816
    ds_read_b64_tr_b16 v[132:133], v194 offset:0
    v_mfma_f32_16x16x32_bf16 v[24:27], v[168:171], v[112:115], v[24:27]
    ds_read_b64_tr_b16 v[134:135], v194 offset:2816
    ds_read_b64_tr_b16 v[136:137], v9 offset:112
    v_mfma_f32_16x16x32_bf16 v[28:31], v[172:175], v[112:115], v[28:31]
    ds_read_b64_tr_b16 v[138:139], v9 offset:2928
    ds_read_b64_tr_b16 v[140:141], v194 offset:112
    v_mfma_f32_16x16x32_bf16 v[32:35], v[112:115], v[176:179], v[32:35]
    ds_read_b64_tr_b16 v[142:143], v194 offset:2928
    ds_read_b64_tr_b16 v[144:145], v9 offset:224
    s_add_u32 m0, s13, 90112
    s_nop 0
    buffer_load_dwordx4 v3, s[40:43], s11 offen lds
    v_mfma_f32_16x16x32_bf16 v[36:39], v[112:115], v[180:183], v[36:39]
    ds_read_b64_tr_b16 v[146:147], v9 offset:3040
    ds_read_b64_tr_b16 v[148:149], v194 offset:224
    v_mfma_f32_16x16x32_bf16 v[40:43], v[160:163], v[116:119], v[40:43]
    ds_read_b64_tr_b16 v[150:151], v194 offset:3040
    v_mfma_f32_16x16x32_bf16 v[44:47], v[164:167], v[116:119], v[44:47]
    s_waitcnt lgkmcnt(8)
    ds_read_b128 v[100:103], v192 offset:4096
    v_mfma_f32_16x16x32_bf16 v[48:51], v[168:171], v[116:119], v[48:51]
    ds_read_b128 v[104:107], v192 offset:6144
    v_mfma_f32_16x16x32_bf16 v[52:55], v[172:175], v[116:119], v[52:55]
    ds_read_b128 v[108:111], v7 offset:0
    s_add_u32 s3, s3, 1
    s_cmp_eq_u32 s3, 7
    s_cselect_b32 s3, 0, s3
    s_lshl_b32 s10, s3, 7
    s_mul_i32 s11, s3, 172032
    s_add_u32 m0, s13, 98304
    s_mov_b64 exec, s[80:81]
    buffer_load_dwordx4 v4, s[36:39], s10 offen lds
    s_mov_b64 exec, -1
    s_setprio 2
    v_mfma_f32_16x16x32_bf16 v[56:59], v[116:119], v[176:179], v[56:59]
    ds_read_b64_tr_b16 v[152:153], v195 offset:0
    v_mfma_f32_16x16x32_bf16 v[60:63], v[116:119], v[180:183], v[60:63]
    ds_read_b64_tr_b16 v[154:155], v195 offset:2816
    v_mfma_f32_16x16x32_bf16 v[64:67], v[160:163], v[120:123], v[64:67]
    ds_read_b64_tr_b16 v[156:157], v196 offset:0
    v_mfma_f32_16x16x32_bf16 v[68:71], v[164:167], v[120:123], v[68:71]
    ds_read_b64_tr_b16 v[158:159], v196 offset:2816
    v_mfma_f32_16x16x32_bf16 v[72:75], v[168:171], v[120:123], v[72:75]
    s_add_u32 m0, s13, 106496
    s_add_u32 s56, s10, 0
    buffer_load_dwordx4 v5, s[36:39], s56 offen lds
    v_mfma_f32_16x16x32_bf16 v[76:79], v[172:175], v[120:123], v[76:79]
    v_mfma_f32_16x16x32_bf16 v[80:83], v[120:123], v[176:179], v[80:83]
    v_mfma_f32_16x16x32_bf16 v[84:87], v[120:123], v[180:183], v[84:87]
    v_mfma_f32_16x16x32_bf16 v[88:91], v[184:187], v[124:127], v[88:91]
    v_mfma_f32_16x16x32_bf16 v[92:95], v[124:127], v[188:191], v[92:95]
    s_add_u32 m0, s13, 114688
    s_add_u32 s56, s10, 57344
    buffer_load_dwordx4 v5, s[36:39], s56 offen lds
    s_waitcnt lgkmcnt(0)
    s_setprio 1
    v_mfma_f32_16x16x32_bf16 v[16:19], v[128:131], v[96:99], v[16:19]
    ds_read_b128 v[112:115], v193 offset:2048
    ds_read_b64_tr_b16 v[160:161], v9 offset:11264
    v_mfma_f32_16x16x32_bf16 v[20:23], v[132:135], v[96:99], v[20:23]
    ds_read_b64_tr_b16 v[162:163], v9 offset:14080
    ds_read_b64_tr_b16 v[164:165], v194 offset:11264
    v_mfma_f32_16x16x32_bf16 v[24:27], v[136:139], v[96:99], v[24:27]
    ds_read_b64_tr_b16 v[166:167], v194 offset:14080
    ds_read_b64_tr_b16 v[168:169], v9 offset:11376
    v_mfma_f32_16x16x32_bf16 v[28:31], v[140:143], v[96:99], v[28:31]
    ds_read_b64_tr_b16 v[170:171], v9 offset:14192
    ds_read_b64_tr_b16 v[172:173], v194 offset:11376
    v_mfma_f32_16x16x32_bf16 v[32:35], v[96:99], v[144:147], v[32:35]
    ds_read_b64_tr_b16 v[174:175], v194 offset:14192
    ds_read_b64_tr_b16 v[176:177], v9 offset:11488
    v_mfma_f32_16x16x32_bf16 v[36:39], v[96:99], v[148:151], v[36:39]
    ds_read_b64_tr_b16 v[178:179], v9 offset:14304
    ds_read_b64_tr_b16 v[180:181], v194 offset:11488
    v_mfma_f32_16x16x32_bf16 v[40:43], v[128:131], v[100:103], v[40:43]
    ds_read_b64_tr_b16 v[182:183], v194 offset:14304
    s_add_u32 m0, s13, 122880
    s_mul_i32 s56, s65, s3
    buffer_load_dwordx4 v6, s[52:55], s56 offen lds
    v_mfma_f32_16x16x32_bf16 v[44:47], v[132:135], v[100:103], v[44:47]
    s_waitcnt lgkmcnt(8)
    ds_read_b128 v[116:119], v193 offset:4096
    v_mfma_f32_16x16x32_bf16 v[48:51], v[136:139], v[100:103], v[48:51]
    ds_read_b128 v[120:123], v193 offset:6144
    v_mfma_f32_16x16x32_bf16 v[52:55], v[140:143], v[100:103], v[52:55]
    ds_read_b128 v[124:127], v8 offset:0
    s_setprio 0
    v_mfma_f32_16x16x32_bf16 v[56:59], v[100:103], v[144:147], v[56:59]
    ds_read_b64_tr_b16 v[184:185], v195 offset:11264
    v_mfma_f32_16x16x32_bf16 v[60:63], v[100:103], v[148:151], v[60:63]
    ds_read_b64_tr_b16 v[186:187], v195 offset:14080
    v_mfma_f32_16x16x32_bf16 v[64:67], v[128:131], v[104:107], v[64:67]
    ds_read_b64_tr_b16 v[188:189], v196 offset:11264
    v_mfma_f32_16x16x32_bf16 v[68:71], v[132:135], v[104:107], v[68:71]
    ds_read_b64_tr_b16 v[190:191], v196 offset:14080
    s_add_u32 m0, s13, 131072
    s_nop 0
    buffer_load_dwordx4 v2, s[40:43], s11 offen lds
    v_mfma_f32_16x16x32_bf16 v[72:75], v[136:139], v[104:107], v[72:75]
    v_mfma_f32_16x16x32_bf16 v[76:79], v[140:143], v[104:107], v[76:79]
    v_mfma_f32_16x16x32_bf16 v[80:83], v[104:107], v[144:147], v[80:83]
    v_mfma_f32_16x16x32_bf16 v[84:87], v[104:107], v[148:151], v[84:87]
    v_mfma_f32_16x16x32_bf16 v[88:91], v[152:155], v[108:111], v[88:91]
    v_mfma_f32_16x16x32_bf16 v[92:95], v[108:111], v[156:159], v[92:95]
    s_add_u32 m0, s13, 139264
    s_nop 0
    buffer_load_dwordx4 v3, s[40:43], s11 offen lds
    s_waitcnt vmcnt(6) lgkmcnt(0)
    s_barrier
    v_add_u32 v7, 49152, v7
    v_add_u32 v8, 49152, v8
    v_add_u32 v192, 49152, v192
    v_add_u32 v193, 49152, v193
    v_add_u32 v9, 49152, v9
    v_add_u32 v194, 49152, v194
    v_add_u32 v195, 49152, v195
    v_add_u32 v196, 49152, v196
    s_setprio 3
    v_mfma_f32_16x16x32_bf16 v[16:19], v[160:163], v[112:115], v[16:19]
    ds_read_b128 v[96:99], v192 offset:2048
    ds_read_b64_tr_b16 v[128:129], v9 offset:0
    v_mfma_f32_16x16x32_bf16 v[20:23], v[164:167], v[112:115], v[20:23]
    ds_read_b64_tr_b16 v[130:131], v9 offset:2816
    ds_read_b64_tr_b16 v[132:133], v194 offset:0
    v_mfma_f32_16x16x32_bf16 v[24:27], v[168:171], v[112:115], v[24:27]
    ds_read_b64_tr_b16 v[134:135], v194 offset:2816
    ds_read_b64_tr_b16 v[136:137], v9 offset:112
    v_mfma_f32_16x16x32_bf16 v[28:31], v[172:175], v[112:115], v[28:31]
    ds_read_b64_tr_b16 v[138:139], v9 offset:2928
    ds_read_b64_tr_b16 v[140:141], v194 offset:112
    v_mfma_f32_16x16x32_bf16 v[32:35], v[112:115], v[176:179], v[32:35]
    ds_read_b64_tr_b16 v[142:143], v194 offset:2928
    ds_read_b64_tr_b16 v[144:145], v9 offset:224
    s_add_u32 s3, s3, 1
    s_cmp_eq_u32 s3, 7
    s_cselect_b32 s3, 0, s3
    s_lshl_b32 s10, s3, 7
    s_mul_i32 s11, s3, 172032
    s_add_u32 m0, s13, 0
    s_mov_b64 exec, s[80:81]
    buffer_load_dwordx4 v4, s[36:39], s10 offen lds
    s_mov_b64 exec, -1
    v_mfma_f32_16x16x32_bf16 v[36:39], v[112:115], v[180:183], v[36:39]
    ds_read_b64_tr_b16 v[146:147], v9 offset:3040
    ds_read_b64_tr_b16 v[148:149], v194 offset:224
    v_mfma_f32_16x16x32_bf16 v[40:43], v[160:163], v[116:119], v[40:43]
    ds_read_b64_tr_b16 v[150:151], v194 offset:3040
    v_mfma_f32_16x16x32_bf16 v[44:47], v[164:167], v[116:119], v[44:47]
    s_waitcnt lgkmcnt(8)
    ds_read_b128 v[100:103], v192 offset:4096
    v_mfma_f32_16x16x32_bf16 v[48:51], v[168:171], v[116:119], v[48:51]
    ds_read_b128 v[104:107], v192 offset:6144
    v_mfma_f32_16x16x32_bf16 v[52:55], v[172:175], v[116:119], v[52:55]
    ds_read_b128 v[108:111], v7 offset:0
    s_add_u32 m0, s13, 8192
    s_add_u32 s56, s10, 0
    buffer_load_dwordx4 v5, s[36:39], s56 offen lds
    s_setprio 2
    v_mfma_f32_16x16x32_bf16 v[56:59], v[116:119], v[176:179], v[56:59]
    ds_read_b64_tr_b16 v[152:153], v195 offset:0
    v_mfma_f32_16x16x32_bf16 v[60:63], v[116:119], v[180:183], v[60:63]
    ds_read_b64_tr_b16 v[154:155], v195 offset:2816
    v_mfma_f32_16x16x32_bf16 v[64:67], v[160:163], v[120:123], v[64:67]
    ds_read_b64_tr_b16 v[156:157], v196 offset:0
    v_mfma_f32_16x16x32_bf16 v[68:71], v[164:167], v[120:123], v[68:71]
    ds_read_b64_tr_b16 v[158:159], v196 offset:2816
    v_mfma_f32_16x16x32_bf16 v[72:75], v[168:171], v[120:123], v[72:75]
    s_add_u32 m0, s13, 16384
    s_add_u32 s56, s10, 57344
    buffer_load_dwordx4 v5, s[36:39], s56 offen lds
    v_mfma_f32_16x16x32_bf16 v[76:79], v[172:175], v[120:123], v[76:79]
    v_mfma_f32_16x16x32_bf16 v[80:83], v[120:123], v[176:179], v[80:83]
    v_mfma_f32_16x16x32_bf16 v[84:87], v[120:123], v[180:183], v[84:87]
    v_mfma_f32_16x16x32_bf16 v[88:91], v[184:187], v[124:127], v[88:91]
    v_mfma_f32_16x16x32_bf16 v[92:95], v[124:127], v[188:191], v[92:95]
    s_add_u32 m0, s13, 24576
    s_mul_i32 s56, s65, s3
    buffer_load_dwordx4 v6, s[52:55], s56 offen lds
    s_waitcnt lgkmcnt(0)
    s_setprio 1
    v_mfma_f32_16x16x32_bf16 v[16:19], v[128:131], v[96:99], v[16:19]
    ds_read_b128 v[112:115], v193 offset:2048
    ds_read_b64_tr_b16 v[160:161], v9 offset:11264
    v_mfma_f32_16x16x32_bf16 v[20:23], v[132:135], v[96:99], v[20:23]
    ds_read_b64_tr_b16 v[162:163], v9 offset:14080
    ds_read_b64_tr_b16 v[164:165], v194 offset:11264
    v_mfma_f32_16x16x32_bf16 v[24:27], v[136:139], v[96:99], v[24:27]
    ds_read_b64_tr_b16 v[166:167], v194 offset:14080
    ds_read_b64_tr_b16 v[168:169], v9 offset:11376
    v_mfma_f32_16x16x32_bf16 v[28:31], v[140:143], v[96:99], v[28:31]
    ds_read_b64_tr_b16 v[170:171], v9 offset:14192
    ds_read_b64_tr_b16 v[172:173], v194 offset:11376
    v_mfma_f32_16x16x32_bf16 v[32:35], v[96:99], v[144:147], v[32:35]
    ds_read_b64_tr_b16 v[174:175], v194 offset:14192
    ds_read_b64_tr_b16 v[176:177], v9 offset:11488
    v_mfma_f32_16x16x32_bf16 v[36:39], v[96:99], v[148:151], v[36:39]
    ds_read_b64_tr_b16 v[178:179], v9 offset:14304
    ds_read_b64_tr_b16 v[180:181], v194 offset:11488
    v_mfma_f32_16x16x32_bf16 v[40:43], v[128:131], v[100:103], v[40:43]
    ds_read_b64_tr_b16 v[182:183], v194 offset:14304
    s_add_u32 m0, s13, 32768
    s_nop 0
    buffer_load_dwordx4 v2, s[40:43], s11 offen lds
    v_mfma_f32_16x16x32_bf16 v[44:47], v[132:135], v[100:103], v[44:47]
    s_waitcnt lgkmcnt(8)
    ds_read_b128 v[116:119], v193 offset:4096
    v_mfma_f32_16x16x32_bf16 v[48:51], v[136:139], v[100:103], v[48:51]
    ds_read_b128 v[120:123], v193 offset:6144
    v_mfma_f32_16x16x32_bf16 v[52:55], v[140:143], v[100:103], v[52:55]
    ds_read_b128 v[124:127], v8 offset:0
    s_setprio 0
    v_mfma_f32_16x16x32_bf16 v[56:59], v[100:103], v[144:147], v[56:59]
    ds_read_b64_tr_b16 v[184:185], v195 offset:11264
    v_mfma_f32_16x16x32_bf16 v[60:63], v[100:103], v[148:151], v[60:63]
    ds_read_b64_tr_b16 v[186:187], v195 offset:14080
    v_mfma_f32_16x16x32_bf16 v[64:67], v[128:131], v[104:107], v[64:67]
    ds_read_b64_tr_b16 v[188:189], v196 offset:11264
    v_mfma_f32_16x16x32_bf16 v[68:71], v[132:135], v[104:107], v[68:71]
    ds_read_b64_tr_b16 v[190:191], v196 offset:14080
    s_add_u32 m0, s13, 40960
    s_nop 0
    buffer_load_dwordx4 v3, s[40:43], s11 offen lds
    v_mfma_f32_16x16x32_bf16 v[72:75], v[136:139], v[104:107], v[72:75]
    v_mfma_f32_16x16x32_bf16 v[76:79], v[140:143], v[104:107], v[76:79]
    v_mfma_f32_16x16x32_bf16 v[80:83], v[104:107], v[144:147], v[80:83]
    v_mfma_f32_16x16x32_bf16 v[84:87], v[104:107], v[148:151], v[84:87]
    v_mfma_f32_16x16x32_bf16 v[88:91], v[152:155], v[108:111], v[88:91]
    v_mfma_f32_16x16x32_bf16 v[92:95], v[108:111], v[156:159], v[92:95]
    buffer_load_dwordx4 v[12:15], v248, s[48:51], 0 offen sc0 sc1
    s_waitcnt vmcnt(7) lgkmcnt(0)
    s_barrier
    v_add_u32 v7, 49152, v7
    v_add_u32 v8, 49152, v8
    v_add_u32 v192, 49152, v192
    v_add_u32 v193, 49152, v193
    v_add_u32 v9, 49152, v9
    v_add_u32 v194, 49152, v194
    v_add_u32 v195, 49152, v195
    v_add_u32 v196, 49152, v196
    s_setprio 3
    v_mfma_f32_16x16x32_bf16 v[16:19], v[160:163], v[112:115], v[16:19]
    ds_read_b128 v[96:99], v192 offset:2048
    ds_read_b64_tr_b16 v[128:129], v9 offset:0
    v_mfma_f32_16x16x32_bf16 v[20:23], v[164:167], v[112:115], v[20:23]
    ds_read_b64_tr_b16 v[130:131], v9 offset:2816
    ds_read_b64_tr_b16 v[132:133], v194 offset:0
    v_mfma_f32_16x16x32_bf16 v[24:27], v[168:171], v[112:115], v[24:27]
    ds_read_b64_tr_b16 v[134:135], v194 offset:2816
    ds_read_b64_tr_b16 v[136:137], v9 offset:112
    v_mfma_f32_16x16x32_bf16 v[28:31], v[172:175], v[112:115], v[28:31]
    ds_read_b64_tr_b16 v[138:139], v9 offset:2928
    ds_read_b64_tr_b16 v[140:141], v194 offset:112
    v_mfma_f32_16x16x32_bf16 v[32:35], v[112:115], v[176:179], v[32:35]
    ds_read_b64_tr_b16 v[142:143], v194 offset:2928
    ds_read_b64_tr_b16 v[144:145], v9 offset:224
    v_mfma_f32_16x16x32_bf16 v[36:39], v[112:115], v[180:183], v[36:39]
    ds_read_b64_tr_b16 v[146:147], v9 offset:3040
    ds_read_b64_tr_b16 v[148:149], v194 offset:224
    v_mfma_f32_16x16x32_bf16 v[40:43], v[160:163], v[116:119], v[40:43]
    ds_read_b64_tr_b16 v[150:151], v194 offset:3040
    v_mfma_f32_16x16x32_bf16 v[44:47], v[164:167], v[116:119], v[44:47]
    s_waitcnt lgkmcnt(8)
    ds_read_b128 v[100:103], v192 offset:4096
    v_mfma_f32_16x16x32_bf16 v[48:51], v[168:171], v[116:119], v[48:51]
    ds_read_b128 v[104:107], v192 offset:6144
    v_mfma_f32_16x16x32_bf16 v[52:55], v[172:175], v[116:119], v[52:55]
    ds_read_b128 v[108:111], v7 offset:0
    s_setprio 2
    v_mfma_f32_16x16x32_bf16 v[56:59], v[116:119], v[176:179], v[56:59]
    ds_read_b64_tr_b16 v[152:153], v195 offset:0
    v_mfma_f32_16x16x32_bf16 v[60:63], v[116:119], v[180:183], v[60:63]
    ds_read_b64_tr_b16 v[154:155], v195 offset:2816
    v_mfma_f32_16x16x32_bf16 v[64:67], v[160:163], v[120:123], v[64:67]
    ds_read_b64_tr_b16 v[156:157], v196 offset:0
    v_mfma_f32_16x16x32_bf16 v[68:71], v[164:167], v[120:123], v[68:71]
    ds_read_b64_tr_b16 v[158:159], v196 offset:2816
    v_mfma_f32_16x16x32_bf16 v[72:75], v[168:171], v[120:123], v[72:75]
    v_mfma_f32_16x16x32_bf16 v[76:79], v[172:175], v[120:123], v[76:79]
    v_mfma_f32_16x16x32_bf16 v[80:83], v[120:123], v[176:179], v[80:83]
    v_mfma_f32_16x16x32_bf16 v[84:87], v[120:123], v[180:183], v[84:87]
    v_mfma_f32_16x16x32_bf16 v[88:91], v[184:187], v[124:127], v[88:91]
    v_mfma_f32_16x16x32_bf16 v[92:95], v[124:127], v[188:191], v[92:95]
    s_waitcnt lgkmcnt(0)
    s_setprio 1
    v_mfma_f32_16x16x32_bf16 v[16:19], v[128:131], v[96:99], v[16:19]
    ds_read_b128 v[112:115], v193 offset:2048
    ds_read_b64_tr_b16 v[160:161], v9 offset:11264
    v_mfma_f32_16x16x32_bf16 v[20:23], v[132:135], v[96:99], v[20:23]
    ds_read_b64_tr_b16 v[162:163], v9 offset:14080
    ds_read_b64_tr_b16 v[164:165], v194 offset:11264
    v_mfma_f32_16x16x32_bf16 v[24:27], v[136:139], v[96:99], v[24:27]
    ds_read_b64_tr_b16 v[166:167], v194 offset:14080
    ds_read_b64_tr_b16 v[168:169], v9 offset:11376
    v_mfma_f32_16x16x32_bf16 v[28:31], v[140:143], v[96:99], v[28:31]
    ds_read_b64_tr_b16 v[170:171], v9 offset:14192
    ds_read_b64_tr_b16 v[172:173], v194 offset:11376
    s_add_u32 s77, s77, 1
    s_cmp_eq_u32 s77, 7
    s_cselect_b32 s77, 0, s77
    s_mul_i32 s67, s77, 28672
    s_add_u32 s67, s67, s78
    s_lshl_b32 s9, s12, 12
    s_add_u32 s9, s9, 49152
    s_add_u32 m0, s9, 0
    s_add_u32 s56, s67, 0
    buffer_load_dwordx4 v244, s[44:47], s56 offen lds
    v_mfma_f32_16x16x32_bf16 v[32:35], v[96:99], v[144:147], v[32:35]
    ds_read_b64_tr_b16 v[174:175], v194 offset:14192
    ds_read_b64_tr_b16 v[176:177], v9 offset:11488
    v_mfma_f32_16x16x32_bf16 v[36:39], v[96:99], v[148:151], v[36:39]
    ds_read_b64_tr_b16 v[178:179], v9 offset:14304
    ds_read_b64_tr_b16 v[180:181], v194 offset:11488
    v_mfma_f32_16x16x32_bf16 v[40:43], v[128:131], v[100:103], v[40:43]
    ds_read_b64_tr_b16 v[182:183], v194 offset:14304
    v_mfma_f32_16x16x32_bf16 v[44:47], v[132:135], v[100:103], v[44:47]
    s_waitcnt lgkmcnt(8)
    ds_read_b128 v[116:119], v193 offset:4096
    s_add_u32 m0, s9, 1024
    s_add_u32 s56, s67, 7168
    buffer_load_dwordx4 v244, s[44:47], s56 offen lds
    v_mfma_f32_16x16x32_bf16 v[48:51], v[136:139], v[100:103], v[48:51]
    ds_read_b128 v[120:123], v193 offset:6144
    v_mfma_f32_16x16x32_bf16 v[52:55], v[140:143], v[100:103], v[52:55]
    ds_read_b128 v[124:127], v8 offset:0
    s_setprio 0
    v_mfma_f32_16x16x32_bf16 v[56:59], v[100:103], v[144:147], v[56:59]
    ds_read_b64_tr_b16 v[184:185], v195 offset:11264
    v_mfma_f32_16x16x32_bf16 v[60:63], v[100:103], v[148:151], v[60:63]
    ds_read_b64_tr_b16 v[186:187], v195 offset:14080
    s_add_u32 m0, s9, 2048
    s_add_u32 s56, s67, 14336
    buffer_load_dwordx4 v244, s[44:47], s56 offen lds
    v_mfma_f32_16x16x32_bf16 v[64:67], v[128:131], v[104:107], v[64:67]
    ds_read_b64_tr_b16 v[188:189], v196 offset:11264
    v_mfma_f32_16x16x32_bf16 v[68:71], v[132:135], v[104:107], v[68:71]
    ds_read_b64_tr_b16 v[190:191], v196 offset:14080
    v_mfma_f32_16x16x32_bf16 v[72:75], v[136:139], v[104:107], v[72:75]
    v_mfma_f32_16x16x32_bf16 v[76:79], v[140:143], v[104:107], v[76:79]
    s_add_u32 m0, s9, 3072
    s_add_u32 s56, s67, 21504
    buffer_load_dwordx4 v244, s[44:47], s56 offen lds
    v_mfma_f32_16x16x32_bf16 v[80:83], v[104:107], v[144:147], v[80:83]
    v_mfma_f32_16x16x32_bf16 v[84:87], v[104:107], v[148:151], v[84:87]
    v_mfma_f32_16x16x32_bf16 v[88:91], v[152:155], v[108:111], v[88:91]
    v_mfma_f32_16x16x32_bf16 v[92:95], v[108:111], v[156:159], v[92:95]
    s_waitcnt vmcnt(4)
    v_cmp_ne_u64 vcc, s[68:69], v[14:15]
    s_and_b64 vcc, vcc, s[84:85]
    s_cbranch_scc0 kk_gok_15
    s_mov_b32 s57, 0
kk_gsp_16:
    s_sleep 2
    buffer_load_dwordx4 v[12:15], v248, s[48:51], 0 offen sc0 sc1
    s_add_u32 s57, s57, 1
    s_waitcnt vmcnt(0)
    v_cmp_ne_u64 vcc, s[68:69], v[14:15]
    s_and_b64 vcc, vcc, s[84:85]
    s_cbranch_scc0 kk_gok_15
    s_cmp_lt_u32 s57, 32768
    s_cbranch_scc1 kk_gsp_16
kk_gok_15:
    v_rcp_f32 v13, v13
    v_sub_f32 v12, 0, v12
    v_cndmask_b32 v12, 0, v12, s[84:85]
    v_cndmask_b32 v13, 0, v13, s[84:85]
    ds_write2st64_b32 v249, v12, v13 offset0:0 offset1:4
    s_waitcnt lgkmcnt(0)
    s_barrier
    v_add_u32 v7, 4294868992, v7
    v_add_u32 v8, 4294868992, v8
    v_add_u32 v192, 4294868992, v192
    v_add_u32 v193, 4294868992, v193
    v_add_u32 v9, 4294868992, v9
    v_add_u32 v194, 4294868992, v194
    v_add_u32 v195, 4294868992, v195
    v_add_u32 v196, 4294868992, v196
    s_setprio 3
    v_mfma_f32_16x16x32_bf16 v[16:19], v[160:163], v[112:115], v[16:19]
    ds_read_b128 v[96:99], v192 offset:2048
    ds_read_b64_tr_b16 v[128:129], v9 offset:0
    v_mfma_f32_16x16x32_bf16 v[20:23], v[164:167], v[112:115], v[20:23]
    ds_read_b64_tr_b16 v[130:131], v9 offset:2816
    ds_read_b64_tr_b16 v[132:133], v194 offset:0
    v_mfma_f32_16x16x32_bf16 v[24:27], v[168:171], v[112:115], v[24:27]
    ds_read_b64_tr_b16 v[134:135], v194 offset:2816
    ds_read_b64_tr_b16 v[136:137], v9 offset:112
    v_mfma_f32_16x16x32_bf16 v[28:31], v[172:175], v[112:115], v[28:31]
    ds_read_b64_tr_b16 v[138:139], v9 offset:2928
    ds_read_b64_tr_b16 v[140:141], v194 offset:112
    v_mfma_f32_16x16x32_bf16 v[32:35], v[112:115], v[176:179], v[32:35]
    ds_read_b64_tr_b16 v[142:143], v194 offset:2928
    ds_read_b64_tr_b16 v[144:145], v9 offset:224
    v_mfma_f32_16x16x32_bf16 v[36:39], v[112:115], v[180:183], v[36:39]
    ds_read_b64_tr_b16 v[146:147], v9 offset:3040
    ds_read_b64_tr_b16 v[148:149], v194 offset:224
    v_mfma_f32_16x16x32_bf16 v[40:43], v[160:163], v[116:119], v[40:43]
    ds_read_b64_tr_b16 v[150:151], v194 offset:3040
    v_mfma_f32_16x16x32_bf16 v[44:47], v[164:167], v[116:119], v[44:47]
    s_waitcnt lgkmcnt(8)
    ds_read_b128 v[100:103], v192 offset:4096
    v_mfma_f32_16x16x32_bf16 v[48:51], v[168:171], v[116:119], v[48:51]
    ds_read_b128 v[104:107], v192 offset:6144
    v_mfma_f32_16x16x32_bf16 v[52:55], v[172:175], v[116:119], v[52:55]
    ds_read_b128 v[108:111], v7 offset:0
    s_setprio 2
    v_mfma_f32_16x16x32_bf16 v[56:59], v[116:119], v[176:179], v[56:59]
    ds_read_b64_tr_b16 v[152:153], v195 offset:0
    v_mfma_f32_16x16x32_bf16 v[60:63], v[116:119], v[180:183], v[60:63]
    ds_read_b64_tr_b16 v[154:155], v195 offset:2816
    v_mfma_f32_16x16x32_bf16 v[64:67], v[160:163], v[120:123], v[64:67]
    ds_read_b64_tr_b16 v[156:157], v196 offset:0
    v_mfma_f32_16x16x32_bf16 v[68:71], v[164:167], v[120:123], v[68:71]
    ds_read_b64_tr_b16 v[158:159], v196 offset:2816
    v_mfma_f32_16x16x32_bf16 v[72:75], v[168:171], v[120:123], v[72:75]
    v_mfma_f32_16x16x32_bf16 v[76:79], v[172:175], v[120:123], v[76:79]
    v_mfma_f32_16x16x32_bf16 v[80:83], v[120:123], v[176:179], v[80:83]
    v_mfma_f32_16x16x32_bf16 v[84:87], v[120:123], v[180:183], v[84:87]
    v_mfma_f32_16x16x32_bf16 v[88:91], v[184:187], v[124:127], v[88:91]
    v_mfma_f32_16x16x32_bf16 v[92:95], v[124:127], v[188:191], v[92:95]
    s_waitcnt lgkmcnt(0)
    s_setprio 1
    v_mfma_f32_16x16x32_bf16 v[16:19], v[128:131], v[96:99], v[16:19]
    ds_read_b128 v[112:115], v193 offset:2048
    ds_read_b64_tr_b16 v[160:161], v9 offset:11264
    v_mfma_f32_16x16x32_bf16 v[20:23], v[132:135], v[96:99], v[20:23]
    ds_read_b64_tr_b16 v[162:163], v9 offset:14080
    ds_read_b64_tr_b16 v[164:165], v194 offset:11264
    v_mfma_f32_16x16x32_bf16 v[24:27], v[136:139], v[96:99], v[24:27]
    ds_read_b64_tr_b16 v[166:167], v194 offset:14080
    ds_read_b64_tr_b16 v[168:169], v9 offset:11376
    v_mfma_f32_16x16x32_bf16 v[28:31], v[140:143], v[96:99], v[28:31]
    ds_read_b64_tr_b16 v[170:171], v9 offset:14192
    ds_read_b64_tr_b16 v[172:173], v194 offset:11376
    v_mfma_f32_16x16x32_bf16 v[32:35], v[96:99], v[144:147], v[32:35]
    ds_read_b64_tr_b16 v[174:175], v194 offset:14192
    ds_read_b64_tr_b16 v[176:177], v9 offset:11488
    s_add_u32 s77, s77, 1
    s_cmp_eq_u32 s77, 7
    s_cselect_b32 s77, 0, s77
    s_mul_i32 s67, s77, 28672
    s_add_u32 s67, s67, s78
    s_lshl_b32 s9, s12, 12
    s_add_u32 s9, s9, 98304
    s_add_u32 m0, s9, 0
    s_add_u32 s56, s67, 0
    buffer_load_dwordx4 v244, s[44:47], s56 offen lds
    v_mfma_f32_16x16x32_bf16 v[36:39], v[96:99], v[148:151], v[36:39]
    ds_read_b64_tr_b16 v[178:179], v9 offset:14304
    ds_read_b64_tr_b16 v[180:181], v194 offset:11488
    v_mfma_f32_16x16x32_bf16 v[40:43], v[128:131], v[100:103], v[40:43]
    ds_read_b64_tr_b16 v[182:183], v194 offset:14304
    v_mfma_f32_16x16x32_bf16 v[44:47], v[132:135], v[100:103], v[44:47]
    s_waitcnt lgkmcnt(8)
    ds_read_b128 v[116:119], v193 offset:4096
    v_mfma_f32_16x16x32_bf16 v[48:51], v[136:139], v[100:103], v[48:51]
    ds_read_b128 v[120:123], v193 offset:6144
    v_mfma_f32_16x16x32_bf16 v[52:55], v[140:143], v[100:103], v[52:55]
    ds_read_b128 v[124:127], v8 offset:0
    s_add_u32 m0, s9, 1024
    s_add_u32 s56, s67, 7168
    buffer_load_dwordx4 v244, s[44:47], s56 offen lds
    s_setprio 0
    v_mfma_f32_16x16x32_bf16 v[56:59], v[100:103], v[144:147], v[56:59]
    ds_read_b64_tr_b16 v[184:185], v195 offset:11264
    v_mfma_f32_16x16x32_bf16 v[60:63], v[100:103], v[148:151], v[60:63]
    ds_read_b64_tr_b16 v[186:187], v195 offset:14080
    v_mfma_f32_16x16x32_bf16 v[64:67], v[128:131], v[104:107], v[64:67]
    ds_read_b64_tr_b16 v[188:189], v196 offset:11264
    v_mfma_f32_16x16x32_bf16 v[68:71], v[132:135], v[104:107], v[68:71]
    ds_read_b64_tr_b16 v[190:191], v196 offset:14080
    v_mfma_f32_16x16x32_bf16 v[72:75], v[136:139], v[104:107], v[72:75]
    s_add_u32 m0, s9, 2048
    s_add_u32 s56, s67, 14336
    buffer_load_dwordx4 v244, s[44:47], s56 offen lds
    v_mfma_f32_16x16x32_bf16 v[76:79], v[140:143], v[104:107], v[76:79]
    v_mfma_f32_16x16x32_bf16 v[80:83], v[104:107], v[144:147], v[80:83]
    v_mfma_f32_16x16x32_bf16 v[84:87], v[104:107], v[148:151], v[84:87]
    v_mfma_f32_16x16x32_bf16 v[88:91], v[152:155], v[108:111], v[88:91]
    v_mfma_f32_16x16x32_bf16 v[92:95], v[108:111], v[156:159], v[92:95]
    s_add_u32 m0, s9, 3072
    s_add_u32 s56, s67, 21504
    buffer_load_dwordx4 v244, s[44:47], s56 offen lds
    s_waitcnt lgkmcnt(0)
    s_setprio 3
    v_mfma_f32_16x16x32_bf16 v[16:19], v[160:163], v[112:115], v[16:19]
    v_mfma_f32_16x16x32_bf16 v[20:23], v[164:167], v[112:115], v[20:23]
    v_mfma_f32_16x16x32_bf16 v[24:27], v[168:171], v[112:115], v[24:27]
    v_mfma_f32_16x16x32_bf16 v[28:31], v[172:175], v[112:115], v[28:31]
    v_mfma_f32_16x16x32_bf16 v[32:35], v[112:115], v[176:179], v[32:35]
    v_mfma_f32_16x16x32_bf16 v[36:39], v[112:115], v[180:183], v[36:39]
    v_mfma_f32_16x16x32_bf16 v[40:43], v[160:163], v[116:119], v[40:43]
    v_mfma_f32_16x16x32_bf16 v[44:47], v[164:167], v[116:119], v[44:47]
    v_mfma_f32_16x16x32_bf16 v[48:51], v[168:171], v[116:119], v[48:51]
    v_mfma_f32_16x16x32_bf16 v[52:55], v[172:175], v[116:119], v[52:55]
    s_setprio 2
    v_mfma_f32_16x16x32_bf16 v[56:59], v[116:119], v[176:179], v[56:59]
    v_mfma_f32_16x16x32_bf16 v[60:63], v[116:119], v[180:183], v[60:63]
    v_mfma_f32_16x16x32_bf16 v[64:67], v[160:163], v[120:123], v[64:67]
    v_mfma_f32_16x16x32_bf16 v[68:71], v[164:167], v[120:123], v[68:71]
    v_mfma_f32_16x16x32_bf16 v[72:75], v[168:171], v[120:123], v[72:75]
    v_mfma_f32_16x16x32_bf16 v[76:79], v[172:175], v[120:123], v[76:79]
    v_mfma_f32_16x16x32_bf16 v[80:83], v[120:123], v[176:179], v[80:83]
    v_mfma_f32_16x16x32_bf16 v[84:87], v[120:123], v[180:183], v[84:87]
    v_mfma_f32_16x16x32_bf16 v[88:91], v[184:187], v[124:127], v[88:91]
    v_mfma_f32_16x16x32_bf16 v[92:95], v[124:127], v[188:191], v[92:95]
    s_setprio 0
    s_mov_b32 s40, s20
    s_mov_b32 s41, s21
    s_mov_b32 s42, 401408
    s_mov_b32 s43, 0x20000
    ds_read_b32 v116, v210 offset:0
    ds_read_b32 v124, v210 offset:1024
    ds_read_b32 v118, v210 offset:64
    ds_read_b32 v126, v210 offset:1088
    ds_read_b32 v120, v210 offset:128
    ds_read_b32 v192, v210 offset:1152
    ds_read_b32 v122, v210 offset:192
    ds_read_b32 v194, v210 offset:1216
    ds_write_b128 v221, v[72:75] offset:0
    ds_write_b128 v221, v[76:79] offset:1024
    ds_write_b128 v221, v[80:83] offset:2048
    ds_write_b128 v221, v[84:87] offset:3072
    ds_write_b128 v219, v[88:91]
    ds_write_b128 v220, v[92:95]
    s_waitcnt lgkmcnt(0)
    s_barrier
    ds_read_b128 v[104:107], v222 offset:2048
    ds_read_b128 v[108:111], v222 offset:3072
    ds_read_b128 v[96:99], v222
    ds_read_b128 v[100:103], v222 offset:1024
    ds_read_b128 v[128:131], v208
    ds_read_b128 v[132:135], v208 offset:1024
    ds_read_b32 v112, v223 offset:4096
    ds_read_b32 v114, v223 offset:5120
    ds_read_b128 v[136:139], v208 offset:2048
    ds_read_b128 v[140:143], v208 offset:3072
    ds_read_b128 v[88:91], v212
    ds_read_b128 v[92:95], v212 offset:1024
    s_mov_b32 s59, 0x3e8b97f6
    v_mov_b32 v12, 0xff800000
    s_waitcnt lgkmcnt(8)
    v_pk_fma_f32 v[24:25], v[118:119], v[104:105], v[24:25] op_sel_hi:[0,1,1]
    v_pk_fma_f32 v[26:27], v[118:119], v[106:107], v[26:27] op_sel_hi:[0,1,1]
    v_pk_fma_f32 v[28:29], v[118:119], v[108:109], v[28:29] op_sel_hi:[0,1,1]
    v_pk_fma_f32 v[30:31], v[118:119], v[110:111], v[30:31] op_sel_hi:[0,1,1]
    v_pk_mul_f32 v[24:25], v[126:127], v[24:25] op_sel_hi:[0,1]
    v_pk_mul_f32 v[26:27], v[126:127], v[26:27] op_sel_hi:[0,1]
    v_pk_mul_f32 v[28:29], v[126:127], v[28:29] op_sel_hi:[0,1]
    v_pk_mul_f32 v[30:31], v[126:127], v[30:31] op_sel_hi:[0,1]
    v_cvt_pk_bf16_f32 v24, v24, v25
    v_cvt_pk_bf16_f32 v25, v26, v27
    v_cvt_pk_bf16_f32 v26, v28, v29
    v_cvt_pk_bf16_f32 v27, v30, v31
    v_pk_fma_f32 v[16:17], v[118:119], v[96:97], v[16:17] op_sel_hi:[0,1,1]
    v_pk_fma_f32 v[18:19], v[118:119], v[98:99], v[18:19] op_sel_hi:[0,1,1]
    v_pk_fma_f32 v[20:21], v[118:119], v[100:101], v[20:21] op_sel_hi:[0,1,1]
    v_pk_fma_f32 v[22:23], v[118:119], v[102:103], v[22:23] op_sel_hi:[0,1,1]
    v_pk_mul_f32 v[16:17], v[126:127], v[16:17] op_sel_hi:[0,1]
    v_pk_mul_f32 v[18:19], v[126:127], v[18:19] op_sel_hi:[0,1]
    v_pk_mul_f32 v[20:21], v[126:127], v[20:21] op_sel_hi:[0,1]
    v_pk_mul_f32 v[22:23], v[126:127], v[22:23] op_sel_hi:[0,1]
    v_cvt_pk_bf16_f32 v16, v16, v17
    v_cvt_pk_bf16_f32 v17, v18, v19
    v_cvt_pk_bf16_f32 v18, v20, v21
    v_cvt_pk_bf16_f32 v19, v22, v23
    s_waitcnt lgkmcnt(0)
    v_pk_fma_f32 v[136:137], v[88:89], v[112:113], v[136:137] op_sel_hi:[1,0,1]
    v_pk_fma_f32 v[138:139], v[90:91], v[112:113], v[138:139] op_sel_hi:[1,0,1]
    v_pk_fma_f32 v[140:141], v[88:89], v[114:115], v[140:141] op_sel_hi:[1,0,1]
    v_pk_fma_f32 v[142:143], v[90:91], v[114:115], v[142:143] op_sel_hi:[1,0,1]
    v_pk_mul_f32 v[136:137], v[92:93], v[136:137]
    v_pk_mul_f32 v[138:139], v[94:95], v[138:139]
    v_pk_mul_f32 v[140:141], v[92:93], v[140:141]
    v_pk_mul_f32 v[142:143], v[94:95], v[142:143]
    v_cvt_pk_bf16_f32 v144, v136, v137
    v_cvt_pk_bf16_f32 v145, v138, v139
    v_cvt_pk_bf16_f32 v152, v140, v141
    v_cvt_pk_bf16_f32 v153, v142, v143
    ds_read_b128 v[88:91], v212 offset:64
    ds_read_b128 v[92:95], v212 offset:1088
    v_pk_fma_f32 v[128:129], v[116:117], v[104:105], v[128:129] op_sel_hi:[0,1,1]
    v_pk_fma_f32 v[130:131], v[116:117], v[106:107], v[130:131] op_sel_hi:[0,1,1]
    v_pk_fma_f32 v[132:133], v[116:117], v[108:109], v[132:133] op_sel_hi:[0,1,1]
    v_pk_fma_f32 v[134:135], v[116:117], v[110:111], v[134:135] op_sel_hi:[0,1,1]
    v_pk_mul_f32 v[128:129], v[124:125], v[128:129] op_sel_hi:[0,1]
    v_pk_mul_f32 v[130:131], v[124:125], v[130:131] op_sel_hi:[0,1]
    v_pk_mul_f32 v[132:133], v[124:125], v[132:133] op_sel_hi:[0,1]
    v_pk_mul_f32 v[134:135], v[124:125], v[134:135] op_sel_hi:[0,1]
    v_cvt_pk_bf16_f32 v128, v128, v129
    v_cvt_pk_bf16_f32 v129, v130, v131
    v_cvt_pk_bf16_f32 v130, v132, v133
    v_cvt_pk_bf16_f32 v131, v134, v135
    v_pk_fma_f32 v[48:49], v[120:121], v[104:105], v[48:49] op_sel_hi:[0,1,1]
    v_pk_fma_f32 v[50:51], v[120:121], v[106:107], v[50:51] op_sel_hi:[0,1,1]
    v_pk_fma_f32 v[52:53], v[120:121], v[108:109], v[52:53] op_sel_hi:[0,1,1]
    v_pk_fma_f32 v[54:55], v[120:121], v[110:111], v[54:55] op_sel_hi:[0,1,1]
    v_pk_mul_f32 v[48:49], v[192:193], v[48:49] op_sel_hi:[0,1]
    v_pk_mul_f32 v[50:51], v[192:193], v[50:51] op_sel_hi:[0,1]
    v_pk_mul_f32 v[52:53], v[192:193], v[52:53] op_sel_hi:[0,1]
    v_pk_mul_f32 v[54:55], v[192:193], v[54:55] op_sel_hi:[0,1]
    v_cvt_pk_bf16_f32 v48, v48, v49
    v_cvt_pk_bf16_f32 v49, v50, v51
    v_cvt_pk_bf16_f32 v50, v52, v53
    v_cvt_pk_bf16_f32 v51, v54, v55
    s_waitcnt lgkmcnt(0)
    v_pk_fma_f32 v[32:33], v[88:89], v[112:113], v[32:33] op_sel_hi:[1,0,1]
    v_pk_fma_f32 v[34:35], v[90:91], v[112:113], v[34:35] op_sel_hi:[1,0,1]
    v_pk_fma_f32 v[36:37], v[88:89], v[114:115], v[36:37] op_sel_hi:[1,0,1]
    v_pk_fma_f32 v[38:39], v[90:91], v[114:115], v[38:39] op_sel_hi:[1,0,1]
    v_pk_mul_f32 v[32:33], v[92:93], v[32:33]
    v_pk_mul_f32 v[34:35], v[94:95], v[34:35]
    v_pk_mul_f32 v[36:37], v[92:93], v[36:37]
    v_pk_mul_f32 v[38:39], v[94:95], v[38:39]
    v_cvt_pk_bf16_f32 v146, v32, v33
    v_cvt_pk_bf16_f32 v147, v34, v35
    v_cvt_pk_bf16_f32 v154, v36, v37
    v_cvt_pk_bf16_f32 v155, v38, v39
    ds_read_b128 v[88:91], v212 offset:128
    ds_read_b128 v[92:95], v212 offset:1152
    v_pk_fma_f32 v[40:41], v[120:121], v[96:97], v[40:41] op_sel_hi:[0,1,1]
    v_pk_fma_f32 v[42:43], v[120:121], v[98:99], v[42:43] op_sel_hi:[0,1,1]
    v_pk_fma_f32 v[44:45], v[120:121], v[100:101], v[44:45] op_sel_hi:[0,1,1]
    v_pk_fma_f32 v[46:47], v[120:121], v[102:103], v[46:47] op_sel_hi:[0,1,1]
    v_pk_mul_f32 v[40:41], v[192:193], v[40:41] op_sel_hi:[0,1]
    v_pk_mul_f32 v[42:43], v[192:193], v[42:43] op_sel_hi:[0,1]
    v_pk_mul_f32 v[44:45], v[192:193], v[44:45] op_sel_hi:[0,1]
    v_pk_mul_f32 v[46:47], v[192:193], v[46:47] op_sel_hi:[0,1]
    v_cvt_pk_bf16_f32 v40, v40, v41
    v_cvt_pk_bf16_f32 v41, v42, v43
    v_cvt_pk_bf16_f32 v42, v44, v45
    v_cvt_pk_bf16_f32 v43, v46, v47
    v_pk_fma_f32 v[72:73], v[122:123], v[104:105], v[72:73] op_sel_hi:[0,1,1]
    v_pk_fma_f32 v[74:75], v[122:123], v[106:107], v[74:75] op_sel_hi:[0,1,1]
    v_pk_fma_f32 v[76:77], v[122:123], v[108:109], v[76:77] op_sel_hi:[0,1,1]
    v_pk_fma_f32 v[78:79], v[122:123], v[110:111], v[78:79] op_sel_hi:[0,1,1]
    v_pk_mul_f32 v[72:73], v[194:195], v[72:73] op_sel_hi:[0,1]
    v_pk_mul_f32 v[74:75], v[194:195], v[74:75] op_sel_hi:[0,1]
    v_pk_mul_f32 v[76:77], v[194:195], v[76:77] op_sel_hi:[0,1]
    v_pk_mul_f32 v[78:79], v[194:195], v[78:79] op_sel_hi:[0,1]
    v_cvt_pk_bf16_f32 v72, v72, v73
    v_cvt_pk_bf16_f32 v73, v74, v75
    v_cvt_pk_bf16_f32 v74, v76, v77
    v_cvt_pk_bf16_f32 v75, v78, v79
    s_waitcnt lgkmcnt(0)
    v_pk_fma_f32 v[56:57], v[88:89], v[112:113], v[56:57] op_sel_hi:[1,0,1]
    v_pk_fma_f32 v[58:59], v[90:91], v[112:113], v[58:59] op_sel_hi:[1,0,1]
    v_pk_fma_f32 v[60:61], v[88:89], v[114:115], v[60:61] op_sel_hi:[1,0,1]
    v_pk_fma_f32 v[62:63], v[90:91], v[114:115], v[62:63] op_sel_hi:[1,0,1]
    v_pk_mul_f32 v[56:57], v[92:93], v[56:57]
    v_pk_mul_f32 v[58:59], v[94:95], v[58:59]
    v_pk_mul_f32 v[60:61], v[92:93], v[60:61]
    v_pk_mul_f32 v[62:63], v[94:95], v[62:63]
    v_cvt_pk_bf16_f32 v148, v56, v57
    v_cvt_pk_bf16_f32 v149, v58, v59
    v_cvt_pk_bf16_f32 v156, v60, v61
    v_cvt_pk_bf16_f32 v157, v62, v63
    ds_read_b128 v[88:91], v212 offset:192
    ds_read_b128 v[92:95], v212 offset:1216
    v_pk_fma_f32 v[64:65], v[122:123], v[96:97], v[64:65] op_sel_hi:[0,1,1]
    v_pk_fma_f32 v[66:67], v[122:123], v[98:99], v[66:67] op_sel_hi:[0,1,1]
    v_pk_fma_f32 v[68:69], v[122:123], v[100:101], v[68:69] op_sel_hi:[0,1,1]
    v_pk_fma_f32 v[70:71], v[122:123], v[102:103], v[70:71] op_sel_hi:[0,1,1]
    v_pk_mul_f32 v[64:65], v[194:195], v[64:65] op_sel_hi:[0,1]
    v_pk_mul_f32 v[66:67], v[194:195], v[66:67] op_sel_hi:[0,1]
    v_pk_mul_f32 v[68:69], v[194:195], v[68:69] op_sel_hi:[0,1]
    v_pk_mul_f32 v[70:71], v[194:195], v[70:71] op_sel_hi:[0,1]
    v_cvt_pk_bf16_f32 v64, v64, v65
    v_cvt_pk_bf16_f32 v65, v66, v67
    v_cvt_pk_bf16_f32 v66, v68, v69
    v_cvt_pk_bf16_f32 v67, v70, v71
    v_cndmask_b32 v18, v18, 0, s[82:83]
    v_cndmask_b32 v19, v19, 0, s[82:83]
    v_cndmask_b32 v42, v42, 0, s[82:83]
    v_cndmask_b32 v43, v43, 0, s[82:83]
    v_cndmask_b32 v66, v66, 0, s[82:83]
    v_cndmask_b32 v67, v67, 0, s[82:83]
    s_waitcnt lgkmcnt(0)
    v_pk_fma_f32 v[80:81], v[88:89], v[112:113], v[80:81] op_sel_hi:[1,0,1]
    v_pk_fma_f32 v[82:83], v[90:91], v[112:113], v[82:83] op_sel_hi:[1,0,1]
    v_pk_fma_f32 v[84:85], v[88:89], v[114:115], v[84:85] op_sel_hi:[1,0,1]
    v_pk_fma_f32 v[86:87], v[90:91], v[114:115], v[86:87] op_sel_hi:[1,0,1]
    v_pk_mul_f32 v[80:81], v[92:93], v[80:81]
    v_pk_mul_f32 v[82:83], v[94:95], v[82:83]
    v_pk_mul_f32 v[84:85], v[92:93], v[84:85]
    v_pk_mul_f32 v[86:87], v[94:95], v[86:87]
    v_cvt_pk_bf16_f32 v150, v80, v81
    v_cvt_pk_bf16_f32 v151, v82, v83
    v_cvt_pk_bf16_f32 v158, v84, v85
    v_cvt_pk_bf16_f32 v159, v86, v87
    s_barrier
    v_mfma_f32_16x16x32_bf16 v[20:23], v[128:131], v[16:19], 0
    v_mfma_f32_16x16x32_bf16 v[28:31], v[24:27], v[16:19], 0
    v_mfma_f32_16x16x32_bf16 v[44:47], v[24:27], v[40:43], 0
    v_mfma_f32_16x16x32_bf16 v[52:55], v[48:51], v[40:43], 0
    v_mfma_f32_16x16x32_bf16 v[68:71], v[48:51], v[64:67], 0
    v_mfma_f32_16x16x32_bf16 v[76:79], v[72:75], v[64:67], 0
    s_nop 3
    v_cndmask_b32 v32, v20, v21, s[86:87]
    v_cndmask_b32 v33, v22, v23, s[86:87]
    v_cndmask_b32 v34, v28, v29, s[86:87]
    v_cndmask_b32 v35, v30, v31, s[86:87]
    v_cndmask_b32 v56, v44, v45, s[86:87]
    v_cndmask_b32 v57, v46, v47, s[86:87]
    v_cndmask_b32 v58, v52, v53, s[86:87]
    v_cndmask_b32 v59, v54, v55, s[86:87]
    v_cndmask_b32 v80, v68, v69, s[86:87]
    v_cndmask_b32 v81, v70, v71, s[86:87]
    v_cndmask_b32 v82, v76, v77, s[86:87]
    v_cndmask_b32 v83, v78, v79, s[86:87]
    v_cndmask_b32 v32, v32, v12, s[92:93]
    v_cndmask_b32 v33, v33, v12, s[92:93]
    v_cndmask_b32 v32, v32, v34, s[88:89]
    v_cndmask_b32 v33, v33, v35, s[90:91]
    v_cndmask_b32 v56, v56, v58, s[88:89]
    v_cndmask_b32 v57, v57, v59, s[90:91]
    v_cndmask_b32 v80, v80, v82, s[88:89]
    v_cndmask_b32 v81, v81, v83, s[90:91]
    v_max_f32 v34, v32, v33
    v_max_f32 v58, v56, v57
    v_max_f32 v82, v80, v81
    v_mov_b32 v35, v34
    v_mov_b32 v59, v58
    v_mov_b32 v83, v82
    s_nop 1
    v_permlane16_swap_b32 v34, v35
    v_permlane16_swap_b32 v58, v59
    v_permlane16_swap_b32 v82, v83
    s_nop 0
    v_max_f32 v34, v34, v35
    v_max_f32 v58, v58, v59
    v_max_f32 v82, v82, v83
    v_mov_b32 v35, v34
    v_mov_b32 v59, v58
    v_mov_b32 v83, v82
    s_nop 1
    v_permlane32_swap_b32 v34, v35
    v_permlane32_swap_b32 v58, v59
    v_permlane32_swap_b32 v82, v83
    s_nop 0
    v_max_f32 v34, v34, v35
    v_max_f32 v58, v58, v59
    v_max_f32 v82, v82, v83
    v_sub_f32 v32, v32, v34
    v_sub_f32 v33, v33, v34
    v_sub_f32 v56, v56, v58
    v_sub_f32 v57, v57, v58
    v_sub_f32 v80, v80, v82
    v_sub_f32 v81, v81, v82
    v_mul_f32 v32, s59, v32
    v_mul_f32 v33, s59, v33
    v_mul_f32 v56, s59, v56
    v_mul_f32 v57, s59, v57
    v_mul_f32 v80, s59, v80
    v_mul_f32 v81, s59, v81
    v_exp_f32 v32, v32
    v_exp_f32 v33, v33
    v_exp_f32 v56, v56
    v_exp_f32 v57, v57
    v_exp_f32 v80, v80
    v_exp_f32 v81, v81
    s_nop 0
    v_add_f32 v34, v32, v33
    v_add_f32 v58, v56, v57
    v_add_f32 v82, v80, v81
    v_mov_b32 v35, v34
    v_mov_b32 v59, v58
    v_mov_b32 v83, v82
    s_nop 1
    v_permlane16_swap_b32 v34, v35
    v_permlane16_swap_b32 v58, v59
    v_permlane16_swap_b32 v82, v83
    s_nop 0
    v_add_f32 v34, v34, v35
    v_add_f32 v58, v58, v59
    v_add_f32 v82, v82, v83
    v_mov_b32 v35, v34
    v_mov_b32 v59, v58
    v_mov_b32 v83, v82
    s_nop 1
    v_permlane32_swap_b32 v34, v35
    v_permlane32_swap_b32 v58, v59
    v_permlane32_swap_b32 v82, v83
    s_nop 0
    v_add_f32 v34, v34, v35
    v_add_f32 v58, v58, v59
    v_add_f32 v82, v82, v83
    v_rcp_f32 v34, v34
    v_rcp_f32 v58, v58
    v_rcp_f32 v82, v82
    s_nop 0
    v_mul_f32 v32, v32, v34
    v_mul_f32 v33, v33, v34
    v_mul_f32 v56, v56, v58
    v_mul_f32 v57, v57, v58
    v_mul_f32 v80, v80, v82
    v_mul_f32 v81, v81, v82
    v_cvt_pk_bf16_f32 v32, v32, v33
    v_cvt_pk_bf16_f32 v56, v56, v57
    v_cvt_pk_bf16_f32 v80, v80, v81
    v_perm_b32 v36, v32, v32, v209
    v_perm_b32 v37, v32, v32, v211
    v_perm_b32 v38, v32, v32, v213
    v_perm_b32 v39, v32, v32, v215
    v_perm_b32 v60, v56, v56, v209
    v_perm_b32 v61, v56, v56, v211
    v_perm_b32 v62, v56, v56, v213
    v_perm_b32 v63, v56, v56, v215
    v_perm_b32 v84, v80, v80, v209
    v_perm_b32 v85, v80, v80, v211
    v_perm_b32 v86, v80, v80, v213
    v_perm_b32 v87, v80, v80, v215
    s_nop 1
    v_mfma_f32_16x16x32_bf16 v[16:19], v[144:147], v[36:39], 0
    v_mfma_f32_16x16x32_bf16 v[20:23], v[152:155], v[36:39], 0
    v_mfma_f32_16x16x32_bf16 v[40:43], v[146:149], v[60:63], 0
    v_mfma_f32_16x16x32_bf16 v[44:47], v[154:157], v[60:63], 0
    v_mfma_f32_16x16x32_bf16 v[64:67], v[148:151], v[84:87], 0
    v_mfma_f32_16x16x32_bf16 v[68:71], v[156:159], v[84:87], 0
    s_nop 3
    v_cvt_pk_bf16_f32 v24, v16, v17
    v_cvt_pk_bf16_f32 v25, v18, v19
    v_cvt_pk_bf16_f32 v26, v20, v21
    v_cvt_pk_bf16_f32 v27, v22, v23
    s_add_u32 s56, s94, 0
    buffer_store_dwordx4 v[24:27], v216, s[48:51], s56 offen sc1
    v_cvt_pk_bf16_f32 v48, v40, v41
    v_cvt_pk_bf16_f32 v49, v42, v43
    v_cvt_pk_bf16_f32 v50, v44, v45
    v_cvt_pk_bf16_f32 v51, v46, v47
    s_add_u32 s56, s94, 16384
    buffer_store_dwordx4 v[48:51], v216, s[48:51], s56 offen sc1
    v_cvt_pk_bf16_f32 v72, v64, v65
    v_cvt_pk_bf16_f32 v73, v66, v67
    v_cvt_pk_bf16_f32 v74, v68, v69
    v_cvt_pk_bf16_f32 v75, v70, v71
    s_add_u32 s56, s94, 32768
    buffer_store_dwordx4 v[72:75], v216, s[48:51], s56 offen sc1
    s_cmp_lt_u32 s70, 12
    s_cbranch_scc1 kA_p2
    s_waitcnt vmcnt(0)
    s_barrier
    s_cmp_lg_u32 s12, 0
    s_cbranch_scc1 k_done
    v_mov_b32 v2, s68
    v_mov_b32 v3, s69
    v_mov_b32 v4, 0
    s_mov_b64 exec, 1
    buffer_store_dwordx2 v[2:3], v4, s[48:51], s95 offen sc0 sc1
    s_mov_b64 exec, -1
    s_endpgm
kA_p2:
    s_waitcnt vmcnt(0)
    s_barrier
    v_mov_b32 v6, v250
    v_mov_b32 v7, v247
    s_cmp_lg_u32 s12, 0
    s_cbranch_scc1 kk_w0_17
    v_mov_b32 v2, s68
    v_mov_b32 v3, s69
    v_mov_b32 v4, 0
    s_mov_b64 exec, 1
    buffer_store_dwordx2 v[2:3], v4, s[48:51], s95 offen sc0 sc1
    s_mov_b64 exec, -1
kk_w0_17:
    s_add_u32 s77, s77, 1
    s_cmp_eq_u32 s77, 7
    s_cselect_b32 s77, 0, s77
    s_mul_i32 s67, s77, 28672
    s_add_u32 s67, s67, s78
    s_lshl_b32 s9, s12, 12
    s_add_u32 s9, s9, 0
    s_add_u32 m0, s9, 0
    s_add_u32 s56, s67, 0
    buffer_load_dwordx4 v244, s[44:47], s56 offen lds
    s_add_u32 m0, s9, 1024
    s_add_u32 s56, s67, 7168
    buffer_load_dwordx4 v244, s[44:47], s56 offen lds
    s_add_u32 m0, s9, 2048
    s_add_u32 s56, s67, 14336
    buffer_load_dwordx4 v244, s[44:47], s56 offen lds
    s_add_u32 m0, s9, 3072
    s_add_u32 s56, s67, 21504
    buffer_load_dwordx4 v244, s[44:47], s56 offen lds
    s_add_u32 s77, s77, 1
    s_cmp_eq_u32 s77, 7
    s_cselect_b32 s77, 0, s77
    s_mul_i32 s67, s77, 28672
    s_add_u32 s67, s67, s78
    s_lshl_b32 s9, s12, 12
    s_add_u32 s9, s9, s7
    s_add_u32 m0, s9, 0
    s_add_u32 s56, s67, 0
    buffer_load_dwordx4 v244, s[44:47], s56 offen lds
    s_add_u32 m0, s9, 1024
    s_add_u32 s56, s67, 7168
    buffer_load_dwordx4 v244, s[44:47], s56 offen lds
    s_add_u32 m0, s9, 2048
    s_add_u32 s56, s67, 14336
    buffer_load_dwordx4 v244, s[44:47], s56 offen lds
    s_add_u32 m0, s9, 3072
    s_add_u32 s56, s67, 21504
    buffer_load_dwordx4 v244, s[44:47], s56 offen lds
    s_waitcnt lgkmcnt(7)
    v_add_u32 v240, 49152, v246
    v_xor_b32 v241, 32, v240
    v_xor_b32 v242, 64, v240
    v_xor_b32 v243, 96, v240
    ds_read_b64_tr_b16 v[208:209], v240 offset:0
    ds_read_b64_tr_b16 v[210:211], v240 offset:2048
    ds_read_b64_tr_b16 v[212:213], v241 offset:0
    ds_read_b64_tr_b16 v[214:215], v241 offset:2048
    ds_read_b64_tr_b16 v[216:217], v242 offset:0
    ds_read_b64_tr_b16 v[218:219], v242 offset:2048
    ds_read_b64_tr_b16 v[220:221], v243 offset:0
    ds_read_b64_tr_b16 v[222:223], v243 offset:2048
    s_waitcnt lgkmcnt(0)
    s_add_u32 s77, s77, 1
    s_cmp_eq_u32 s77, 7
    s_cselect_b32 s77, 0, s77
    s_mul_i32 s67, s77, 28672
    s_add_u32 s67, s67, s78
    s_lshl_b32 s9, s12, 12
    s_add_u32 s9, s9, 49152
    s_add_u32 m0, s9, 0
    s_add_u32 s56, s67, 0
    buffer_load_dwordx4 v244, s[44:47], s56 offen lds
    s_add_u32 m0, s9, 1024
    s_add_u32 s56, s67, 7168
    buffer_load_dwordx4 v244, s[44:47], s56 offen lds
    s_add_u32 m0, s9, 2048
    s_add_u32 s56, s67, 14336
    buffer_load_dwordx4 v244, s[44:47], s56 offen lds
    s_add_u32 m0, s9, 3072
    s_add_u32 s56, s67, 21504
    buffer_load_dwordx4 v244, s[44:47], s56 offen lds
    s_waitcnt lgkmcnt(7)
    v_add_u32 v240, 98304, v246
    v_xor_b32 v241, 32, v240
    v_xor_b32 v242, 64, v240
    v_xor_b32 v243, 96, v240
    ds_read_b64_tr_b16 v[224:225], v240 offset:0
    ds_read_b64_tr_b16 v[226:227], v240 offset:2048
    ds_read_b64_tr_b16 v[228:229], v241 offset:0
    ds_read_b64_tr_b16 v[230:231], v241 offset:2048
    ds_read_b64_tr_b16 v[232:233], v242 offset:0
    ds_read_b64_tr_b16 v[234:235], v242 offset:2048
    ds_read_b64_tr_b16 v[236:237], v243 offset:0
    ds_read_b64_tr_b16 v[238:239], v243 offset:2048
    s_waitcnt lgkmcnt(0)
    s_add_u32 s77, s77, 1
    s_cmp_eq_u32 s77, 7
    s_cselect_b32 s77, 0, s77
    s_mul_i32 s67, s77, 28672
    s_add_u32 s67, s67, s78
    s_lshl_b32 s9, s12, 12
    s_add_u32 s9, s9, 98304
    s_add_u32 m0, s9, 0
    s_add_u32 s56, s67, 0
    buffer_load_dwordx4 v244, s[44:47], s56 offen lds
    s_add_u32 m0, s9, 1024
    s_add_u32 s56, s67, 7168
    buffer_load_dwordx4 v244, s[44:47], s56 offen lds
    s_add_u32 m0, s9, 2048
    s_add_u32 s56, s67, 14336
    buffer_load_dwordx4 v244, s[44:47], s56 offen lds
    s_add_u32 m0, s9, 3072
    s_add_u32 s56, s67, 21504
    buffer_load_dwordx4 v244, s[44:47], s56 offen lds
    s_waitcnt vmcnt(12) lgkmcnt(7)
    v_add_u32 v240, 0, v246
    v_xor_b32 v241, 32, v240
    v_xor_b32 v242, 64, v240
    v_xor_b32 v243, 96, v240
    ds_read_b64_tr_b16 v[160:161], v240 offset:0
    ds_read_b64_tr_b16 v[162:163], v240 offset:2048
    ds_read_b64_tr_b16 v[164:165], v241 offset:0
    ds_read_b64_tr_b16 v[166:167], v241 offset:2048
    ds_read_b64_tr_b16 v[168:169], v242 offset:0
    ds_read_b64_tr_b16 v[170:171], v242 offset:2048
    ds_read_b64_tr_b16 v[172:173], v243 offset:0
    ds_read_b64_tr_b16 v[174:175], v243 offset:2048
    s_waitcnt lgkmcnt(0)
    s_add_u32 s77, s77, 1
    s_cmp_eq_u32 s77, 7
    s_cselect_b32 s77, 0, s77
    s_mul_i32 s67, s77, 28672
    s_add_u32 s67, s67, s78
    s_lshl_b32 s9, s12, 12
    s_add_u32 s9, s9, 0
    s_add_u32 m0, s9, 0
    s_add_u32 s56, s67, 0
    buffer_load_dwordx4 v244, s[44:47], s56 offen lds
    s_add_u32 m0, s9, 1024
    s_add_u32 s56, s67, 7168
    buffer_load_dwordx4 v244, s[44:47], s56 offen lds
    s_add_u32 m0, s9, 2048
    s_add_u32 s56, s67, 14336
    buffer_load_dwordx4 v244, s[44:47], s56 offen lds
    s_add_u32 m0, s9, 3072
    s_add_u32 s56, s67, 21504
    buffer_load_dwordx4 v244, s[44:47], s56 offen lds
    s_waitcnt vmcnt(12) lgkmcnt(7)
    v_add_u32 v240, s7, v246
    v_xor_b32 v241, 32, v240
    v_xor_b32 v242, 64, v240
    v_xor_b32 v243, 96, v240
    ds_read_b64_tr_b16 v[176:177], v240 offset:0
    ds_read_b64_tr_b16 v[178:179], v240 offset:2048
    ds_read_b64_tr_b16 v[180:181], v241 offset:0
    ds_read_b64_tr_b16 v[182:183], v241 offset:2048
    ds_read_b64_tr_b16 v[184:185], v242 offset:0
    ds_read_b64_tr_b16 v[186:187], v242 offset:2048
    ds_read_b64_tr_b16 v[188:189], v243 offset:0
    ds_read_b64_tr_b16 v[190:191], v243 offset:2048
    s_waitcnt lgkmcnt(0)
    s_add_u32 s67, s79, 0
    s_lshl_b32 s9, s12, 12
    s_add_u32 s9, s9, s7
    s_add_u32 m0, s9, 0
    s_add_u32 s56, s67, 0
    buffer_load_dwordx4 v244, s[40:43], s56 offen lds
    s_add_u32 m0, s9, 1024
    s_add_u32 s56, s67, 7168
    buffer_load_dwordx4 v244, s[40:43], s56 offen lds
    s_add_u32 m0, s9, 2048
    s_add_u32 s56, s67, 14336
    buffer_load_dwordx4 v244, s[40:43], s56 offen lds
    s_add_u32 m0, s9, 3072
    s_add_u32 s56, s67, 21504
    buffer_load_dwordx4 v245, s[40:43], s56 offen lds
    s_waitcnt vmcnt(12) lgkmcnt(7)
    v_add_u32 v240, 49152, v246
    v_xor_b32 v241, 32, v240
    v_xor_b32 v242, 64, v240
    v_xor_b32 v243, 96, v240
    ds_read_b64_tr_b16 v[192:193], v240 offset:0
    ds_read_b64_tr_b16 v[194:195], v240 offset:2048
    ds_read_b64_tr_b16 v[196:197], v241 offset:0
    ds_read_b64_tr_b16 v[198:199], v241 offset:2048
    ds_read_b64_tr_b16 v[200:201], v242 offset:0
    ds_read_b64_tr_b16 v[202:203], v242 offset:2048
    ds_read_b64_tr_b16 v[204:205], v243 offset:0
    ds_read_b64_tr_b16 v[206:207], v243 offset:2048
    s_waitcnt lgkmcnt(0)
    s_add_u32 s67, s79, 25088
    s_lshl_b32 s9, s12, 12
    s_add_u32 s9, s9, 49152
    s_add_u32 m0, s9, 0
    s_add_u32 s56, s67, 0
    buffer_load_dwordx4 v244, s[40:43], s56 offen lds
    s_add_u32 m0, s9, 1024
    s_add_u32 s56, s67, 7168
    buffer_load_dwordx4 v244, s[40:43], s56 offen lds
    s_add_u32 m0, s9, 2048
    s_add_u32 s56, s67, 14336
    buffer_load_dwordx4 v244, s[40:43], s56 offen lds
    s_add_u32 m0, s9, 3072
    s_add_u32 s56, s67, 21504
    buffer_load_dwordx4 v245, s[40:43], s56 offen lds
    s_mul_i32 s56, s70, 174
    s_movk_i32 s57, 96
    s_movk_i32 s58, 2048
    v_lshrrev_b32 v4, 4, v1
    v_lshlrev_b32 v4, 8, v4
    v_add_u32 v4, 12582912, v4
    s_lshl_b32 s59, 7, 4
    v_and_b32 v112, 15, v1
    v_add_u32 v112, s59, v112
    v_cmp_lt_u32 vcc, 95, v112
    v_cmp_ne_u32 s[60:61], 0, v112
    v_cmp_ne_u32 s[64:65], s57, v112
    v_subbrev_co_u32 v112, vcc, 1, v112, vcc
    s_and_b64 s[60:61], s[60:61], s[64:65]
    v_add_u32 v112, s56, v112
    v_cmp_gt_u32 vcc, s58, v112
    v_lshrrev_b32 v5, 4, v112
    v_and_b32 v112, 15, v112
    s_and_b64 s[60:61], s[60:61], vcc
    v_lshl_add_u32 v112, v112, 4, v4
    v_lshl_add_u32 v112, v5, 14, v112
    v_mov_b32 v5, 2147483648
    v_cndmask_b32 v112, v5, v112, s[60:61]
    s_lshl_b32 s59, 9, 4
    v_and_b32 v113, 15, v1
    v_add_u32 v113, s59, v113
    v_cmp_lt_u32 vcc, 95, v113
    v_cmp_ne_u32 s[60:61], 0, v113
    v_cmp_ne_u32 s[64:65], s57, v113
    v_subbrev_co_u32 v113, vcc, 1, v113, vcc
    s_and_b64 s[60:61], s[60:61], s[64:65]
    v_add_u32 v113, s56, v113
    v_cmp_gt_u32 vcc, s58, v113
    v_lshrrev_b32 v5, 4, v113
    v_and_b32 v113, 15, v113
    s_and_b64 s[60:61], s[60:61], vcc
    v_lshl_add_u32 v113, v113, 4, v4
    v_lshl_add_u32 v113, v5, 14, v113
    v_mov_b32 v5, 2147483648
    v_cndmask_b32 v113, v5, v113, s[60:61]
    s_lshl_b32 s59, 10, 4
    v_and_b32 v114, 15, v1
    v_add_u32 v114, s59, v114
    v_cmp_lt_u32 vcc, 95, v114
    v_cmp_ne_u32 s[60:61], 0, v114
    v_cmp_ne_u32 s[64:65], s57, v114
    v_subbrev_co_u32 v114, vcc, 1, v114, vcc
    s_and_b64 s[60:61], s[60:61], s[64:65]
    v_add_u32 v114, s56, v114
    v_cmp_gt_u32 vcc, s58, v114
    v_lshrrev_b32 v5, 4, v114
    v_and_b32 v114, 15, v114
    s_and_b64 s[60:61], s[60:61], vcc
    v_lshl_add_u32 v114, v114, 4, v4
    v_lshl_add_u32 v114, v5, 14, v114
    v_mov_b32 v5, 2147483648
    v_cndmask_b32 v114, v5, v114, s[60:61]
    v_lshlrev_b32 v5, 4, v1
    s_mul_i32 s64, s12, 7168
    s_add_u32 s66, s64, 7168
    s_lshl_b32 s65, s76, 10
    s_add_u32 s65, s65, s64
    s_sub_u32 s65, s65, 1024
    s_lshl_b32 s63, s12, 11
    s_cmp_lg_u32 s12, 0
    s_cbranch_scc1 kk_pok_18
    s_mov_b32 s57, 0
    s_mov_b32 exec_hi, 0
kk_psp_19:
    buffer_load_dwordx2 v[2:3], v7, s[48:51], 0 offen sc0 sc1
    s_add_u32 s57, s57, 1
    s_waitcnt vmcnt(0)
    v_cmp_ne_u64 vcc, s[68:69], v[2:3]
    s_cmp_eq_u64 vcc, 0
    s_cbranch_scc1 kk_pok_18
    s_sleep 2
    s_cmp_lt_u32 s57, 32768
    s_cbranch_scc1 kk_psp_19
kk_pok_18:
    s_mov_b32 exec_hi, -1
    s_barrier
    s_add_u32 s65, s65, 1024
    s_cmp_eq_u32 s65, s66
    s_cselect_b32 s65, s64, s65
    s_add_u32 s56, s72, s65
    buffer_load_dwordx4 v[64:67], v5, s[48:51], s56 offen sc1
    s_add_u32 s56, s73, s65
    buffer_load_dwordx4 v[68:71], v5, s[48:51], s56 offen sc1
    s_add_u32 s56, s74, s65
    buffer_load_dwordx4 v[72:75], v5, s[48:51], s56 offen sc1
    s_add_u32 s65, s65, 1024
    s_cmp_eq_u32 s65, s66
    s_cselect_b32 s65, s64, s65
    s_add_u32 s56, s72, s65
    buffer_load_dwordx4 v[76:79], v5, s[48:51], s56 offen sc1
    s_add_u32 s56, s73, s65
    buffer_load_dwordx4 v[80:83], v5, s[48:51], s56 offen sc1
    s_add_u32 s56, s74, s65
    buffer_load_dwordx4 v[84:87], v5, s[48:51], s56 offen sc1
    s_add_u32 s65, s65, 1024
    s_cmp_eq_u32 s65, s66
    s_cselect_b32 s65, s64, s65
    s_add_u32 s56, s72, s65
    buffer_load_dwordx4 v[88:91], v5, s[48:51], s56 offen sc1
    s_add_u32 s56, s73, s65
    buffer_load_dwordx4 v[92:95], v5, s[48:51], s56 offen sc1
    buffer_load_dwordx4 v[12:15], v6, s[36:39], 0 offen
    s_waitcnt vmcnt(21) lgkmcnt(7)
    v_add_u32 v240, 98304, v246
    v_xor_b32 v241, 32, v240
    v_xor_b32 v242, 64, v240
    v_xor_b32 v243, 96, v240
    ds_read_b64_tr_b16 v[96:97], v240 offset:0
    ds_read_b64_tr_b16 v[98:99], v240 offset:2048
    ds_read_b64_tr_b16 v[100:101], v241 offset:0
    ds_read_b64_tr_b16 v[102:103], v241 offset:2048
    ds_read_b64_tr_b16 v[104:105], v242 offset:0
    ds_read_b64_tr_b16 v[106:107], v242 offset:2048
    ds_read_b64_tr_b16 v[108:109], v243 offset:0
    ds_read_b64_tr_b16 v[110:111], v243 offset:2048
    s_waitcnt vmcnt(17) lgkmcnt(7)
    v_add_u32 v240, 0, v246
    v_xor_b32 v241, 32, v240
    v_xor_b32 v242, 64, v240
    v_xor_b32 v243, 96, v240
    ds_read_b64_tr_b16 v[128:129], v240 offset:0
    ds_read_b64_tr_b16 v[130:131], v240 offset:2048
    ds_read_b64_tr_b16 v[132:133], v241 offset:0
    ds_read_b64_tr_b16 v[134:135], v241 offset:2048
    ds_read_b64_tr_b16 v[136:137], v242 offset:0
    ds_read_b64_tr_b16 v[138:139], v242 offset:2048
    ds_read_b64_tr_b16 v[140:141], v243 offset:0
    ds_read_b64_tr_b16 v[142:143], v243 offset:2048
    s_waitcnt vmcnt(13) lgkmcnt(7)
    v_add_u32 v240, s7, v246
    v_xor_b32 v241, 32, v240
    v_xor_b32 v242, 64, v240
    v_xor_b32 v243, 96, v240
    ds_read_b64_tr_b16 v[144:145], v240 offset:0
    ds_read_b64_tr_b16 v[146:147], v240 offset:2048
    ds_read_b64_tr_b16 v[148:149], v241 offset:0
    ds_read_b64_tr_b16 v[150:151], v241 offset:2048
    ds_read_b64_tr_b16 v[152:153], v242 offset:0
    ds_read_b64_tr_b16 v[154:155], v242 offset:2048
    ds_read_b64_tr_b16 v[156:157], v243 offset:0
    ds_read_b64_tr_b16 v[158:159], v243 offset:2048
    s_waitcnt vmcnt(9) lgkmcnt(7)
    v_add_u32 v8, 49152, v246
    v_xor_b32 v9, 32, v8
    v_xor_b32 v10, 64, v8
    v_xor_b32 v11, 96, v8
    ds_read_b64_tr_b16 v[240:241], v8 offset:0
    ds_read_b64_tr_b16 v[242:243], v8 offset:2048
    ds_read_b64_tr_b16 v[244:245], v9 offset:0
    ds_read_b64_tr_b16 v[246:247], v9 offset:2048
    ds_read_b64_tr_b16 v[248:249], v10 offset:0
    ds_read_b64_tr_b16 v[250:251], v10 offset:2048
    ds_read_b64_tr_b16 v[252:253], v11 offset:0
    ds_read_b64_tr_b16 v[254:255], v11 offset:2048
    v_and_b32 v8, 15, v1
    v_lshrrev_b32 v9, 4, v1
    v_and_b32 v10, 2, v9
    v_xor_b32 v8, v8, v10
    v_lshlrev_b32 v8, 4, v8
    v_lshl_add_u32 v8, v9, 8, v8
    s_lshl_b32 s56, s12, 14
    v_add_u32 v8, s56, v8
    v_xor_b32 v9, 64, v8
    v_xor_b32 v10, 0x80, v8
    v_xor_b32 v11, 0xc0, v8
    s_lshr_b32 s60, s12, 1
    s_and_b32 s61, s12, 1
    s_lshl_b32 s61, s61, 3
    v_lshrrev_b32 v2, 3, v1
    v_add_u32 v2, s61, v2
    v_and_b32 v3, 7, v1
    v_lshlrev_b32 v7, 1, v3
    v_xor_b32 v2, v2, v7
    v_lshlrev_b32 v3, 9, v3
    v_lshl_add_u32 v2, v2, 4, v3
    s_lshl_b32 s56, s60, 12
    v_add_u32 v2, s56, v2
    v_add_u32 v3, 0x10000, v2
    s_waitcnt lgkmcnt(0)
    s_mov_b32 s52, s30
    s_mov_b32 s53, s31
    s_mov_b32 s54, 1835008
    s_mov_b32 s55, 0x20000
    s_waitcnt vmcnt(8)
    v_mfma_f32_16x16x32_bf16 v[16:19], v[208:211], v[64:67], 0
    v_mfma_f32_16x16x32_bf16 v[20:23], v[212:215], v[64:67], 0
    v_mfma_f32_16x16x32_bf16 v[24:27], v[216:219], v[64:67], 0
    v_mfma_f32_16x16x32_bf16 v[28:31], v[220:223], v[64:67], 0
    s_add_u32 s56, s74, s65
    buffer_load_dwordx4 v[64:67], v5, s[48:51], s56 offen sc1
    s_waitcnt vmcnt(8)
    v_mfma_f32_16x16x32_bf16 v[32:35], v[208:211], v[68:71], 0
    v_mfma_f32_16x16x32_bf16 v[36:39], v[212:215], v[68:71], 0
    v_mfma_f32_16x16x32_bf16 v[40:43], v[216:219], v[68:71], 0
    v_mfma_f32_16x16x32_bf16 v[44:47], v[220:223], v[68:71], 0
    s_add_u32 s65, s65, 1024
    s_cmp_eq_u32 s65, s66
    s_cselect_b32 s65, s64, s65
    s_add_u32 s56, s72, s65
    buffer_load_dwordx4 v[68:71], v5, s[48:51], s56 offen sc1
    s_waitcnt vmcnt(8)
    v_mfma_f32_16x16x32_bf16 v[48:51], v[208:211], v[72:75], 0
    v_mfma_f32_16x16x32_bf16 v[52:55], v[212:215], v[72:75], 0
    v_mfma_f32_16x16x32_bf16 v[56:59], v[216:219], v[72:75], 0
    v_mfma_f32_16x16x32_bf16 v[60:63], v[220:223], v[72:75], 0
    s_add_u32 s56, s73, s65
    buffer_load_dwordx4 v[72:75], v5, s[48:51], s56 offen sc1
    s_waitcnt vmcnt(8)
    v_mfma_f32_16x16x32_bf16 v[16:19], v[224:227], v[76:79], v[16:19]
    v_mfma_f32_16x16x32_bf16 v[20:23], v[228:231], v[76:79], v[20:23]
    v_mfma_f32_16x16x32_bf16 v[24:27], v[232:235], v[76:79], v[24:27]
    v_mfma_f32_16x16x32_bf16 v[28:31], v[236:239], v[76:79], v[28:31]
    s_add_u32 s56, s74, s65
    buffer_load_dwordx4 v[76:79], v5, s[48:51], s56 offen sc1
    s_waitcnt vmcnt(8)
    v_mfma_f32_16x16x32_bf16 v[32:35], v[224:227], v[80:83], v[32:35]
    v_mfma_f32_16x16x32_bf16 v[36:39], v[228:231], v[80:83], v[36:39]
    v_mfma_f32_16x16x32_bf16 v[40:43], v[232:235], v[80:83], v[40:43]
    v_mfma_f32_16x16x32_bf16 v[44:47], v[236:239], v[80:83], v[44:47]
    s_add_u32 s65, s65, 1024
    s_cmp_eq_u32 s65, s66
    s_cselect_b32 s65, s64, s65
    s_add_u32 s56, s72, s65
    buffer_load_dwordx4 v[80:83], v5, s[48:51], s56 offen sc1
    s_waitcnt vmcnt(8)
    v_mfma_f32_16x16x32_bf16 v[48:51], v[224:227], v[84:87], v[48:51]
    v_mfma_f32_16x16x32_bf16 v[52:55], v[228:231], v[84:87], v[52:55]
    v_mfma_f32_16x16x32_bf16 v[56:59], v[232:235], v[84:87], v[56:59]
    v_mfma_f32_16x16x32_bf16 v[60:63], v[236:239], v[84:87], v[60:63]
    s_add_u32 s56, s73, s65
    buffer_load_dwordx4 v[84:87], v5, s[48:51], s56 offen sc1
    s_barrier
    s_waitcnt vmcnt(8)
    v_mfma_f32_16x16x32_bf16 v[16:19], v[160:163], v[88:91], v[16:19]
    v_mfma_f32_16x16x32_bf16 v[20:23], v[164:167], v[88:91], v[20:23]
    v_mfma_f32_16x16x32_bf16 v[24:27], v[168:171], v[88:91], v[24:27]
    v_mfma_f32_16x16x32_bf16 v[28:31], v[172:175], v[88:91], v[28:31]
    s_add_u32 s56, s74, s65
    buffer_load_dwordx4 v[88:91], v5, s[48:51], s56 offen sc1
    s_waitcnt vmcnt(8)
    v_mfma_f32_16x16x32_bf16 v[32:35], v[160:163], v[92:95], v[32:35]
    v_mfma_f32_16x16x32_bf16 v[36:39], v[164:167], v[92:95], v[36:39]
    v_mfma_f32_16x16x32_bf16 v[40:43], v[168:171], v[92:95], v[40:43]
    v_mfma_f32_16x16x32_bf16 v[44:47], v[172:175], v[92:95], v[44:47]
    s_add_u32 s65, s65, 1024
    s_cmp_eq_u32 s65, s66
    s_cselect_b32 s65, s64, s65
    s_mov_b32 s58, s65
    s_add_u32 s56, s72, s58
    buffer_load_dwordx4 v[92:95], v5, s[48:51], s56 offen sc1
    s_waitcnt vmcnt(7)
    v_mfma_f32_16x16x32_bf16 v[48:51], v[160:163], v[64:67], v[48:51]
    v_mfma_f32_16x16x32_bf16 v[52:55], v[164:167], v[64:67], v[52:55]
    v_mfma_f32_16x16x32_bf16 v[56:59], v[168:171], v[64:67], v[56:59]
    v_mfma_f32_16x16x32_bf16 v[60:63], v[172:175], v[64:67], v[60:63]
    s_add_u32 s65, s65, 1024
    s_cmp_eq_u32 s65, s66
    s_cselect_b32 s65, s64, s65
    s_mov_b32 s59, s65
    s_add_u32 s56, s72, s59
    buffer_load_dwordx4 v[64:67], v5, s[48:51], s56 offen sc1
    s_waitcnt vmcnt(7)
    v_mfma_f32_16x16x32_bf16 v[16:19], v[176:179], v[68:71], v[16:19]
    v_mfma_f32_16x16x32_bf16 v[20:23], v[180:183], v[68:71], v[20:23]
    v_mfma_f32_16x16x32_bf16 v[24:27], v[184:187], v[68:71], v[24:27]
    v_mfma_f32_16x16x32_bf16 v[28:31], v[188:191], v[68:71], v[28:31]
    buffer_load_dwordx4 v[68:71], v112, s[48:51], s63 offen offset:0 sc1
    s_waitcnt vmcnt(7)
    v_mfma_f32_16x16x32_bf16 v[32:35], v[176:179], v[72:75], v[32:35]
    v_mfma_f32_16x16x32_bf16 v[36:39], v[180:183], v[72:75], v[36:39]
    v_mfma_f32_16x16x32_bf16 v[40:43], v[184:187], v[72:75], v[40:43]
    v_mfma_f32_16x16x32_bf16 v[44:47], v[188:191], v[72:75], v[44:47]
    buffer_load_dwordx4 v[72:75], v112, s[48:51], s63 offen offset:1024 sc1
    s_waitcnt vmcnt(7)
    v_mfma_f32_16x16x32_bf16 v[48:51], v[176:179], v[76:79], v[48:51]
    v_mfma_f32_16x16x32_bf16 v[52:55], v[180:183], v[76:79], v[52:55]
    v_mfma_f32_16x16x32_bf16 v[56:59], v[184:187], v[76:79], v[56:59]
    v_mfma_f32_16x16x32_bf16 v[60:63], v[188:191], v[76:79], v[60:63]
    s_add_u32 s56, s73, s58
    buffer_load_dwordx4 v[76:79], v5, s[48:51], s56 offen sc1
    s_waitcnt vmcnt(7)
    v_mfma_f32_16x16x32_bf16 v[16:19], v[192:195], v[80:83], v[16:19]
    v_mfma_f32_16x16x32_bf16 v[20:23], v[196:199], v[80:83], v[20:23]
    v_mfma_f32_16x16x32_bf16 v[24:27], v[200:203], v[80:83], v[24:27]
    v_mfma_f32_16x16x32_bf16 v[28:31], v[204:207], v[80:83], v[28:31]
    s_add_u32 s56, s73, s59
    buffer_load_dwordx4 v[80:83], v5, s[48:51], s56 offen sc1
    s_waitcnt vmcnt(7)
    v_mfma_f32_16x16x32_bf16 v[32:35], v[192:195], v[84:87], v[32:35]
    v_mfma_f32_16x16x32_bf16 v[36:39], v[196:199], v[84:87], v[36:39]
    v_mfma_f32_16x16x32_bf16 v[40:43], v[200:203], v[84:87], v[40:43]
    v_mfma_f32_16x16x32_bf16 v[44:47], v[204:207], v[84:87], v[44:47]
    buffer_load_dwordx4 v[84:87], v113, s[48:51], s63 offen offset:0 sc1
    s_waitcnt vmcnt(7)
    v_mfma_f32_16x16x32_bf16 v[48:51], v[192:195], v[88:91], v[48:51]
    v_mfma_f32_16x16x32_bf16 v[52:55], v[196:199], v[88:91], v[52:55]
    v_mfma_f32_16x16x32_bf16 v[56:59], v[200:203], v[88:91], v[56:59]
    v_mfma_f32_16x16x32_bf16 v[60:63], v[204:207], v[88:91], v[60:63]
    buffer_load_dwordx4 v[88:91], v113, s[48:51], s63 offen offset:1024 sc1
    s_waitcnt vmcnt(7)
    v_mfma_f32_16x16x32_bf16 v[16:19], v[96:99], v[92:95], v[16:19]
    v_mfma_f32_16x16x32_bf16 v[20:23], v[100:103], v[92:95], v[20:23]
    v_mfma_f32_16x16x32_bf16 v[24:27], v[104:107], v[92:95], v[24:27]
    v_mfma_f32_16x16x32_bf16 v[28:31], v[108:111], v[92:95], v[28:31]
    s_add_u32 s56, s74, s58
    buffer_load_dwordx4 v[92:95], v5, s[48:51], s56 offen sc1
    s_waitcnt vmcnt(7)
    v_mfma_f32_16x16x32_bf16 v[16:19], v[128:131], v[64:67], v[16:19]
    v_mfma_f32_16x16x32_bf16 v[20:23], v[132:135], v[64:67], v[20:23]
    v_mfma_f32_16x16x32_bf16 v[24:27], v[136:139], v[64:67], v[24:27]
    v_mfma_f32_16x16x32_bf16 v[28:31], v[140:143], v[64:67], v[28:31]
    s_add_u32 s56, s74, s59
    buffer_load_dwordx4 v[64:67], v5, s[48:51], s56 offen sc1
    s_waitcnt vmcnt(7)
    v_mfma_f32_16x16x32_bf16 v[16:19], v[144:147], v[68:71], v[16:19]
    v_mfma_f32_16x16x32_bf16 v[20:23], v[148:151], v[68:71], v[20:23]
    v_mfma_f32_16x16x32_bf16 v[24:27], v[152:155], v[68:71], v[24:27]
    v_mfma_f32_16x16x32_bf16 v[28:31], v[156:159], v[68:71], v[28:31]
    buffer_load_dwordx4 v[68:71], v114, s[48:51], s63 offen offset:0 sc1
    s_waitcnt vmcnt(7)
    v_mfma_f32_16x16x32_bf16 v[16:19], v[240:243], v[72:75], v[16:19]
    v_mfma_f32_16x16x32_bf16 v[20:23], v[244:247], v[72:75], v[20:23]
    v_mfma_f32_16x16x32_bf16 v[24:27], v[248:251], v[72:75], v[24:27]
    v_mfma_f32_16x16x32_bf16 v[28:31], v[252:255], v[72:75], v[28:31]
    buffer_load_dwordx4 v[72:75], v114, s[48:51], s63 offen offset:1024 sc1
    s_waitcnt vmcnt(7)
    v_mfma_f32_16x16x32_bf16 v[32:35], v[96:99], v[76:79], v[32:35]
    v_mfma_f32_16x16x32_bf16 v[36:39], v[100:103], v[76:79], v[36:39]
    v_mfma_f32_16x16x32_bf16 v[40:43], v[104:107], v[76:79], v[40:43]
    v_mfma_f32_16x16x32_bf16 v[44:47], v[108:111], v[76:79], v[44:47]
    s_waitcnt vmcnt(6)
    v_mfma_f32_16x16x32_bf16 v[32:35], v[128:131], v[80:83], v[32:35]
    v_mfma_f32_16x16x32_bf16 v[36:39], v[132:135], v[80:83], v[36:39]
    v_mfma_f32_16x16x32_bf16 v[40:43], v[136:139], v[80:83], v[40:43]
    v_mfma_f32_16x16x32_bf16 v[44:47], v[140:143], v[80:83], v[44:47]
    ds_write_b128 v8, v[16:19] offset:0
    ds_write_b128 v9, v[20:23] offset:1024
    ds_write_b128 v10, v[24:27] offset:2048
    ds_write_b128 v11, v[28:31] offset:3072
    s_waitcnt vmcnt(5)
    v_mfma_f32_16x16x32_bf16 v[32:35], v[144:147], v[84:87], v[32:35]
    v_mfma_f32_16x16x32_bf16 v[36:39], v[148:151], v[84:87], v[36:39]
    v_mfma_f32_16x16x32_bf16 v[40:43], v[152:155], v[84:87], v[40:43]
    v_mfma_f32_16x16x32_bf16 v[44:47], v[156:159], v[84:87], v[44:47]
    s_waitcnt vmcnt(4)
    v_mfma_f32_16x16x32_bf16 v[32:35], v[240:243], v[88:91], v[32:35]
    v_mfma_f32_16x16x32_bf16 v[36:39], v[244:247], v[88:91], v[36:39]
    v_mfma_f32_16x16x32_bf16 v[40:43], v[248:251], v[88:91], v[40:43]
    v_mfma_f32_16x16x32_bf16 v[44:47], v[252:255], v[88:91], v[44:47]
    s_waitcnt vmcnt(3)
    v_mfma_f32_16x16x32_bf16 v[48:51], v[96:99], v[92:95], v[48:51]
    v_mfma_f32_16x16x32_bf16 v[52:55], v[100:103], v[92:95], v[52:55]
    v_mfma_f32_16x16x32_bf16 v[56:59], v[104:107], v[92:95], v[56:59]
    v_mfma_f32_16x16x32_bf16 v[60:63], v[108:111], v[92:95], v[60:63]
    s_waitcnt vmcnt(2)
    v_mfma_f32_16x16x32_bf16 v[48:51], v[128:131], v[64:67], v[48:51]
    v_mfma_f32_16x16x32_bf16 v[52:55], v[132:135], v[64:67], v[52:55]
    v_mfma_f32_16x16x32_bf16 v[56:59], v[136:139], v[64:67], v[56:59]
    v_mfma_f32_16x16x32_bf16 v[60:63], v[140:143], v[64:67], v[60:63]
    ds_write_b128 v8, v[32:35] offset:4096
    ds_write_b128 v9, v[36:39] offset:5120
    ds_write_b128 v10, v[40:43] offset:6144
    ds_write_b128 v11, v[44:47] offset:7168
    s_waitcnt vmcnt(1)
    v_mfma_f32_16x16x32_bf16 v[48:51], v[144:147], v[68:71], v[48:51]
    v_mfma_f32_16x16x32_bf16 v[52:55], v[148:151], v[68:71], v[52:55]
    v_mfma_f32_16x16x32_bf16 v[56:59], v[152:155], v[68:71], v[56:59]
    v_mfma_f32_16x16x32_bf16 v[60:63], v[156:159], v[68:71], v[60:63]
    s_waitcnt vmcnt(0)
    v_mfma_f32_16x16x32_bf16 v[48:51], v[240:243], v[72:75], v[48:51]
    v_mfma_f32_16x16x32_bf16 v[52:55], v[244:247], v[72:75], v[52:55]
    v_mfma_f32_16x16x32_bf16 v[56:59], v[248:251], v[72:75], v[56:59]
    v_mfma_f32_16x16x32_bf16 v[60:63], v[252:255], v[72:75], v[60:63]
    v_lshlrev_b32 v192, 16, v12
    v_and_b32 v193, 0xffff0000, v12
    v_lshlrev_b32 v194, 16, v13
    v_and_b32 v195, 0xffff0000, v13
    v_lshlrev_b32 v196, 16, v14
    v_and_b32 v197, 0xffff0000, v14
    v_lshlrev_b32 v198, 16, v15
    v_and_b32 v199, 0xffff0000, v15
    ds_write_b128 v8, v[48:51] offset:8192
    ds_write_b128 v9, v[52:55] offset:9216
    ds_write_b128 v10, v[56:59] offset:10240
    ds_write_b128 v11, v[60:63] offset:11264
    s_waitcnt lgkmcnt(0)
    s_barrier
    ds_read_b128 v[208:211], v2 offset:0
    ds_read_b128 v[212:215], v2 offset:256
    ds_read_b128 v[216:219], v2 offset:16384
    ds_read_b128 v[220:223], v2 offset:16640
    ds_read_b128 v[224:227], v2 offset:32768
    ds_read_b128 v[228:231], v2 offset:33024
    ds_read_b128 v[232:235], v2 offset:49152
    ds_read_b128 v[236:239], v2 offset:49408
    ds_read_b128 v[160:163], v3 offset:0
    ds_read_b128 v[164:167], v3 offset:256
    ds_read_b128 v[168:171], v3 offset:16384
    ds_read_b128 v[172:175], v3 offset:16640
    ds_read_b128 v[176:179], v3 offset:32768
    ds_read_b128 v[180:183], v3 offset:33024
    s_waitcnt lgkmcnt(12)
    ds_read_b128 v[184:187], v3 offset:49152
    ds_read_b128 v[188:191], v3 offset:49408
    s_waitcnt lgkmcnt(14)
    v_pk_add_f32 v[192:193], v[192:193], v[208:209]
    v_pk_add_f32 v[194:195], v[194:195], v[210:211]
    v_pk_add_f32 v[196:197], v[196:197], v[212:213]
    v_pk_add_f32 v[198:199], v[198:199], v[214:215]
    s_waitcnt lgkmcnt(12)
    v_pk_add_f32 v[192:193], v[192:193], v[216:217]
    v_pk_add_f32 v[194:195], v[194:195], v[218:219]
    v_pk_add_f32 v[196:197], v[196:197], v[220:221]
    v_pk_add_f32 v[198:199], v[198:199], v[222:223]
    s_waitcnt lgkmcnt(10)
    v_pk_add_f32 v[192:193], v[192:193], v[224:225]
    v_pk_add_f32 v[194:195], v[194:195], v[226:227]
    v_pk_add_f32 v[196:197], v[196:197], v[228:229]
    v_pk_add_f32 v[198:199], v[198:199], v[230:231]
    s_waitcnt lgkmcnt(8)
    v_pk_add_f32 v[192:193], v[192:193], v[232:233]
    v_pk_add_f32 v[194:195], v[194:195], v[234:235]
    v_pk_add_f32 v[196:197], v[196:197], v[236:237]
    v_pk_add_f32 v[198:199], v[198:199], v[238:239]
    s_waitcnt lgkmcnt(6)
    v_pk_add_f32 v[192:193], v[192:193], v[160:161]
    v_pk_add_f32 v[194:195], v[194:195], v[162:163]
    v_pk_add_f32 v[196:197], v[196:197], v[164:165]
    v_pk_add_f32 v[198:199], v[198:199], v[166:167]
    s_waitcnt lgkmcnt(4)
    v_pk_add_f32 v[192:193], v[192:193], v[168:169]
    v_pk_add_f32 v[194:195], v[194:195], v[170:171]
    v_pk_add_f32 v[196:197], v[196:197], v[172:173]
    v_pk_add_f32 v[198:199], v[198:199], v[174:175]
    s_waitcnt lgkmcnt(2)
    v_pk_add_f32 v[192:193], v[192:193], v[176:177]
    v_pk_add_f32 v[194:195], v[194:195], v[178:179]
    v_pk_add_f32 v[196:197], v[196:197], v[180:181]
    v_pk_add_f32 v[198:199], v[198:199], v[182:183]
    s_waitcnt lgkmcnt(0)
    v_pk_add_f32 v[192:193], v[192:193], v[184:185]
    v_pk_add_f32 v[194:195], v[194:195], v[186:187]
    v_pk_add_f32 v[196:197], v[196:197], v[188:189]
    v_pk_add_f32 v[198:199], v[198:199], v[190:191]
    v_cvt_pk_bf16_f32 v200, v192, v193
    v_cvt_pk_bf16_f32 v201, v194, v195
    v_cvt_pk_bf16_f32 v202, v196, v197
    v_cvt_pk_bf16_f32 v203, v198, v199
    buffer_store_dwordx4 v[200:203], v6, s[52:55], 0 offen
k_done:
k_end:
    s_endpgm
.section .rodata,"a"
.p2align 6
.amdhsa_kernel parallel_sum__sliding_local_dilated__geglu_ffn__prompt_kernel
  .amdhsa_next_free_vgpr 256
  .amdhsa_next_free_sgpr 102
  .amdhsa_accum_offset 256
  .amdhsa_group_segment_fixed_size 0
  .amdhsa_kernarg_size 80
  .amdhsa_user_sgpr_count 2
  .amdhsa_user_sgpr_kernarg_segment_ptr 1
  .amdhsa_system_sgpr_workgroup_id_x 1
.end_amdhsa_kernel
```
